```python
import torch

def _softmax(x, axis=-1):
    return torch.softmax(x, dim=axis)
def _gelu(x):
    return torch.nn.functional.gelu(x, approximate="tanh")
def _silu(x):
    return torch.nn.functional.silu(x)
def _sigmoid(x):
    return torch.sigmoid(x)
def _layernorm(x, axis=-1, eps=1e-5):
    m = x.mean(dim=axis, keepdim=True)
    v = x.var(dim=axis, keepdim=True, unbiased=False)
    return (x - m) / torch.sqrt(v + eps)
def _scatter_add(tgt, idx, src, axis=0):
    return tgt.clone().index_add_(axis, idx, src)
def _segment_sum(src, seg, n):
    out = torch.zeros((n,) + src.shape[1:], dtype=src.dtype)
    return out.index_add_(0, seg, src)
def _pad(x, pw):
    flat = tuple(v for pair in reversed(pw) for v in pair)
    return torch.nn.functional.pad(x, flat)

kernel_name = 'interleave_layers__spectral_gfnet__dense_activation_gelu__prompt'

def setup_inputs():

    _w = (lambda a: (lambda t: t.to(torch.bfloat16) if t.is_floating_point() else t)(torch.as_tensor(a)))
    def _A_setup():
        B, S, D = 1, 2048, 1024
        Df = D // 2 + 1
        return {
            "x": _w((lambda *s: torch.randn(*s, dtype=torch.bfloat16) * 0.05)(B, S, D)),
            "w_r": _w((lambda *s: torch.randn(*s, dtype=torch.bfloat16) * 0.4)(S, Df) * 0.02),
            "w_i": _w((lambda *s: torch.randn(*s, dtype=torch.bfloat16) * 0.4)(S, Df) * 0.02),
        }
    _A_in = _A_setup()

    def _B_setup():
        B, S, D, F = 1, 2048, 1024, 3584
        return {
            "x": _w((lambda *s: torch.randn(*s, dtype=torch.bfloat16) * 0.05)(B, S, D)),
            "w1": _w((lambda *s: torch.randn(*s, dtype=torch.bfloat16) * 0.4)(D, F) * (D ** -0.5)),
            "b1": _w((lambda *s: torch.randn(*s, dtype=torch.bfloat16) * 12.8)(F) * 0.01),
            "w2": _w((lambda *s: torch.randn(*s, dtype=torch.bfloat16) * 0.1)(F, D) * (F ** -0.5)),
            "b2": _w((lambda *s: torch.randn(*s, dtype=torch.bfloat16) * 0.8)(D) * 0.01),
        }
    _B_in = _B_setup()

    return {
        "A_x": _A_in["x"],
        "A_w_r": _A_in["w_r"],
        "A_w_i": _A_in["w_i"],
        "B_x": _B_in["x"],
        "B_w1": _B_in["w1"],
        "B_b1": _B_in["b1"],
        "B_w2": _B_in["w2"],
        "B_b2": _B_in["b2"],
    }

def reference(A_x, A_w_r, A_w_i, B_x, B_w1, B_b1, B_w2, B_b2):
    def _A_ref(x, w_r, w_i):
        B, S, D = x.shape
        X = (lambda x, axes=(-2,-1): torch.fft.rfft2(x.float(), dim=axes))(x, axes=(-2, -1))
        W = w_r + 1j * w_i
        X = X * W
        y = (lambda x, s, axes=(-2,-1): torch.fft.irfft2(x, s=s, dim=axes).to(torch.bfloat16))(X, (S, D), axes=(-2, -1))
        return y

    def _B_ref(x, w1, b1, w2, b2):
        h = torch.einsum("bsd,df->bsf", x, w1) + b1
        h = _gelu(h)
        return torch.einsum("bsf,fd->bsd", h, w2) + b2

    x = A_x
    x = x + _A_ref(_layernorm(x, axis=-1), A_w_r, A_w_i)
    x = x + _B_ref(_layernorm(x, axis=-1), B_w1, B_b1, B_w2, B_b2)
    x = x + _A_ref(_layernorm(x, axis=-1), A_w_r, A_w_i)
    x = x + _B_ref(_layernorm(x, axis=-1), B_w1, B_b1, B_w2, B_b2)
    return x
```

```asm
; @launch kernel=k1a_kernel grid=(512,1,1) block=(512,1,1) lds=20480
; @launch kernel=k2a_kernel grid=(256,1,1) block=(512,1,1) lds=16384
; @launch kernel=gga_kernel grid=(256,1,1) block=(256,1,1) lds=148480
; @launch kernel=k2b_kernel grid=(256,1,1) block=(512,1,1) lds=16384
; @launch kernel=ggb_kernel grid=(256,1,1) block=(256,1,1) lds=148480
.amdgcn_target "amdgcn-amd-amdhsa--gfx950"
.text
.globl k1a_kernel
.p2align 8
.type k1a_kernel,@function
k1a_kernel:
code_start:
    s_load_dwordx2 s[4:5], s[0:1], 0
    s_load_dwordx2 s[6:7], s[0:1], 80
    s_mov_b32 s20, 0
    s_mov_b32 s21, 8388608
    s_mov_b32 s64, 0
    s_load_dwordx2 s[54:55], s[0:1], 32
    s_cmp_lt_u32 s2, 256
    s_cbranch_scc0 L_k1_other
L_k1_body:
    s_mov_b32 s65, s2
    s_and_b32 s3, s65, 3
    s_lshl_b32 s2, s3, 6
    s_lshr_b32 s3, s65, 4
    s_lshl_b32 s3, s3, 2
    s_or_b32 s2, s2, s3
    s_bfe_u32 s3, s65, 0x10002
    s_lshl_b32 s3, s3, 1
    s_or_b32 s2, s2, s3
    s_bfe_u32 s3, s65, 0x10003
    s_or_b32 s2, s2, s3
    s_getpc_b64 s[30:31]
Lpc_k1:
    s_add_u32 s30, s30, tbl_k1-Lpc_k1
    s_addc_u32 s31, s31, 0
    v_and_b32 v1, 63, v0
    v_lshlrev_b32 v3, 4, v1
    global_load_dwordx4 v[16:19], v3, s[30:31]
    global_load_dwordx4 v[20:23], v3, s[30:31] offset:1024
    v_lshrrev_b32 v4, 6, v0
    v_lshrrev_b32 v5, 4, v1
    v_readfirstlane_b32 s22, v4
    v_and_b32 v6, 15, v1
    v_lshrrev_b32 v2, 2, v1
    v_lshlrev_b32 v2, 6, v2
    v_and_b32 v8, 3, v1
    v_lshl_add_u32 v2, v8, 3, v2
    s_lshl_b32 s32, s22, 11
    s_mov_b32 m0, s32
    v_add_u32 v2, s32, v2
    s_lshl_b32 s23, s22, 8
    s_add_u32 s23, s23, s2
    s_lshl_b32 s23, s23, 11
    s_mov_b32 s24, 0x00010001
    s_mov_b32 s25, 0x00010001
    s_mov_b32 s26, 1
    s_mov_b32 s27, 0
    s_mov_b32 s28, 0x05040100
    s_mov_b32 s29, 0x07060302
    v_cndmask_b32 v118, v6, 16, s[24:25]
    v_cvt_f32_u32 v118, v118
    v_cvt_f32_u32 v119, v5
    v_mul_f32 v118, 0x3a800000, v118
    v_mul_f32 v119, v119, v118
    v_mul_f32 v119, 4.0, v119
    v_cos_f32 v48, v119
    v_sin_f32 v56, v119
    v_add_f32 v119, v119, v118
    v_cos_f32 v49, v119
    v_sin_f32 v57, v119
    v_add_f32 v119, v119, v118
    v_cos_f32 v50, v119
    v_sin_f32 v58, v119
    v_add_f32 v119, v119, v118
    v_cos_f32 v51, v119
    v_sin_f32 v59, v119
    v_fmac_f32 v119, 0x41500000, v118
    v_cos_f32 v52, v119
    v_sin_f32 v60, v119
    v_add_f32 v119, v119, v118
    v_cos_f32 v53, v119
    v_sin_f32 v61, v119
    v_add_f32 v119, v119, v118
    v_cos_f32 v54, v119
    v_sin_f32 v62, v119
    v_add_f32 v119, v119, v118
    v_cos_f32 v55, v119
    v_sin_f32 v63, v119
    s_waitcnt lgkmcnt(0)
    s_add_u32 s8, s4, s20
    s_addc_u32 s9, s5, 0
    s_mov_b32 s10, 4194304
    s_mov_b32 s11, 0x20000
    buffer_load_dwordx4 v3, s[8:11], s23 offen lds
    buffer_load_dwordx4 v3, s[8:11], s23 offen offset:1024 lds
    s_add_u32 s12, s6, s21
    s_addc_u32 s13, s7, 0
    s_mov_b32 s14, 4194304
    s_mov_b32 s15, 0x20000
    v_lshrrev_b32 v118, 1, v6
    v_and_b32 v119, 1, v6
    v_lshlrev_b32 v119, 9, v119
    v_lshlrev_b32 v120, 9, v5
    v_add_u32 v120, s2, v120
    v_mad_u32_u24 v120, v118, v120, v119
    v_lshl_add_u32 v121, v118, 8, v120
    v_and_b32 v120, 2047, v120
    v_and_b32 v121, 2047, v121
    v_cvt_f32_u32 v120, v120
    v_cvt_f32_u32 v121, v121
    v_mul_f32 v120, 0x3a000000, v120
    v_mul_f32 v121, 0x3a000000, v121
    v_cos_f32 v122, v120
    v_sin_f32 v123, v120
    v_cos_f32 v124, v121
    v_sin_f32 v125, v121
    v_mov_b32 v44, 0x3f803f80
    v_mov_b32 v45, 0x3f803f80
    v_mov_b32 v46, 0x3f803f80
    v_mov_b32 v47, 0x3f803f80
    v_mov_b32 v118, 0xbf803f80
    s_waitcnt vmcnt(2)
    v_xor_b32 v24, 0x80008000, v20
    v_xor_b32 v28, 0x80000000, v16
    v_xor_b32 v32, 0x80000000, v20
    v_xor_b32 v36, 0x00008000, v20
    v_cndmask_b32 v40, v16, v118, s[24:25]
    v_xor_b32 v25, 0x80008000, v21
    v_xor_b32 v29, 0x80000000, v17
    v_xor_b32 v33, 0x80000000, v21
    v_xor_b32 v37, 0x00008000, v21
    v_cndmask_b32 v41, v17, v118, s[24:25]
    v_xor_b32 v26, 0x80008000, v22
    v_xor_b32 v30, 0x80000000, v18
    v_xor_b32 v34, 0x80000000, v22
    v_xor_b32 v38, 0x00008000, v22
    v_cndmask_b32 v42, v18, v118, s[24:25]
    v_xor_b32 v27, 0x80008000, v23
    v_xor_b32 v31, 0x80000000, v19
    v_xor_b32 v35, 0x80000000, v23
    v_xor_b32 v39, 0x00008000, v23
    v_cndmask_b32 v43, v19, v118, s[24:25]
    s_lshl_b32 s32, s22, 11
    v_add_u32 v126, s32, v3
    v_lshlrev_b32 v127, 12, v5
    v_lshl_add_u32 v127, v6, 4, v127
    s_lshl_b32 s33, s22, 8
    v_add_u32 v127, s33, v127
    v_lshlrev_b32 v7, 20, v5
    v_lshl_add_u32 v7, v6, 4, v7
    s_waitcnt vmcnt(0)
    ds_read_b64_tr_b16 v[64:65], v2 offset:0
    ds_read_b64_tr_b16 v[66:67], v2 offset:1024
    ds_read_b64_tr_b16 v[68:69], v2 offset:32
    ds_read_b64_tr_b16 v[70:71], v2 offset:1056
    s_waitcnt lgkmcnt(0)
    v_mfma_f32_16x16x32_bf16 v[72:75], v[64:67], v[40:43], 0
    v_mfma_f32_16x16x32_bf16 v[80:83], v[64:67], v[20:23], 0
    v_mfma_f32_16x16x32_bf16 v[76:79], v[68:71], v[40:43], 0
    v_mfma_f32_16x16x32_bf16 v[84:87], v[68:71], v[20:23], 0
    s_cmp_eq_u32 s64, 0
    s_cselect_b32 s60, 7340032, 0
    s_add_u32 s56, s54, 0
    s_addc_u32 s57, s55, 0
    s_mov_b32 s58, s60
    s_mov_b32 s59, 0x20000
    s_lshl_b32 s61, s2, 3
    s_add_u32 s61, s61, s22
    s_mul_i32 s61, s61, 1792
    s_add_u32 s61, s61, 0
    v_min_u32 v10, 27, v1
    v_lshlrev_b32 v10, 6, v10
    buffer_load_dword v0, v10, s[56:59], s61 offen
    v_dot2_f32_bf16 v116, v64, v44, 0
    v_dot2_f32_bf16 v117, v64, v64, 0
    v_dot2_f32_bf16 v116, v65, v44, v116
    v_dot2_f32_bf16 v117, v65, v65, v117
    v_dot2_f32_bf16 v116, v66, v44, v116
    v_dot2_f32_bf16 v117, v66, v66, v117
    v_dot2_f32_bf16 v116, v67, v44, v116
    v_dot2_f32_bf16 v117, v67, v67, v117
    v_dot2_f32_bf16 v116, v68, v44, v116
    v_dot2_f32_bf16 v117, v68, v68, v117
    v_dot2_f32_bf16 v116, v69, v44, v116
    v_dot2_f32_bf16 v117, v69, v69, v117
    v_dot2_f32_bf16 v116, v70, v44, v116
    v_dot2_f32_bf16 v117, v70, v70, v117
    v_dot2_f32_bf16 v116, v71, v44, v116
    v_dot2_f32_bf16 v117, v71, v71, v117
    s_nop 1
    v_add_f32_dpp v116, v116, v116 quad_perm:[1,0,3,2] row_mask:0xf bank_mask:0xf
    v_add_f32_dpp v117, v117, v117 quad_perm:[1,0,3,2] row_mask:0xf bank_mask:0xf
    s_nop 0
    v_add_f32_dpp v116, v116, v116 quad_perm:[2,3,0,1] row_mask:0xf bank_mask:0xf
    v_add_f32_dpp v117, v117, v117 quad_perm:[2,3,0,1] row_mask:0xf bank_mask:0xf
    s_nop 0
    v_add_f32_dpp v116, v116, v116 row_half_mirror row_mask:0xf bank_mask:0xf
    v_add_f32_dpp v117, v117, v117 row_half_mirror row_mask:0xf bank_mask:0xf
    s_nop 0
    v_add_f32_dpp v116, v116, v116 row_mirror row_mask:0xf bank_mask:0xf
    v_add_f32_dpp v117, v117, v117 row_mirror row_mask:0xf bank_mask:0xf
    s_nop 0
    v_add_f32_dpp v116, v116, v116 row_bcast:15 row_mask:0xa bank_mask:0xf
    v_add_f32_dpp v117, v117, v117 row_bcast:15 row_mask:0xa bank_mask:0xf
    s_nop 0
    v_add_f32_dpp v116, v116, v116 row_bcast:31 row_mask:0xc bank_mask:0xf
    v_add_f32_dpp v117, v117, v117 row_bcast:31 row_mask:0xc bank_mask:0xf
    v_readlane_b32 s34, v116, 63
    v_readlane_b32 s35, v117, 63
    v_mov_b32 v118, 0xbd000000
    v_mul_f32 v96, s34, v118
    v_mov_b32 v97, v96
    v_mov_b32 v98, v96
    v_mov_b32 v99, v96
    s_nop 1
    v_mfma_f32_16x16x32_bf16 v[88:91], v[64:67], v[44:47], v[96:99]
    v_mfma_f32_16x16x32_bf16 v[92:95], v[68:71], v[44:47], v[96:99]
    v_mul_f32 v100, v72, v48
    v_mul_f32 v108, v80, v48
    v_mul_f32 v101, v73, v49
    v_mul_f32 v109, v81, v49
    v_mul_f32 v102, v74, v50
    v_mul_f32 v110, v82, v50
    v_mul_f32 v103, v75, v51
    v_mul_f32 v111, v83, v51
    v_fmac_f32 v100, v80, v56
    v_fma_f32 v108, -v72, v56, v108
    v_fmac_f32 v101, v81, v57
    v_fma_f32 v109, -v73, v57, v109
    v_fmac_f32 v102, v82, v58
    v_fma_f32 v110, -v74, v58, v110
    v_fmac_f32 v103, v83, v59
    v_fma_f32 v111, -v75, v59, v111
    v_mul_f32 v104, v76, v52
    v_mul_f32 v112, v84, v52
    v_mul_f32 v105, v77, v53
    v_mul_f32 v113, v85, v53
    v_mul_f32 v106, v78, v54
    v_mul_f32 v114, v86, v54
    v_mul_f32 v107, v79, v55
    v_mul_f32 v115, v87, v55
    v_fmac_f32 v104, v84, v60
    v_fma_f32 v112, -v76, v60, v112
    v_fmac_f32 v105, v85, v61
    v_fma_f32 v113, -v77, v61, v113
    v_fmac_f32 v106, v86, v62
    v_fma_f32 v114, -v78, v62, v114
    v_fmac_f32 v107, v87, v63
    v_fma_f32 v115, -v79, v63, v115
    v_mov_b32 v119, 0x3a800000
    v_mul_f32 v118, s34, v119
    v_mul_f32 v119, s35, v119
    v_fma_f32 v119, -v118, v118, v119
    v_max_f32 v119, 0, v119
    v_add_f32 v119, 0x3727c5ac, v119
    v_rsq_f32 v119, v119
    v_cvt_pk_bf16_f32 v72, v100, v101
    v_cvt_pk_bf16_f32 v76, v108, v109
    v_cvt_pk_bf16_f32 v73, v102, v103
    v_cvt_pk_bf16_f32 v77, v110, v111
    v_cvt_pk_bf16_f32 v74, v104, v105
    v_cvt_pk_bf16_f32 v78, v112, v113
    v_cvt_pk_bf16_f32 v75, v106, v107
    v_cvt_pk_bf16_f32 v79, v114, v115
    s_lshl_b32 s36, s22, 2
    v_mov_b32 v120, s36
    ds_write_b32 v120, v119 offset:16384
    v_mfma_f32_16x16x32_bf16 v[100:103], v[28:31], v[72:75], 0
    v_mfma_f32_16x16x32_bf16 v[104:107], v[28:31], v[76:79], 0
    v_mfma_f32_16x16x32_bf16 v[100:103], v[36:39], v[76:79], v[100:103]
    v_mfma_f32_16x16x32_bf16 v[104:107], v[32:35], v[72:75], v[104:107]
    v_cvt_pk_bf16_f32 v80, v88, v89
    v_cndmask_b32 v80, v72, v80, s[24:25]
    v_cndmask_b32 v84, v76, 0, s[24:25]
    v_cvt_pk_bf16_f32 v81, v90, v91
    v_cndmask_b32 v81, v73, v81, s[24:25]
    v_cndmask_b32 v85, v77, 0, s[24:25]
    v_cvt_pk_bf16_f32 v82, v92, v93
    v_cndmask_b32 v82, v74, v82, s[24:25]
    v_cndmask_b32 v86, v78, 0, s[24:25]
    v_cvt_pk_bf16_f32 v83, v94, v95
    v_cndmask_b32 v83, v75, v83, s[24:25]
    v_cndmask_b32 v87, v79, 0, s[24:25]
    s_nop 0
    v_mfma_f32_16x16x32_bf16 v[96:99], v[28:31], v[80:83], 0
    v_mfma_f32_16x16x32_bf16 v[108:111], v[16:19], v[80:83], 0
    v_mfma_f32_16x16x32_bf16 v[112:115], v[16:19], v[84:87], 0
    v_mfma_f32_16x16x32_bf16 v[108:111], v[24:27], v[84:87], v[108:111]
    v_mfma_f32_16x16x32_bf16 v[112:115], v[20:23], v[80:83], v[112:115]
    v_cvt_pk_bf16_f32 v92, v100, v104
    v_cvt_pk_bf16_f32 v93, v101, v105
    v_cvt_pk_bf16_f32 v94, v102, v106
    v_cvt_pk_bf16_f32 v95, v103, v107
    ds_write_b128 v126, v[92:95] offset:1024
    v_mul_f32 v96, 0.5, v96
    s_nop 0
    v_cndmask_b32 v108, v108, v96, s[26:27]
    v_cvt_pk_bf16_f32 v88, v108, v112
    v_cvt_pk_bf16_f32 v89, v109, v113
    v_cvt_pk_bf16_f32 v90, v110, v114
    v_cvt_pk_bf16_f32 v91, v111, v115
    ds_write_b128 v126, v[88:91]
    v_lshlrev_b32 v120, 3, v5
    s_waitcnt lgkmcnt(0)
    s_barrier
    ds_read_b64 v[118:119], v120 offset:16384
    ds_read_b128 v[64:67], v127
    ds_read_b128 v[68:71], v127 offset:2048
    s_lshl_b32 s37, s2, 12
    s_lshl_b32 s38, s22, 9
    s_add_u32 s37, s37, s38
    s_add_u32 s38, s37, 256
    s_waitcnt lgkmcnt(2)
    v_mul_f32 v122, v122, v118
    v_mul_f32 v123, v123, v118
    v_mul_f32 v124, v124, v119
    v_mul_f32 v125, v125, v119
    v_cvt_pk_bf16_f32 v120, v122, v123
    v_cvt_pk_bf16_f32 v121, v124, v125
    s_waitcnt lgkmcnt(0)
    v_swap_b32 v65, v68
    v_swap_b32 v67, v70
    s_nop 0
    v_mfma_f32_16x16x16_bf16 v[72:75], v[120:121], v[64:65], 0
    v_mfma_f32_16x16x16_bf16 v[76:79], v[120:121], v[68:69], 0
    v_mfma_f32_16x16x16_bf16 v[80:83], v[120:121], v[66:67], 0
    v_mfma_f32_16x16x16_bf16 v[84:87], v[120:121], v[70:71], 0
    s_nop 4
    v_cvt_pk_bf16_f32 v100, v72, v73
    v_cvt_pk_bf16_f32 v101, v74, v75
    v_cvt_pk_bf16_f32 v102, v76, v77
    v_cvt_pk_bf16_f32 v103, v78, v79
    buffer_store_dwordx4 v[100:103], v7, s[12:15], s37 offen
    v_cvt_pk_bf16_f32 v104, v80, v81
    v_cvt_pk_bf16_f32 v105, v82, v83
    v_cvt_pk_bf16_f32 v106, v84, v85
    v_cvt_pk_bf16_f32 v107, v86, v87
    buffer_store_dwordx4 v[104:107], v7, s[12:15], s38 offen
    s_endpgm
L_k1_other:
    s_cmp_ge_u32 s2, 512
    s_cbranch_scc1 L_k1_exit
    s_load_dwordx4 s[16:19], s[0:1], 8
    s_sub_u32 s3, s2, 256
    s_and_b32 s40, s3, 7
    s_sub_u32 s41, 0, s40
    s_and_b32 s41, s41, 7
    s_bitcmp1_b32 s3, 7
    s_cselect_b32 s40, s41, s40
    s_bfe_u32 s41, s3, 0x40003
    v_and_b32 v1, 63, v0
    v_lshrrev_b32 v4, 6, v0
    v_and_b32 v6, 15, v1
    v_readfirstlane_b32 s39, v4
    v_lshrrev_b32 v5, 4, v1
    s_lshr_b32 s22, s3, 7
    s_lshl_b32 s22, s22, 2
    s_and_b32 s38, s39, 3
    s_add_u32 s22, s22, s38
    s_lshr_b32 s38, s39, 2
    s_lshl_b32 s51, s38, 7
    s_lshr_b32 s42, s41, 2
    s_lshl_b32 s42, s42, 6
    s_and_b32 s43, s41, 3
    s_lshl_b32 s43, s43, 2
    s_add_u32 s42, s42, s43
    s_lshl_b32 s42, s42, 3
    s_add_u32 s42, s42, s40
    v_lshl_add_u32 v8, v5, 3, s42
    s_cmp_ge_u32 s22, 4
    s_cselect_b32 s44, -1, 1
    s_cselect_b32 s45, 0x80000000, 0
    s_cselect_b32 s46, 3, 0
    s_lshl_b32 s47, s22, 7
    s_sub_u32 s48, 928, s47
    s_cmp_ge_u32 s22, 4
    s_cselect_b32 s47, s48, s47
    s_cselect_b32 s48, 16, 0
    v_mov_b32 v9, s48
    v_cmp_eq_u32 vcc, 0, v6
    s_nop 1
    v_cndmask_b32 v9, v6, v9, vcc
    v_mul_i32_i24 v9, s44, v9
    v_add_u32 v9, s47, v9
    v_lshlrev_b32 v9, 1, v9
    s_or_b32 s49, s22, s38
    s_cmp_eq_u32 s49, 0
    s_cselect_b32 s49, 1024, 0
    v_mov_b32 v10, s49
    v_cndmask_b32 v10, 0, v10, vcc
    s_mov_b32 s50, 1026
    v_add_u32 v12, 0, v8
    v_mul_i32_i24 v12, s44, v12
    v_and_b32 v12, 2047, v12
    v_mad_u32_u24 v12, v12, s50, v9
    v_add_u32 v16, v12, v10
    v_add_u32 v13, 128, v8
    v_mul_i32_i24 v13, s44, v13
    v_and_b32 v13, 2047, v13
    v_mad_u32_u24 v13, v13, s50, v9
    v_add_u32 v17, v13, v10
    v_add_u32 v14, 256, v8
    v_mul_i32_i24 v14, s44, v14
    v_and_b32 v14, 2047, v14
    v_mad_u32_u24 v14, v14, s50, v9
    v_add_u32 v18, v14, v10
    v_add_u32 v15, 384, v8
    v_mul_i32_i24 v15, s44, v15
    v_and_b32 v15, 2047, v15
    v_mad_u32_u24 v15, v15, s50, v9
    v_add_u32 v19, v15, v10
    s_waitcnt lgkmcnt(0)
    s_add_u32 s8, s16, 0
    s_addc_u32 s9, s17, 0
    s_mov_b32 s10, 2101248
    s_mov_b32 s11, 0x20000
    s_add_u32 s52, s18, 0
    s_addc_u32 s53, s19, 0
    s_mov_b32 s54, 2101248
    s_mov_b32 s55, 0x20000
    s_add_u32 s12, s6, 0
    s_addc_u32 s13, s7, 0
    s_mov_b32 s14, 4194304
    s_mov_b32 s15, 0x20000
    buffer_load_ushort v24, v16, s[8:11], s51 offen offset:0
    buffer_load_ushort v28, v12, s[8:11], s51 offen offset:64
    buffer_load_ushort v40, v16, s[52:55], s51 offen offset:0
    buffer_load_ushort v44, v12, s[52:55], s51 offen offset:64
    buffer_load_ushort v25, v17, s[8:11], s51 offen offset:0
    buffer_load_ushort v29, v13, s[8:11], s51 offen offset:64
    buffer_load_ushort v41, v17, s[52:55], s51 offen offset:0
    buffer_load_ushort v45, v13, s[52:55], s51 offen offset:64
    buffer_load_ushort v26, v18, s[8:11], s51 offen offset:0
    buffer_load_ushort v30, v14, s[8:11], s51 offen offset:64
    buffer_load_ushort v42, v18, s[52:55], s51 offen offset:0
    buffer_load_ushort v46, v14, s[52:55], s51 offen offset:64
    buffer_load_ushort v27, v19, s[8:11], s51 offen offset:0
    buffer_load_ushort v31, v15, s[8:11], s51 offen offset:64
    buffer_load_ushort v43, v19, s[52:55], s51 offen offset:0
    buffer_load_ushort v47, v15, s[52:55], s51 offen offset:64
    s_getpc_b64 s[30:31]
Lpc_cpf:
    s_sub_u32 s30, s30, Lpc_cpf-code_start
    s_subb_u32 s31, s31, 0
    s_lshl_b32 s36, s41, 3
    s_add_u32 s36, s36, s39
    v_lshlrev_b32 v21, 6, v6
    s_lshl_b32 s36, s36, 10
    s_mov_b32 s32, s30
    s_mov_b32 s33, s31
    s_mov_b32 s34, code_end-code_start
    s_mov_b32 s35, 0x20000
    buffer_load_dword v22, v21, s[32:35], s36 offen
    v_lshrrev_b32 v2, 2, v1
    v_and_b32 v3, 3, v1
    v_lshlrev_b32 v20, 12, v2
    v_lshl_add_u32 v20, v3, 4, v20
    s_mul_i32 s37, s39, 2560
    v_mul_u32_u24 v7, 320, v5
    v_lshl_add_u32 v7, v6, 4, v7
    v_add_u32 v7, s37, v7
    v_mul_u32_u24 v11, 320, v3
    v_lshl_add_u32 v11, v2, 4, v11
    v_add_u32 v11, s37, v11
    s_lshr_b32 s56, s40, 1
    s_lshl_b32 s56, s56, 20
    s_and_b32 s57, s40, 1
    s_lshl_b32 s57, s57, 10
    s_add_u32 s56, s56, s57
    s_lshl_b32 s57, s41, 6
    s_add_u32 s56, s56, s57
    s_lshl_b32 s57, s22, 17
    s_add_u32 s56, s56, s57
    s_lshl_b32 s38, s38, 1
    s_xor_b32 s46, s46, s38
    s_xor_b32 s57, s46, 0
    s_lshr_b32 s58, s57, 1
    s_lshl_b32 s58, s58, 16
    s_and_b32 s57, s57, 1
    s_lshl_b32 s57, s57, 11
    s_add_u32 s57, s57, s58
    s_add_u32 s62, s56, s57
    s_xor_b32 s57, s46, 1
    s_lshr_b32 s58, s57, 1
    s_lshl_b32 s58, s58, 16
    s_and_b32 s57, s57, 1
    s_lshl_b32 s57, s57, 11
    s_add_u32 s57, s57, s58
    s_add_u32 s63, s56, s57
    s_waitcnt vmcnt(1)
    v_lshl_or_b32 v24, v40, 16, v24
    v_xor_b32 v24, s45, v24
    v_lshl_or_b32 v25, v41, 16, v25
    v_xor_b32 v25, s45, v25
    v_lshl_or_b32 v26, v42, 16, v26
    v_xor_b32 v26, s45, v26
    v_lshl_or_b32 v27, v43, 16, v27
    v_xor_b32 v27, s45, v27
    ds_write_b128 v7, v[24:27] offset:0
    v_lshl_or_b32 v28, v44, 16, v28
    v_xor_b32 v28, s45, v28
    v_lshl_or_b32 v29, v45, 16, v29
    v_xor_b32 v29, s45, v29
    v_lshl_or_b32 v30, v46, 16, v30
    v_xor_b32 v30, s45, v30
    v_lshl_or_b32 v31, v47, 16, v31
    v_xor_b32 v31, s45, v31
    ds_write_b128 v7, v[28:31] offset:1280
    s_waitcnt lgkmcnt(0)
    ds_read_b128 v[40:43], v11 offset:0
    ds_read_b128 v[44:47], v11 offset:1280
    s_waitcnt lgkmcnt(1)
    buffer_store_dwordx4 v[40:43], v20, s[12:15], s62 offen
    s_waitcnt lgkmcnt(0)
    buffer_store_dwordx4 v[44:47], v20, s[12:15], s63 offen
L_k1_exit:
    s_endpgm
.globl k2a_kernel
.p2align 8
.type k2a_kernel,@function
k2a_kernel:
    s_load_dwordx2 s[6:7], s[0:1], 80
    s_mov_b32 s62, 8388608
    s_mov_b32 s63, 50331648
    s_mov_b32 s64, 0
    s_load_dwordx2 s[54:55], s[0:1], 32
    s_cmp_lt_u32 s2, 256
    s_cbranch_scc1 L_k2_body
    s_endpgm
.globl k2b_kernel
.p2align 8
.type k2b_kernel,@function
k2b_kernel:
    s_load_dwordx2 s[6:7], s[0:1], 80
    s_mov_b32 s62, 58720256
    s_mov_b32 s63, 100663296
    s_mov_b32 s64, 1
    s_load_dwordx2 s[54:55], s[0:1], 32
    s_cmp_lt_u32 s2, 256
    s_cbranch_scc1 L_k2_body
    s_endpgm
.p2align 6
L_k2_body:
    v_and_b32 v1, 63, v0
    v_lshlrev_b32 v2, 4, v1
    v_lshrrev_b32 v3, 6, v0
    v_lshrrev_b32 v4, 4, v1
    v_readfirstlane_b32 s22, v3
    v_and_b32 v5, 15, v1
    s_and_b32 s40, s2, 7
    s_lshr_b32 s41, s2, 3
    s_lshl_b32 s40, s40, 5
    s_add_u32 s40, s40, s41
    s_lshr_b32 s41, s40, 6
    s_and_b32 s42, s40, 63
    v_lshlrev_b32 v90, 4, v4
    v_xor_b32 v90, v90, v2
    s_lshl_b32 s49, s40, 14
    s_lshl_b32 s45, s22, 11
    s_add_u32 s49, s49, s45
    v_lshrrev_b32 v88, 2, v1
    v_and_b32 v89, 6, v88
    v_lshrrev_b32 v6, 3, v88
    v_or_b32 v89, v89, v6
    v_and_b32 v88, 1, v88
    v_lshl_or_b32 v88, v88, 3, v89
    v_and_b32 v89, 3, v1
    v_xor_b32 v89, v89, v4
    v_mul_u32_u24 v6, 4096, v88
    v_lshl_add_u32 v6, v89, 4, v6
    s_mul_i32 s43, s41, 1048576
    s_lshl_b32 s44, s42, 6
    s_add_u32 s43, s43, s44
    s_mul_i32 s44, s22, 131072
    s_add_u32 s43, s43, s44
    s_add_u32 s44, s43, 65536
    s_lshl_b32 s46, s40, 3
    s_add_u32 s46, s46, s22
    s_lshl_b32 s46, s46, 11
    v_lshlrev_b32 v88, 2, v4
    v_mul_u32_u24 v88, v88, v5
    v_cvt_f32_u32 v72, v88
    v_and_b32 v73, 15, v88
    v_mul_f32 v72, 0x3b800000, v72
    v_cvt_f32_u32 v73, v73
    v_cos_f32 v16, v72
    v_mul_f32 v73, 0x3d800000, v73
    v_sin_f32 v20, v72
    v_cos_f32 v74, v73
    v_sin_f32 v75, v73
    v_add_u32 v88, v88, v5
    v_cvt_pk_bf16_f32 v8, v74, v75
    v_cvt_pk_bf16_f32 v12, -v75, v74
    v_cvt_f32_u32 v72, v88
    v_and_b32 v73, 15, v88
    v_mul_f32 v72, 0x3b800000, v72
    v_cvt_f32_u32 v73, v73
    v_cos_f32 v17, v72
    v_mul_f32 v73, 0x3d800000, v73
    v_sin_f32 v21, v72
    v_cos_f32 v74, v73
    v_sin_f32 v75, v73
    v_add_u32 v88, v88, v5
    v_cvt_pk_bf16_f32 v9, v74, v75
    v_cvt_pk_bf16_f32 v13, -v75, v74
    v_cvt_f32_u32 v72, v88
    v_and_b32 v73, 15, v88
    v_mul_f32 v72, 0x3b800000, v72
    v_cvt_f32_u32 v73, v73
    v_cos_f32 v18, v72
    v_mul_f32 v73, 0x3d800000, v73
    v_sin_f32 v22, v72
    v_cos_f32 v74, v73
    v_sin_f32 v75, v73
    v_add_u32 v88, v88, v5
    v_cvt_pk_bf16_f32 v10, v74, v75
    v_cvt_pk_bf16_f32 v14, -v75, v74
    v_cvt_f32_u32 v72, v88
    v_and_b32 v73, 15, v88
    v_mul_f32 v72, 0x3b800000, v72
    v_cvt_f32_u32 v73, v73
    v_cos_f32 v19, v72
    v_mul_f32 v73, 0x3d800000, v73
    v_sin_f32 v23, v72
    v_cos_f32 v74, v73
    v_sin_f32 v75, v73
    s_nop 0
    v_cvt_pk_bf16_f32 v11, v74, v75
    v_cvt_pk_bf16_f32 v15, -v75, v74
    s_waitcnt lgkmcnt(0)
    s_add_u32 s8, s6, s62
    s_addc_u32 s9, s7, 0
    s_mov_b32 s10, 4194304
    s_mov_b32 s11, 0x20000
    s_add_u32 s16, s6, 0
    s_addc_u32 s17, s7, 0
    s_mov_b32 s18, 4194304
    s_mov_b32 s19, 0x20000
    s_mov_b32 m0, s45
    s_nop 0
    buffer_load_dwordx4 v6, s[8:11], s43 offen lds
    s_add_u32 m0, s45, 1024
    s_nop 0
    buffer_load_dwordx4 v6, s[8:11], s44 offen lds
    s_add_u32 s12, s6, s63
    s_addc_u32 s13, s7, 0
    s_mov_b32 s14, 4194304
    s_mov_b32 s15, 0x20000
    s_add_u32 s48, s63, -28311552
    s_add_u32 s68, s6, s48
    s_addc_u32 s69, s7, 0
    s_mov_b32 s70, 131072
    s_mov_b32 s71, 0x20000
    s_lshl_b32 s48, s2, 3
    s_add_u32 s48, s48, s22
    s_lshl_b32 s48, s48, 6
    v_lshlrev_b32 v91, 2, v5
    v_mov_b32 v92, 0
    v_and_b32 v89, 6, v5
    v_lshrrev_b32 v88, 3, v5
    v_or_b32 v89, v89, v88
    v_and_b32 v88, 1, v5
    v_lshl_or_b32 v89, v88, 3, v89
    s_lshr_b32 s47, s22, 1
    v_lshrrev_b32 v88, 2, v89
    v_xor_b32 v88, s47, v88
    v_lshlrev_b32 v7, 12, v4
    v_lshl_add_u32 v7, v89, 6, v7
    v_lshl_add_u32 v7, v88, 4, v7
    s_and_b32 s47, s22, 1
    s_lshl_b32 s47, s47, 3
    v_add_u32 v7, s47, v7
    v_add_u32 v89, s45, v2
    s_waitcnt vmcnt(0)
    buffer_load_dwordx4 v[24:27], v2, s[16:19], s46 offen
    buffer_load_dwordx4 v[28:31], v2, s[16:19], s46 offen offset:1024
    s_barrier
    ds_read_b64 v[48:49], v7 offset:0
    ds_read_b64 v[50:51], v7 offset:2048
    ds_read_b64 v[52:53], v7 offset:1024
    ds_read_b64 v[54:55], v7 offset:3072
    s_waitcnt lgkmcnt(0)
    v_swap_b32 v49, v52
    v_swap_b32 v51, v54
    s_cmp_eq_u32 s64, 0
    s_cselect_b32 s60, 7340032, 0
    s_add_u32 s56, s54, 0
    s_addc_u32 s57, s55, 0
    s_mov_b32 s58, s60
    s_mov_b32 s59, 0x20000
    s_lshl_b32 s61, s2, 3
    s_add_u32 s61, s61, s22
    s_mul_i32 s61, s61, 1792
    s_add_u32 s61, s61, 3670016
    v_min_u32 v93, 27, v1
    v_lshlrev_b32 v93, 6, v93
    buffer_load_dword v0, v93, s[56:59], s61 offen
    s_getpc_b64 s[72:73]
Lpc_cp2:
    s_add_u32 s72, s72, ggb_kernel-Lpc_cp2
    s_addc_u32 s73, s73, 0
    s_mov_b32 s74, code_end-ggb_kernel
    s_mov_b32 s75, 0x20000
    s_bfe_u32 s76, s2, 0x10003
    s_lshl_b32 s76, s76, 3
    s_add_u32 s76, s76, s22
    s_lshl_b32 s76, s76, 12
    v_lshlrev_b32 v94, 6, v1
    buffer_load_dword v94, v94, s[72:75], s76 offen
    v_mfma_f32_16x16x32_bf16 v[56:59], v[48:51], v[8:11], 0
    v_mfma_f32_16x16x32_bf16 v[64:67], v[48:51], v[12:15], 0
    v_mfma_f32_16x16x32_bf16 v[60:63], v[52:55], v[8:11], 0
    v_mfma_f32_16x16x32_bf16 v[68:71], v[52:55], v[12:15], 0
    s_nop 4
    v_mul_f32 v72, v56, v16
    v_mul_f32 v80, v64, v16
    v_mul_f32 v73, v57, v17
    v_mul_f32 v81, v65, v17
    v_mul_f32 v74, v58, v18
    v_mul_f32 v82, v66, v18
    v_mul_f32 v75, v59, v19
    v_mul_f32 v83, v67, v19
    v_fmac_f32 v72, v64, v20
    v_fma_f32 v80, -v56, v20, v80
    v_fmac_f32 v73, v65, v21
    v_fma_f32 v81, -v57, v21, v81
    v_fmac_f32 v74, v66, v22
    v_fma_f32 v82, -v58, v22, v82
    v_fmac_f32 v75, v67, v23
    v_fma_f32 v83, -v59, v23, v83
    v_cvt_pk_bf16_f32 v48, v72, v80
    v_cvt_pk_bf16_f32 v49, v73, v81
    v_cvt_pk_bf16_f32 v50, v74, v82
    v_cvt_pk_bf16_f32 v51, v75, v83
    s_nop 1
    v_mfma_f32_16x16x32_bf16 v[56:59], v[8:11], v[48:51], 0
    v_mfma_f32_16x16x32_bf16 v[64:67], v[12:15], v[48:51], 0
    v_mul_f32 v76, v60, v16
    v_mul_f32 v84, v68, v16
    v_mul_f32 v77, v61, v17
    v_mul_f32 v85, v69, v17
    v_mul_f32 v78, v62, v18
    v_mul_f32 v86, v70, v18
    v_mul_f32 v79, v63, v19
    v_mul_f32 v87, v71, v19
    v_fmac_f32 v76, v68, v20
    v_fma_f32 v84, -v60, v20, v84
    v_fmac_f32 v77, v69, v21
    v_fma_f32 v85, -v61, v21, v85
    v_fmac_f32 v78, v70, v22
    v_fma_f32 v86, -v62, v22, v86
    v_fmac_f32 v79, v71, v23
    v_fma_f32 v87, -v63, v23, v87
    v_cvt_pk_bf16_f32 v52, v76, v84
    v_cvt_pk_bf16_f32 v53, v77, v85
    v_cvt_pk_bf16_f32 v54, v78, v86
    v_cvt_pk_bf16_f32 v55, v79, v87
    s_nop 1
    v_mfma_f32_16x16x32_bf16 v[60:63], v[8:11], v[52:55], 0
    v_mfma_f32_16x16x32_bf16 v[68:71], v[12:15], v[52:55], 0
    s_waitcnt vmcnt(2)
    v_lshlrev_b32 v32, 16, v24
    v_and_b32 v40, 0xffff0000, v24
    v_lshlrev_b32 v33, 16, v25
    v_and_b32 v41, 0xffff0000, v25
    v_lshlrev_b32 v34, 16, v26
    v_and_b32 v42, 0xffff0000, v26
    v_lshlrev_b32 v35, 16, v27
    v_and_b32 v43, 0xffff0000, v27
    v_lshlrev_b32 v36, 16, v28
    v_and_b32 v44, 0xffff0000, v28
    v_lshlrev_b32 v37, 16, v29
    v_and_b32 v45, 0xffff0000, v29
    v_lshlrev_b32 v38, 16, v30
    v_and_b32 v46, 0xffff0000, v30
    v_lshlrev_b32 v39, 16, v31
    v_and_b32 v47, 0xffff0000, v31
    v_mul_f32 v72, v56, v32
    v_mul_f32 v80, v64, v32
    v_mul_f32 v73, v57, v33
    v_mul_f32 v81, v65, v33
    v_mul_f32 v74, v58, v34
    v_mul_f32 v82, v66, v34
    v_mul_f32 v75, v59, v35
    v_mul_f32 v83, v67, v35
    v_fma_f32 v72, -v64, v40, v72
    v_fmac_f32 v80, v56, v40
    v_fma_f32 v73, -v65, v41, v73
    v_fmac_f32 v81, v57, v41
    v_fma_f32 v74, -v66, v42, v74
    v_fmac_f32 v82, v58, v42
    v_fma_f32 v75, -v67, v43, v75
    v_fmac_f32 v83, v59, v43
    v_cvt_pk_bf16_f32 v48, v80, v72
    v_cvt_pk_bf16_f32 v49, v81, v73
    v_cvt_pk_bf16_f32 v50, v82, v74
    v_cvt_pk_bf16_f32 v51, v83, v75
    v_mul_f32 v76, v60, v36
    v_mul_f32 v84, v68, v36
    v_mul_f32 v77, v61, v37
    v_mul_f32 v85, v69, v37
    v_mul_f32 v78, v62, v38
    v_mul_f32 v86, v70, v38
    v_mul_f32 v79, v63, v39
    v_mul_f32 v87, v71, v39
    v_fma_f32 v76, -v68, v44, v76
    v_fmac_f32 v84, v60, v44
    v_fma_f32 v77, -v69, v45, v77
    v_fmac_f32 v85, v61, v45
    v_fma_f32 v78, -v70, v46, v78
    v_fmac_f32 v86, v62, v46
    v_fma_f32 v79, -v71, v47, v79
    v_fmac_f32 v87, v63, v47
    v_cvt_pk_bf16_f32 v52, v84, v76
    v_cvt_pk_bf16_f32 v53, v85, v77
    v_cvt_pk_bf16_f32 v54, v86, v78
    v_cvt_pk_bf16_f32 v55, v87, v79
    v_mfma_f32_16x16x32_bf16 v[56:59], v[48:51], v[8:11], 0
    v_mfma_f32_16x16x32_bf16 v[64:67], v[48:51], v[12:15], 0
    v_mfma_f32_16x16x32_bf16 v[60:63], v[52:55], v[8:11], 0
    v_mfma_f32_16x16x32_bf16 v[68:71], v[52:55], v[12:15], 0
    s_nop 4
    v_mul_f32 v72, v56, v16
    v_mul_f32 v80, v64, v16
    v_mul_f32 v73, v57, v17
    v_mul_f32 v81, v65, v17
    v_mul_f32 v74, v58, v18
    v_mul_f32 v82, v66, v18
    v_mul_f32 v75, v59, v19
    v_mul_f32 v83, v67, v19
    v_fmac_f32 v72, v64, v20
    v_fma_f32 v80, -v56, v20, v80
    v_fmac_f32 v73, v65, v21
    v_fma_f32 v81, -v57, v21, v81
    v_fmac_f32 v74, v66, v22
    v_fma_f32 v82, -v58, v22, v82
    v_fmac_f32 v75, v67, v23
    v_fma_f32 v83, -v59, v23, v83
    v_cvt_pk_bf16_f32 v48, v72, v80
    v_cvt_pk_bf16_f32 v49, v73, v81
    v_cvt_pk_bf16_f32 v50, v74, v82
    v_cvt_pk_bf16_f32 v51, v75, v83
    s_nop 1
    v_mfma_f32_16x16x32_bf16 v[56:59], v[8:11], v[48:51], 0
    v_mfma_f32_16x16x32_bf16 v[64:67], v[12:15], v[48:51], 0
    v_mul_f32 v76, v60, v16
    v_mul_f32 v84, v68, v16
    v_mul_f32 v77, v61, v17
    v_mul_f32 v85, v69, v17
    v_mul_f32 v78, v62, v18
    v_mul_f32 v86, v70, v18
    v_mul_f32 v79, v63, v19
    v_mul_f32 v87, v71, v19
    v_fmac_f32 v76, v68, v20
    v_fma_f32 v84, -v60, v20, v84
    v_fmac_f32 v77, v69, v21
    v_fma_f32 v85, -v61, v21, v85
    v_fmac_f32 v78, v70, v22
    v_fma_f32 v86, -v62, v22, v86
    v_fmac_f32 v79, v71, v23
    v_fma_f32 v87, -v63, v23, v87
    v_cvt_pk_bf16_f32 v52, v76, v84
    v_cvt_pk_bf16_f32 v53, v77, v85
    v_cvt_pk_bf16_f32 v54, v78, v86
    v_cvt_pk_bf16_f32 v55, v79, v87
    s_nop 1
    v_mfma_f32_16x16x32_bf16 v[60:63], v[8:11], v[52:55], 0
    v_mfma_f32_16x16x32_bf16 v[68:71], v[12:15], v[52:55], 0
    v_cvt_pk_bf16_f32 v48, v64, v56
    s_nop 6
    v_cvt_pk_bf16_f32 v49, v68, v60
    ds_write_b64 v7, v[48:49] offset:0
    v_cvt_pk_bf16_f32 v50, v65, v57
    v_cvt_pk_bf16_f32 v51, v69, v61
    ds_write_b64 v7, v[50:51] offset:1024
    v_cvt_pk_bf16_f32 v52, v66, v58
    v_cvt_pk_bf16_f32 v53, v70, v62
    ds_write_b64 v7, v[52:53] offset:2048
    v_cvt_pk_bf16_f32 v54, v67, v59
    v_cvt_pk_bf16_f32 v55, v71, v63
    ds_write_b64 v7, v[54:55] offset:3072
    s_waitcnt lgkmcnt(0)
    s_barrier
    ds_read_b128 v[72:75], v89
    ds_read_b128 v[76:79], v89 offset:1024
    s_cmp_eq_u32 s64, 0
    s_cbranch_scc1 L_k2_tail_a
    buffer_store_dword v92, v91, s[68:71], s48 offen sc1
    s_waitcnt lgkmcnt(1)
    buffer_store_dwordx4 v[72:75], v6, s[12:15], s43 offen sc1
    s_waitcnt lgkmcnt(0)
    buffer_store_dwordx4 v[76:79], v6, s[12:15], s44 offen sc1
    s_endpgm
L_k2_tail_a:
    buffer_store_dword v92, v91, s[68:71], s48 offen
    s_waitcnt lgkmcnt(1)
    buffer_store_dwordx4 v[72:75], v6, s[12:15], s43 offen
    s_waitcnt lgkmcnt(0)
    buffer_store_dwordx4 v[76:79], v6, s[12:15], s44 offen
    s_endpgm
.globl ggb_kernel
.p2align 8
.type ggb_kernel,@function
ggb_kernel:
    s_load_dwordx8 s[64:71], s[0:1], 32
    s_load_dwordx2 s[6:7], s[0:1], 80
    s_load_dwordx2 s[4:5], s[0:1], 64
    s_mov_b32 s20, 0
    s_mov_b32 s21, 58720256
    s_load_dwordx2 s[92:93], s[0:1], 80
    s_mov_b32 s94, 29360128
    s_mov_b32 s23, 0
    s_cmp_lt_u32 s2, 256
    s_cbranch_scc1 L_gg_body
    s_endpgm
.globl gga_kernel
.p2align 8
.type gga_kernel,@function
gga_kernel:
    s_load_dwordx8 s[64:71], s[0:1], 32
    s_load_dwordx2 s[6:7], s[0:1], 80
    s_load_dwordx2 s[4:5], s[0:1], 80
    s_mov_b32 s20, 29360128
    s_mov_b32 s21, 8388608
    s_load_dwordx2 s[92:93], s[0:1], 0
    s_mov_b32 s94, 0
    s_mov_b32 s23, 4
    s_cmp_lt_u32 s2, 256
    s_cbranch_scc0 L_gg_exit
L_gg_body:
    v_and_b32 v1, 63, v0
    v_lshlrev_b32 v2, 4, v1
    v_lshrrev_b32 v12, 6, v0
    v_lshrrev_b32 v3, 4, v1
    v_readfirstlane_b32 s22, v12
    v_and_b32 v4, 15, v1
    v_lshlrev_b32 v13, 1, v3
    v_and_b32 v12, 1, v12
    v_lshl_add_u32 v12, v12, 3, v13
    v_xor_b32 v12, v12, v4
    v_mov_b32 v10, v2
    v_and_b32 v9, 7, v1
    v_lshlrev_b32 v9, 8, v9
    v_add_u32 v9, 32768, v9
    v_mul_u32_u24 v14, 7168, v3
    v_lshl_add_u32 v7, v12, 4, v14
    v_add_u32 v8, 27648, v7
    v_and_b32 v12, 1, v3
    v_lshrrev_b32 v13, 1, v3
    v_lshlrev_b32 v5, 4, v12
    v_lshl_add_u32 v5, v13, 3, v5
    s_and_b32 s48, s2, 1
    s_lshl_b32 s48, s48, 2
    s_bfe_u32 s49, s2, 0x20003
    s_add_u32 s48, s48, s49
    s_lshl_b32 s48, s48, 2
    s_add_u32 s48, s48, s22
    s_bfe_u32 s49, s2, 0x20001
    s_mul_i32 s49, s49, 7
    s_lshr_b32 s50, s2, 5
    s_add_u32 s49, s49, s50
    s_lshl_b32 s55, s48, 17
    s_add_u32 s55, s55, s21
    s_add_u32 s55, s55, 8388608
    s_mul_i32 s54, s22, 57344
    s_lshl_b32 s52, s49, 8
    s_add_u32 s54, s54, s52
    s_lshl_b32 s46, s22, 11
    s_add_u32 s47, s46, 65536
    s_lshl_b32 s57, s48, 9
    s_add_u32 s57, s57, s21
    s_add_u32 s57, s57, 13680640
    v_lshlrev_b32 v11, 3, v4
    v_lshlrev_b32 v36, 2, v1
    v_lshlrev_b32 v37, 3, v1
    s_mul_i32 s3, s22, 4352
    s_add_u32 s3, s3, 131072
    v_add_u32 v38, s3, v36
    v_lshl_add_u32 v39, v4, 2, s3
    v_add_u32 v40, s3, v5
    v_add_u32 v224, 32768, v2
    v_add_u32 v225, 65536, v2
    v_add_u32 v226, 98304, v2
    s_mov_b32 s10, 268435456
    s_mov_b32 s11, 0x20000
    s_mov_b32 s14, 7340032
    s_mov_b32 s15, 0x20000
    s_mov_b32 s18, 7168
    s_mov_b32 s19, 0x20000
    s_mov_b32 s26, 2048
    s_mov_b32 s27, 0x20000
    s_and_b32 s3, s2, 3
    s_lshl_b32 s76, s3, 6
    s_lshr_b32 s3, s2, 4
    s_lshl_b32 s3, s3, 2
    s_or_b32 s76, s76, s3
    s_bfe_u32 s3, s2, 0x10002
    s_lshl_b32 s3, s3, 1
    s_or_b32 s76, s76, s3
    s_bfe_u32 s3, s2, 0x10003
    s_or_b32 s76, s76, s3
    v_lshlrev_b32 v72, 20, v3
    v_lshl_add_u32 v72, v4, 4, v72
    s_lshl_b32 s77, s76, 12
    s_lshl_b32 s3, s22, 9
    s_add_u32 s77, s77, s3
    s_add_u32 s77, s77, s21
    s_add_u32 s77, s77, 41943040
    s_lshl_b32 s78, s22, 8
    s_add_u32 s78, s78, s76
    s_lshl_b32 s78, s78, 11
    s_add_u32 s79, s78, 2097152
    s_mov_b32 s30, 4194304
    s_mov_b32 s31, 0x20000
    s_getpc_b64 s[32:33]
Lpc_fk:
    s_add_u32 s32, s32, tbl_k3-Lpc_fk
    s_addc_u32 s33, s33, 0
    global_load_dwordx4 v[32:35], v2, s[32:33] offset:0
    global_load_dwordx4 v[40:43], v2, s[32:33] offset:1024
    global_load_dwordx4 v[48:51], v2, s[32:33] offset:2048
    global_load_dwordx4 v[52:55], v2, s[32:33] offset:3072
    v_lshlrev_b32 v230, 2, v1
    s_waitcnt lgkmcnt(0)
    s_mov_b64 s[12:13], s[64:65]
    s_mov_b64 s[8:9], s[6:7]
    s_mov_b64 s[16:17], s[66:67]
    s_mov_b64 s[24:25], s[70:71]
    s_add_u32 s28, s92, s94
    s_addc_u32 s29, s93, 0
    s_add_u32 m0, s47, 16384
    s_nop 0
    buffer_load_dwordx4 v2, s[28:31], s78 offen lds
    buffer_load_dwordx4 v2, s[28:31], s78 offen offset:1024 lds
    s_add_u32 m0, s47, 24576
    s_nop 0
    buffer_load_dwordx4 v2, s[28:31], s79 offen lds
    buffer_load_dwordx4 v2, s[28:31], s79 offen offset:1024 lds
    buffer_load_dwordx4 v[80:83], v72, s[8:11], s77 offen offset:0
    buffer_load_dwordx4 v[84:87], v72, s[8:11], s77 offen offset:256
    buffer_load_dwordx4 v[152:155], v72, s[8:11], s77 offen offset:2048
    buffer_load_dwordx4 v[156:159], v72, s[8:11], s77 offen offset:2304
    buffer_load_dword a164, v230, s[16:19], s52 offen
    s_mov_b32 s72, 0x00010001
    s_mov_b32 s73, 0x00010001
    s_mov_b32 s74, 0xffff
    s_mov_b32 s75, 0
    s_mov_b32 s91, 0x3f803f80
    v_lshrrev_b32 v14, 1, v4
    v_lshlrev_b32 v14, 8, v14
    v_add_u32 v14, s76, v14
    v_and_b32 v15, 1, v4
    v_mul_u32_u24 v15, 1536, v15
    v_lshlrev_b32 v77, 1, v3
    v_mad_u32_u24 v15, v77, v14, v15
    v_add_u32 v14, v15, v14
    v_and_b32 v15, 2047, v15
    v_and_b32 v14, 2047, v14
    v_cvt_f32_u32 v15, v15
    v_cvt_f32_u32 v14, v14
    v_mul_f32 v15, 0x3a000000, v15
    v_mul_f32 v14, 0x3a000000, v14
    v_cos_f32 v216, v15
    v_sin_f32 v217, v15
    v_cos_f32 v218, v14
    v_sin_f32 v219, v14
    v_mul_f32 v216, 0x35800000, v216
    v_mul_f32 v217, 0xb5800000, v217
    v_mul_f32 v218, 0x35800000, v218
    v_mul_f32 v219, 0xb5800000, v219
    v_cvt_pk_bf16_f32 v78, v216, v217
    v_cvt_pk_bf16_f32 v79, v218, v219
    s_lshl_b32 s80, s22, 8
    s_add_u32 s80, s80, 65536
    v_lshlrev_b32 v73, 12, v3
    v_lshl_add_u32 v73, v4, 4, v73
    v_add_u32 v73, s80, v73
    v_add_u32 v74, s47, v2
    v_lshlrev_b32 v75, 6, v4
    v_lshl_add_u32 v75, v3, 4, v75
    v_add_u32 v75, s47, v75
    v_mov_b32 v77, 0x8000
    v_cmp_eq_u32 vcc, 0, v1
    s_nop 1
    v_cndmask_b32 v77, 0, v77, vcc
    s_waitcnt vmcnt(5)
    ds_read_b128 v[88:91], v75 offset:16384
    ds_read_b128 v[92:95], v75 offset:17408
    ds_read_b128 v[160:163], v75 offset:24576
    ds_read_b128 v[164:167], v75 offset:25600
    s_add_u32 m0, s46, 0
    s_nop 0
    buffer_load_dwordx4 v7, s[12:15], s54 offen lds
    buffer_load_dwordx4 v8, s[12:15], s54 offen offset:1024 lds
    s_add_u32 s54, s54, 229376
    s_add_u32 m0, s46, 8192
    s_nop 0
    buffer_load_dwordx4 v7, s[12:15], s54 offen lds
    buffer_load_dwordx4 v8, s[12:15], s54 offen offset:1024 lds
    s_add_u32 s54, s54, 229376
    s_waitcnt lgkmcnt(0)
    v_dot2_f32_bf16 v136, v88, s91, 0
    v_dot2_f32_bf16 v208, v160, s91, 0
    v_dot2_f32_bf16 v137, v92, s91, 0
    v_dot2_f32_bf16 v209, v164, s91, 0
    v_dot2_f32_bf16 v136, v89, s91, v136
    v_dot2_f32_bf16 v208, v161, s91, v208
    v_dot2_f32_bf16 v137, v93, s91, v137
    v_dot2_f32_bf16 v209, v165, s91, v209
    v_dot2_f32_bf16 v136, v90, s91, v136
    v_dot2_f32_bf16 v208, v162, s91, v208
    v_dot2_f32_bf16 v137, v94, s91, v137
    v_dot2_f32_bf16 v209, v166, s91, v209
    v_dot2_f32_bf16 v136, v91, s91, v136
    v_dot2_f32_bf16 v208, v163, s91, v208
    v_dot2_f32_bf16 v137, v95, s91, v137
    v_dot2_f32_bf16 v209, v167, s91, v209
    v_and_b32 v111, 0xffff0000, v95
    v_and_b32 v183, 0xffff0000, v167
    v_lshlrev_b32 v103, 16, v95
    v_lshlrev_b32 v175, 16, v167
    v_and_b32 v110, 0xffff0000, v94
    v_and_b32 v182, 0xffff0000, v166
    v_lshlrev_b32 v102, 16, v94
    v_lshlrev_b32 v174, 16, v166
    v_and_b32 v109, 0xffff0000, v93
    v_and_b32 v181, 0xffff0000, v165
    v_lshlrev_b32 v101, 16, v93
    v_lshlrev_b32 v173, 16, v165
    v_and_b32 v108, 0xffff0000, v92
    v_and_b32 v180, 0xffff0000, v164
    v_lshlrev_b32 v100, 16, v92
    v_lshlrev_b32 v172, 16, v164
    v_and_b32 v107, 0xffff0000, v91
    v_and_b32 v179, 0xffff0000, v163
    v_lshlrev_b32 v99, 16, v91
    v_lshlrev_b32 v171, 16, v163
    v_add_f32 v136, v136, v137
    v_add_f32 v208, v208, v209
    v_and_b32 v106, 0xffff0000, v90
    v_and_b32 v178, 0xffff0000, v162
    v_add_f32_dpp v136, v136, v136 quad_perm:[1,0,3,2] row_mask:0xf bank_mask:0xf
    v_add_f32_dpp v208, v208, v208 quad_perm:[1,0,3,2] row_mask:0xf bank_mask:0xf
    v_lshlrev_b32 v98, 16, v90
    v_lshlrev_b32 v170, 16, v162
    v_add_f32_dpp v136, v136, v136 quad_perm:[2,3,0,1] row_mask:0xf bank_mask:0xf
    v_add_f32_dpp v208, v208, v208 quad_perm:[2,3,0,1] row_mask:0xf bank_mask:0xf
    v_and_b32 v105, 0xffff0000, v89
    v_and_b32 v177, 0xffff0000, v161
    v_add_f32_dpp v136, v136, v136 row_half_mirror row_mask:0xf bank_mask:0xf
    v_add_f32_dpp v208, v208, v208 row_half_mirror row_mask:0xf bank_mask:0xf
    v_lshlrev_b32 v97, 16, v89
    v_lshlrev_b32 v169, 16, v161
    v_add_f32_dpp v136, v136, v136 row_mirror row_mask:0xf bank_mask:0xf
    v_add_f32_dpp v208, v208, v208 row_mirror row_mask:0xf bank_mask:0xf
    v_and_b32 v104, 0xffff0000, v88
    v_and_b32 v176, 0xffff0000, v160
    v_add_f32_dpp v136, v136, v136 row_bcast:15 row_mask:0xa bank_mask:0xf
    v_add_f32_dpp v208, v208, v208 row_bcast:15 row_mask:0xa bank_mask:0xf
    v_lshlrev_b32 v96, 16, v88
    v_lshlrev_b32 v168, 16, v160
    v_add_f32_dpp v136, v136, v136 row_bcast:31 row_mask:0xc bank_mask:0xf
    v_add_f32_dpp v208, v208, v208 row_bcast:31 row_mask:0xc bank_mask:0xf
    v_mov_b32 v233, 0x3a800000
    v_mov_b32 v235, 0x3a800000
    v_readlane_b32 s89, v136, 63
    v_readlane_b32 s90, v208, 63
    s_nop 0
    s_nop 0
    v_mul_f32 v233, s89, v233
    v_mul_f32 v235, s90, v235
    v_pk_add_f32 v[96:97], v[96:97], v[232:233] op_sel:[0,1] op_sel_hi:[1,1] neg_lo:[0,1] neg_hi:[0,1]
    v_pk_add_f32 v[168:169], v[168:169], v[234:235] op_sel:[0,1] op_sel_hi:[1,1] neg_lo:[0,1] neg_hi:[0,1]
    v_pk_add_f32 v[98:99], v[98:99], v[232:233] op_sel:[0,1] op_sel_hi:[1,1] neg_lo:[0,1] neg_hi:[0,1]
    v_pk_add_f32 v[170:171], v[170:171], v[234:235] op_sel:[0,1] op_sel_hi:[1,1] neg_lo:[0,1] neg_hi:[0,1]
    v_pk_add_f32 v[100:101], v[100:101], v[232:233] op_sel:[0,1] op_sel_hi:[1,1] neg_lo:[0,1] neg_hi:[0,1]
    v_pk_add_f32 v[172:173], v[172:173], v[234:235] op_sel:[0,1] op_sel_hi:[1,1] neg_lo:[0,1] neg_hi:[0,1]
    v_pk_add_f32 v[102:103], v[102:103], v[232:233] op_sel:[0,1] op_sel_hi:[1,1] neg_lo:[0,1] neg_hi:[0,1]
    v_pk_add_f32 v[174:175], v[174:175], v[234:235] op_sel:[0,1] op_sel_hi:[1,1] neg_lo:[0,1] neg_hi:[0,1]
    v_pk_add_f32 v[104:105], v[104:105], v[232:233] op_sel:[0,1] op_sel_hi:[1,1] neg_lo:[0,1] neg_hi:[0,1]
    v_pk_add_f32 v[176:177], v[176:177], v[234:235] op_sel:[0,1] op_sel_hi:[1,1] neg_lo:[0,1] neg_hi:[0,1]
    v_pk_add_f32 v[106:107], v[106:107], v[232:233] op_sel:[0,1] op_sel_hi:[1,1] neg_lo:[0,1] neg_hi:[0,1]
    v_pk_add_f32 v[178:179], v[178:179], v[234:235] op_sel:[0,1] op_sel_hi:[1,1] neg_lo:[0,1] neg_hi:[0,1]
    v_pk_add_f32 v[108:109], v[108:109], v[232:233] op_sel:[0,1] op_sel_hi:[1,1] neg_lo:[0,1] neg_hi:[0,1]
    v_pk_add_f32 v[180:181], v[180:181], v[234:235] op_sel:[0,1] op_sel_hi:[1,1] neg_lo:[0,1] neg_hi:[0,1]
    v_pk_add_f32 v[110:111], v[110:111], v[232:233] op_sel:[0,1] op_sel_hi:[1,1] neg_lo:[0,1] neg_hi:[0,1]
    v_pk_add_f32 v[182:183], v[182:183], v[234:235] op_sel:[0,1] op_sel_hi:[1,1] neg_lo:[0,1] neg_hi:[0,1]
    s_waitcnt vmcnt(7)
    v_mfma_f32_16x16x16_bf16 v[112:115], v[78:79], v[80:81], 0
    v_mfma_f32_16x16x16_bf16 v[116:119], v[78:79], v[82:83], 0
    v_mfma_f32_16x16x16_bf16 v[120:123], v[78:79], v[84:85], 0
    v_mfma_f32_16x16x16_bf16 v[124:127], v[78:79], v[86:87], 0
    s_waitcnt vmcnt(5)
    v_mfma_f32_16x16x16_bf16 v[184:187], v[78:79], v[152:153], 0
    v_mfma_f32_16x16x16_bf16 v[188:191], v[78:79], v[154:155], 0
    v_mfma_f32_16x16x16_bf16 v[192:195], v[78:79], v[156:157], 0
    v_mfma_f32_16x16x16_bf16 v[196:199], v[78:79], v[158:159], 0
    v_cvt_pk_bf16_f32 v128, v112, v113
    v_cvt_pk_bf16_f32 v129, v116, v117
    v_cvt_pk_bf16_f32 v130, v120, v121
    v_cvt_pk_bf16_f32 v131, v124, v125
    ds_write_b128 v73, v[128:131] offset:0
    v_cvt_pk_bf16_f32 v132, v114, v115
    v_cvt_pk_bf16_f32 v133, v118, v119
    v_cvt_pk_bf16_f32 v134, v122, v123
    v_cvt_pk_bf16_f32 v135, v126, v127
    ds_write_b128 v73, v[132:135] offset:2048
    v_cvt_pk_bf16_f32 v200, v184, v185
    v_cvt_pk_bf16_f32 v201, v188, v189
    v_cvt_pk_bf16_f32 v202, v192, v193
    v_cvt_pk_bf16_f32 v203, v196, v197
    ds_write_b128 v73, v[200:203] offset:1024
    v_cvt_pk_bf16_f32 v204, v186, v187
    v_cvt_pk_bf16_f32 v205, v190, v191
    v_cvt_pk_bf16_f32 v206, v194, v195
    v_cvt_pk_bf16_f32 v207, v198, v199
    ds_write_b128 v73, v[204:207] offset:3072
    v_alignbit_b32 v36, v32, v32, 16
    v_xor_b32 v36, 0x8000, v36
    v_alignbit_b32 v37, v33, v33, 16
    v_xor_b32 v37, 0x8000, v37
    s_add_u32 m0, s46, 16384
    s_nop 0
    buffer_load_dwordx4 v7, s[12:15], s54 offen lds
    buffer_load_dwordx4 v8, s[12:15], s54 offen offset:1024 lds
    s_add_u32 s54, s54, 229376
    v_alignbit_b32 v38, v34, v34, 16
    v_xor_b32 v38, 0x8000, v38
    v_alignbit_b32 v39, v35, v35, 16
    v_xor_b32 v39, 0x8000, v39
    s_add_u32 m0, s46, 24576
    s_nop 0
    buffer_load_dwordx4 v7, s[12:15], s54 offen lds
    buffer_load_dwordx4 v8, s[12:15], s54 offen offset:1024 lds
    s_add_u32 s54, s54, 229376
    v_alignbit_b32 v44, v40, v40, 16
    v_xor_b32 v44, 0x8000, v44
    v_alignbit_b32 v45, v41, v41, 16
    v_xor_b32 v45, 0x8000, v45
    s_add_u32 m0, s46, 32768
    s_nop 0
    buffer_load_dwordx4 v7, s[12:15], s54 offen lds
    buffer_load_dwordx4 v8, s[12:15], s54 offen offset:1024 lds
    s_add_u32 s54, s54, 229376
    v_alignbit_b32 v46, v42, v42, 16
    v_xor_b32 v46, 0x8000, v46
    v_alignbit_b32 v47, v43, v43, 16
    v_xor_b32 v47, 0x8000, v47
    s_add_u32 m0, s46, 40960
    s_nop 0
    buffer_load_dwordx4 v7, s[12:15], s54 offen lds
    buffer_load_dwordx4 v8, s[12:15], s54 offen offset:1024 lds
    s_add_u32 s54, s54, 229376
    s_waitcnt lgkmcnt(0)
    s_barrier
    ds_read_b128 v[132:135], v74 offset:1024
    ds_read_b128 v[128:131], v74 offset:0
    ds_read_b128 v[204:207], v74 offset:9216
    ds_read_b128 v[200:203], v74 offset:8192
    v_cvt_f32_u32 v12, v4
    v_cvt_f32_u32 v14, v3
    v_mul_f32 v12, 0x3b000000, v12
    v_mul_f32 v14, 4.0, v14
    v_add_f32 v15, 0x3a800000, v12
    v_mov_b32 v78, 0x41800000
    v_cndmask_b32 v78, v14, v78, s[74:75]
    v_mul_f32 v230, v78, v12
    v_mul_f32 v231, v78, v15
    s_waitcnt lgkmcnt(2)
    v_mfma_f32_16x16x32_bf16 v[112:115], v[132:135], v[32:35], 0
    v_cos_f32 v56, v230
    v_cndmask_b32 v136, v128, 0, s[72:73]
    v_cndmask_b32 v137, v129, 0, s[72:73]
    v_cndmask_b32 v138, v130, 0, s[72:73]
    v_cndmask_b32 v139, v131, 0, s[72:73]
    v_mfma_f32_16x16x32_bf16 v[116:119], v[132:135], v[36:39], 0
    v_sin_f32 v64, v230
    v_xor_b32 v140, 0x80008000, v132
    v_xor_b32 v141, 0x80008000, v133
    v_xor_b32 v142, 0x80008000, v134
    v_xor_b32 v143, 0x80008000, v135
    v_mfma_f32_16x16x32_bf16 v[144:147], v[128:131], v[32:35], 0
    v_cos_f32 v60, v231
    v_mfma_f32_16x16x32_bf16 v[112:115], v[136:139], v[32:35], v[112:115]
    v_sin_f32 v68, v231
    v_xor_b32 v128, v128, v77
    v_mfma_f32_16x16x32_bf16 v[116:119], v[136:139], v[36:39], v[116:119]
    v_add_f32 v78, 1.0, v14
    v_mfma_f32_16x16x32_bf16 v[120:123], v[140:143], v[40:43], 0
    v_mul_f32 v230, v78, v12
    v_mfma_f32_16x16x32_bf16 v[124:127], v[140:143], v[44:47], 0
    v_mul_f32 v231, v78, v15
    v_mfma_f32_16x16x32_bf16 v[120:123], v[136:139], v[40:43], v[120:123]
    v_cos_f32 v57, v230
    v_mfma_f32_16x16x32_bf16 v[124:127], v[136:139], v[44:47], v[124:127]
    v_sin_f32 v65, v230
    v_mfma_f32_16x16x32_bf16 v[148:151], v[128:131], v[40:43], 0
    v_cos_f32 v61, v231
    s_waitcnt lgkmcnt(0)
    v_mfma_f32_16x16x32_bf16 v[184:187], v[204:207], v[32:35], 0
    v_sin_f32 v69, v231
    v_cndmask_b32 v208, v200, 0, s[72:73]
    v_cndmask_b32 v209, v201, 0, s[72:73]
    v_cndmask_b32 v210, v202, 0, s[72:73]
    v_cndmask_b32 v211, v203, 0, s[72:73]
    v_mfma_f32_16x16x32_bf16 v[188:191], v[204:207], v[36:39], 0
    v_add_f32 v78, 2.0, v14
    v_xor_b32 v212, 0x80008000, v204
    v_xor_b32 v213, 0x80008000, v205
    v_xor_b32 v214, 0x80008000, v206
    v_xor_b32 v215, 0x80008000, v207
    v_mfma_f32_16x16x32_bf16 v[216:219], v[200:203], v[32:35], 0
    v_mul_f32 v230, v78, v12
    v_mfma_f32_16x16x32_bf16 v[184:187], v[208:211], v[32:35], v[184:187]
    v_mul_f32 v231, v78, v15
    v_xor_b32 v200, v200, v77
    v_mfma_f32_16x16x32_bf16 v[188:191], v[208:211], v[36:39], v[188:191]
    v_cos_f32 v58, v230
    v_mfma_f32_16x16x32_bf16 v[192:195], v[212:215], v[40:43], 0
    v_sin_f32 v66, v230
    v_mfma_f32_16x16x32_bf16 v[196:199], v[212:215], v[44:47], 0
    v_cos_f32 v62, v231
    v_mfma_f32_16x16x32_bf16 v[192:195], v[208:211], v[40:43], v[192:195]
    v_sin_f32 v70, v231
    v_mfma_f32_16x16x32_bf16 v[196:199], v[208:211], v[44:47], v[196:199]
    v_add_f32 v78, 0x40400000, v14
    v_mfma_f32_16x16x32_bf16 v[220:223], v[200:203], v[40:43], 0
    v_mul_f32 v230, v78, v12
    v_mul_f32 v231, v78, v15
    v_cos_f32 v59, v230
    v_sin_f32 v67, v230
    v_cos_f32 v63, v231
    v_sin_f32 v71, v231
    v_pk_mul_f32 v[80:81], v[112:113], v[56:57]
    v_pk_mul_f32 v[84:85], v[116:117], v[56:57]
    v_pk_mul_f32 v[82:83], v[114:115], v[58:59]
    v_pk_mul_f32 v[86:87], v[118:119], v[58:59]
    v_pk_fma_f32 v[80:81], v[116:117], v[64:65], v[80:81] neg_lo:[0,1,0] neg_hi:[0,1,0]
    v_pk_fma_f32 v[84:85], v[112:113], v[64:65], v[84:85]
    v_pk_fma_f32 v[82:83], v[118:119], v[66:67], v[82:83] neg_lo:[0,1,0] neg_hi:[0,1,0]
    v_pk_fma_f32 v[86:87], v[114:115], v[66:67], v[86:87]
    v_cndmask_b32 v84, v84, v144, s[74:75]
    v_cvt_pk_bf16_f32 v88, v80, v84
    v_cvt_pk_bf16_f32 v89, v81, v85
    v_cvt_pk_bf16_f32 v90, v82, v86
    v_cvt_pk_bf16_f32 v91, v83, v87
    v_pk_mul_f32 v[152:153], v[184:185], v[56:57]
    v_pk_mul_f32 v[156:157], v[188:189], v[56:57]
    v_pk_mul_f32 v[154:155], v[186:187], v[58:59]
    v_pk_mul_f32 v[158:159], v[190:191], v[58:59]
    v_pk_fma_f32 v[152:153], v[188:189], v[64:65], v[152:153] neg_lo:[0,1,0] neg_hi:[0,1,0]
    v_pk_fma_f32 v[156:157], v[184:185], v[64:65], v[156:157]
    v_pk_fma_f32 v[154:155], v[190:191], v[66:67], v[154:155] neg_lo:[0,1,0] neg_hi:[0,1,0]
    v_pk_fma_f32 v[158:159], v[186:187], v[66:67], v[158:159]
    v_cndmask_b32 v156, v156, v216, s[74:75]
    v_cvt_pk_bf16_f32 v160, v152, v156
    v_cvt_pk_bf16_f32 v161, v153, v157
    v_cvt_pk_bf16_f32 v162, v154, v158
    v_cvt_pk_bf16_f32 v163, v155, v159
    v_mfma_f32_16x16x32_bf16 v[96:99], v[88:91], v[48:51], v[96:99]
    v_mfma_f32_16x16x32_bf16 v[100:103], v[88:91], v[52:55], v[100:103]
    v_mfma_f32_16x16x32_bf16 v[168:171], v[160:163], v[48:51], v[168:171]
    v_mfma_f32_16x16x32_bf16 v[172:175], v[160:163], v[52:55], v[172:175]
    v_pk_mul_f32 v[80:81], v[120:121], v[60:61]
    v_pk_mul_f32 v[84:85], v[124:125], v[60:61]
    v_pk_mul_f32 v[82:83], v[122:123], v[62:63]
    v_pk_mul_f32 v[86:87], v[126:127], v[62:63]
    v_pk_fma_f32 v[80:81], v[124:125], v[68:69], v[80:81] neg_lo:[0,1,0] neg_hi:[0,1,0]
    v_pk_fma_f32 v[84:85], v[120:121], v[68:69], v[84:85]
    v_pk_fma_f32 v[82:83], v[126:127], v[70:71], v[82:83] neg_lo:[0,1,0] neg_hi:[0,1,0]
    v_pk_fma_f32 v[86:87], v[122:123], v[70:71], v[86:87]
    v_cndmask_b32 v84, v84, v148, s[74:75]
    v_cvt_pk_bf16_f32 v92, v80, v84
    v_cvt_pk_bf16_f32 v93, v81, v85
    v_cvt_pk_bf16_f32 v94, v82, v86
    v_cvt_pk_bf16_f32 v95, v83, v87
    v_pk_mul_f32 v[152:153], v[192:193], v[60:61]
    v_pk_mul_f32 v[156:157], v[196:197], v[60:61]
    v_pk_mul_f32 v[154:155], v[194:195], v[62:63]
    v_pk_mul_f32 v[158:159], v[198:199], v[62:63]
    v_pk_fma_f32 v[152:153], v[196:197], v[68:69], v[152:153] neg_lo:[0,1,0] neg_hi:[0,1,0]
    v_pk_fma_f32 v[156:157], v[192:193], v[68:69], v[156:157]
    v_pk_fma_f32 v[154:155], v[198:199], v[70:71], v[154:155] neg_lo:[0,1,0] neg_hi:[0,1,0]
    v_pk_fma_f32 v[158:159], v[194:195], v[70:71], v[158:159]
    v_cndmask_b32 v156, v156, v220, s[74:75]
    v_cvt_pk_bf16_f32 v164, v152, v156
    v_cvt_pk_bf16_f32 v165, v153, v157
    v_cvt_pk_bf16_f32 v166, v154, v158
    v_cvt_pk_bf16_f32 v167, v155, v159
    v_mfma_f32_16x16x32_bf16 v[104:107], v[92:95], v[48:51], v[104:107]
    v_mfma_f32_16x16x32_bf16 v[108:111], v[92:95], v[52:55], v[108:111]
    v_mfma_f32_16x16x32_bf16 v[176:179], v[164:167], v[48:51], v[176:179]
    v_mfma_f32_16x16x32_bf16 v[180:183], v[164:167], v[52:55], v[180:183]
    s_lshl_b32 s3, s22, 6
    v_xor_b32 v227, s3, v74
    v_and_b32 v12, 7, v1
    v_lshrrev_b32 v15, 3, v1
    v_and_b32 v14, 3, v1
    v_lshlrev_b32 v14, 2, v14
    v_xor_b32 v14, v14, v15
    v_lshlrev_b32 v228, 11, v12
    v_lshl_add_u32 v228, v14, 4, v228
    v_add_u32 v228, s80, v228
    v_xor_b32 v229, 128, v228
    v_lshlrev_b32 v76, 10, v15
    v_lshl_add_u32 v76, v12, 4, v76
    v_cvt_pk_bf16_f32 v120, v96, v104
    v_cvt_pk_bf16_f32 v121, v97, v105
    v_cvt_pk_bf16_f32 v122, v98, v106
    v_cvt_pk_bf16_f32 v123, v99, v107
    ds_write_b128 v227, v[120:123] offset:0
    v_cvt_pk_bf16_f32 v124, v100, v108
    v_cvt_pk_bf16_f32 v125, v101, v109
    v_cvt_pk_bf16_f32 v126, v102, v110
    v_cvt_pk_bf16_f32 v127, v103, v111
    ds_write_b128 v227, v[124:127] offset:1024
    v_cvt_pk_bf16_f32 v192, v168, v176
    v_cvt_pk_bf16_f32 v193, v169, v177
    v_cvt_pk_bf16_f32 v194, v170, v178
    v_cvt_pk_bf16_f32 v195, v171, v179
    ds_write_b128 v227, v[192:195] offset:8192
    v_cvt_pk_bf16_f32 v196, v172, v180
    v_cvt_pk_bf16_f32 v197, v173, v181
    v_cvt_pk_bf16_f32 v198, v174, v182
    v_cvt_pk_bf16_f32 v199, v175, v183
    ds_write_b128 v227, v[196:199] offset:9216
    s_lshr_b32 s81, s76, 1
    s_lshl_b32 s81, s81, 15
    s_and_b32 s3, s76, 1
    s_lshl_b32 s3, s3, 7
    s_add_u32 s81, s81, s3
    s_add_u32 s81, s81, s80
    s_add_u32 s81, s81, s21
    s_add_u32 s81, s81, 8323072
    s_add_u32 s82, s81, 8192
    s_add_u32 s83, s81, 16384
    s_add_u32 s84, s81, 24576
    s_lshl_b32 s85, s76, 6
    s_add_u32 s85, s85, s21
    s_add_u32 s85, s85, 13680640
    s_cmp_eq_u32 s22, 0
    s_cselect_b32 s85, s85, 0x40000000
    s_waitcnt lgkmcnt(0)
    s_barrier
    ds_read_b128 v[112:115], v228 offset:0
    ds_read_b128 v[116:119], v229 offset:0
    ds_read_b128 v[120:123], v228 offset:1024
    ds_read_b128 v[124:127], v229 offset:1024
    s_waitcnt lgkmcnt(3)
    buffer_store_dwordx4 v[112:115], v76, s[8:11], s81 offen sc1
    s_waitcnt lgkmcnt(2)
    buffer_store_dwordx4 v[116:119], v76, s[8:11], s82 offen sc1
    s_waitcnt lgkmcnt(1)
    buffer_store_dwordx4 v[120:123], v76, s[8:11], s83 offen sc1
    s_waitcnt lgkmcnt(0)
    buffer_store_dwordx4 v[124:127], v76, s[8:11], s84 offen sc1
    v_pk_mul_f32 v[128:129], v[96:97], v[96:97]
    v_pk_mul_f32 v[200:201], v[168:169], v[168:169]
    v_pk_fma_f32 v[128:129], v[98:99], v[98:99], v[128:129]
    v_pk_fma_f32 v[200:201], v[170:171], v[170:171], v[200:201]
    v_pk_fma_f32 v[128:129], v[100:101], v[100:101], v[128:129]
    v_pk_fma_f32 v[200:201], v[172:173], v[172:173], v[200:201]
    v_pk_fma_f32 v[128:129], v[102:103], v[102:103], v[128:129]
    v_pk_fma_f32 v[200:201], v[174:175], v[174:175], v[200:201]
    v_pk_fma_f32 v[128:129], v[104:105], v[104:105], v[128:129]
    v_pk_fma_f32 v[200:201], v[176:177], v[176:177], v[200:201]
    v_pk_fma_f32 v[128:129], v[106:107], v[106:107], v[128:129]
    v_pk_fma_f32 v[200:201], v[178:179], v[178:179], v[200:201]
    v_pk_fma_f32 v[128:129], v[108:109], v[108:109], v[128:129]
    v_pk_fma_f32 v[200:201], v[180:181], v[180:181], v[200:201]
    v_pk_fma_f32 v[128:129], v[110:111], v[110:111], v[128:129]
    v_pk_fma_f32 v[200:201], v[182:183], v[182:183], v[200:201]
    v_add_f32 v128, v128, v129
    v_add_f32 v200, v200, v201
    s_nop 0
    v_add_f32_dpp v128, v128, v128 quad_perm:[1,0,3,2] row_mask:0xf bank_mask:0xf
    v_add_f32_dpp v200, v200, v200 quad_perm:[1,0,3,2] row_mask:0xf bank_mask:0xf
    s_nop 0
    v_add_f32_dpp v128, v128, v128 quad_perm:[2,3,0,1] row_mask:0xf bank_mask:0xf
    v_add_f32_dpp v200, v200, v200 quad_perm:[2,3,0,1] row_mask:0xf bank_mask:0xf
    s_nop 0
    v_add_f32_dpp v128, v128, v128 row_half_mirror row_mask:0xf bank_mask:0xf
    v_add_f32_dpp v200, v200, v200 row_half_mirror row_mask:0xf bank_mask:0xf
    s_nop 0
    v_add_f32_dpp v128, v128, v128 row_mirror row_mask:0xf bank_mask:0xf
    v_add_f32_dpp v200, v200, v200 row_mirror row_mask:0xf bank_mask:0xf
    s_nop 0
    v_add_f32_dpp v128, v128, v128 row_bcast:15 row_mask:0xa bank_mask:0xf
    v_add_f32_dpp v200, v200, v200 row_bcast:15 row_mask:0xa bank_mask:0xf
    s_nop 0
    v_add_f32_dpp v128, v128, v128 row_bcast:31 row_mask:0xc bank_mask:0xf
    v_add_f32_dpp v200, v200, v200 row_bcast:31 row_mask:0xc bank_mask:0xf
    v_mov_b32 v130, 0x3a800000
    v_mov_b32 v202, 0x3a800000
    v_readlane_b32 s89, v128, 63
    v_readlane_b32 s90, v200, 63
    v_mov_b32 v131, 0x3727c5ac
    v_mov_b32 v203, 0x3727c5ac
    v_fma_f32 v130, s89, v130, v131
    v_fma_f32 v202, s90, v202, v203
    v_rsq_f32 v232, v130
    v_rsq_f32 v234, v202
    v_max_f32 v232, 0x00800000, v232
    v_max_f32 v234, 0x00800000, v234
    s_lshl_b32 s3, s22, 3
    s_add_u32 s3, s3, 65536
    v_mov_b32 v15, s3
    ds_write_b64 v15, v[232:233] offset:32768
    ds_write_b64 v15, v[234:235] offset:32800
    s_and_b32 s59, s2, 3
    s_lshl_b32 s59, s59, 2
    s_bfe_u32 s60, s2, 0x20003
    s_add_u32 s59, s59, s60
    s_lshr_b32 s60, s2, 5
    s_lshl_b32 s59, s59, 2
    s_add_u32 s59, s59, s22
    s_bfe_u32 s61, s2, 0x10002
    s_lshl_b32 s63, s60, 8
    s_lshl_b32 s40, s61, 3
    s_add_u32 s40, s40, s60
    s_mul_i32 s40, s40, 458752
    s_add_u32 s40, s40, s46
    s_add_u32 s40, s40, 117440512
    s_lshl_b32 s50, s59, 1
    s_add_u32 s50, s50, s61
    s_xor_b32 s51, s50, 1
    s_lshl_b32 s43, s50, 7
    s_add_u32 s43, s43, s21
    s_add_u32 s43, s43, 13680640
    s_lshl_b32 s42, s50, 15
    s_lshl_b32 s3, s60, 12
    s_add_u32 s42, s42, s3
    s_add_u32 s42, s42, s21
    s_add_u32 s42, s42, 8388608
    s_mul_i32 s41, s61, 57344
    s_add_u32 s41, s41, s21
    s_add_u32 s41, s41, 25165824
    s_mul_i32 s3, s50, 114688
    v_add_u32 v254, s3, v2
    s_mul_i32 s3, s51, 114688
    v_add_u32 v255, s3, v2
    s_add_u32 s56, s21, 13631488
    v_add_u32 v9, s56, v9
    s_lshr_b32 s62, s59, 1
    s_lshl_b32 s62, s62, 9
    s_lshl_b32 s3, s61, 7
    s_add_u32 s62, s62, s3
    s_add_u32 s62, s62, s56
    s_mov_b32 s58, 0x40000000
    v_mov_b32 v250, 0
    v_mov_b32 v251, 1
    v_bfe_u32 v12, v4, 2, 1
    v_lshrrev_b32 v14, 3, v4
    v_bfe_u32 v15, v4, 1, 1
    v_lshl_add_u32 v14, v14, 1, v15
    v_and_b32 v15, 1, v4
    v_lshlrev_b32 v15, 4, v15
    v_mov_b32 v249, 0x3f80
    v_lshlrev_b32 v15, v15, v249
    v_sub_u32 v12, v3, v12
    v_lshl_add_u32 v12, v12, 3, v14
    v_cmp_eq_u32 vcc, 0, v12
    s_nop 1
    v_cndmask_b32 v24, 0, v15, vcc
    v_cmp_eq_u32 vcc, 1, v12
    s_nop 1
    v_cndmask_b32 v25, 0, v15, vcc
    v_cmp_eq_u32 vcc, 2, v12
    s_nop 1
    v_cndmask_b32 v26, 0, v15, vcc
    v_cmp_eq_u32 vcc, 3, v12
    s_nop 1
    v_cndmask_b32 v27, 0, v15, vcc
    v_cmp_eq_u32 vcc, 16, v12
    s_nop 1
    v_cndmask_b32 v28, 0, v15, vcc
    v_cmp_eq_u32 vcc, 17, v12
    s_nop 1
    v_cndmask_b32 v29, 0, v15, vcc
    v_cmp_eq_u32 vcc, 18, v12
    s_nop 1
    v_cndmask_b32 v30, 0, v15, vcc
    v_cmp_eq_u32 vcc, 19, v12
    s_nop 1
    v_cndmask_b32 v31, 0, v15, vcc
    s_lshr_b32 s88, s59, 1
    s_lshl_b32 s88, s88, 9
    s_add_u32 s88, s88, s21
    s_add_u32 s88, s88, 13680640
    v_lshlrev_b32 v227, 3, v1
    v_and_b32 v15, 48, v2
    v_add_u32 v14, 65536, v15
    s_waitcnt vmcnt(0) lgkmcnt(0)
    s_barrier
    ds_read_b128 v[112:115], v14 offset:32768
    s_waitcnt lgkmcnt(0)
    s_mov_b64 exec, 15
    buffer_store_dwordx4 v[112:115], v15, s[8:11], s85 offen sc1
    s_mov_b64 exec, -1
    v_and_b32 v12, 1, v3
    v_bfe_u32 v14, v1, 2, 2
    v_lshl_add_u32 v15, v12, 2, v14
    v_lshl_add_u32 v14, v3, 3, v14
    v_lshlrev_b32 v14, 8, v14
    v_and_b32 v12, 1, v1
    v_lshl_add_u32 v14, v12, 4, v14
    v_bfe_u32 v12, v1, 1, 1
    v_lshl_add_u32 v14, v12, 3, v14
    v_xor_b32 v12, 0, v15
    v_lshl_add_u32 v16, v12, 5, v14
    v_xor_b32 v12, 1, v15
    v_lshl_add_u32 v17, v12, 5, v14
    v_xor_b32 v12, 2, v15
    v_lshl_add_u32 v18, v12, 5, v14
    v_xor_b32 v12, 3, v15
    v_lshl_add_u32 v19, v12, 5, v14
    v_xor_b32 v12, 4, v15
    v_lshl_add_u32 v20, v12, 5, v14
    v_xor_b32 v12, 5, v15
    v_lshl_add_u32 v21, v12, 5, v14
    v_xor_b32 v12, 6, v15
    v_lshl_add_u32 v22, v12, 5, v14
    v_xor_b32 v12, 7, v15
    v_lshl_add_u32 v23, v12, 5, v14
    s_getpc_b64 s[96:97]
Lpc_csa:
    s_sub_u32 s96, s96, Lpc_csa-code_start
    s_subb_u32 s97, s97, 0
    s_mov_b32 s98, code_end-code_start
    s_mov_b32 s99, 0x20000
    s_bfe_u32 s3, s2, 0x20003
    s_lshl_b32 s3, s3, 2
    s_add_u32 s3, s3, s22
    s_lshl_b32 s3, s3, 12
    v_lshlrev_b32 v253, 6, v1
    v_add_u32 v253, s3, v253
    s_mul_i32 s36, s48, 458752
    s_lshl_b32 s3, s49, 11
    s_add_u32 s36, s36, s3
    s_cmp_ge_u32 s49, 14
    s_cselect_b32 s3, 28672, 0
    s_cselect_b32 s44, 128, 0
    s_add_u32 s36, s36, s3
    s_lshl_b32 s3, s48, 9
    s_add_u32 s44, s44, s3
    s_add_u32 s44, s44, s56
    s_add_u32 s36, s36, s21
    s_add_u32 s36, s36, 25165824
    s_add_u32 s37, s36, 229376
    s_add_u32 s38, s36, 28672
    s_add_u32 s39, s36, 258048
    v_and_b32 v12, 31, v1
    v_mul_u32_u24 v6, 114688, v13
    v_lshl_add_u32 v6, v12, 4, v6
    s_cmp_ge_u32 s2, 224
    s_cbranch_scc1 L_gg_skip1
    s_mul_i32 s3, s22, 4352
    s_add_u32 s3, s3, 131072
    v_lshl_add_u32 v12, v1, 2, s3
    v_add_u32 v14, s3, v5
    ds_write_b32 v12, a164
    s_waitcnt lgkmcnt(0)
    ds_read_b64 v[96:97], v14 offset:0
    ds_read_b64 v[98:99], v14 offset:32
    ds_read_b64 v[100:101], v14 offset:64
    ds_read_b64 v[102:103], v14 offset:96
    ds_read_b64 v[104:105], v14 offset:128
    ds_read_b64 v[106:107], v14 offset:160
    ds_read_b64 v[108:109], v14 offset:192
    ds_read_b64 v[110:111], v14 offset:224
    s_mov_b32 s45, 3
    s_branch L_gg_warm0
L_gg_warmed:
    buffer_load_dword v249, v227, s[8:11], s57 offen sc1
    s_waitcnt lgkmcnt(0)
    v_lshlrev_b32 v64, 16, v96
    v_and_b32 v65, 0xffff0000, v96
    v_lshlrev_b32 v66, 16, v97
    v_and_b32 v67, 0xffff0000, v97
    v_lshlrev_b32 v68, 16, v98
    v_and_b32 v69, 0xffff0000, v98
    v_lshlrev_b32 v70, 16, v99
    v_and_b32 v71, 0xffff0000, v99
    v_lshlrev_b32 v72, 16, v100
    v_and_b32 v73, 0xffff0000, v100
    v_lshlrev_b32 v74, 16, v101
    v_and_b32 v75, 0xffff0000, v101
    v_lshlrev_b32 v76, 16, v102
    v_and_b32 v77, 0xffff0000, v102
    v_lshlrev_b32 v78, 16, v103
    v_and_b32 v79, 0xffff0000, v103
    v_lshlrev_b32 v80, 16, v104
    v_and_b32 v81, 0xffff0000, v104
    v_lshlrev_b32 v82, 16, v105
    v_and_b32 v83, 0xffff0000, v105
    v_lshlrev_b32 v84, 16, v106
    v_and_b32 v85, 0xffff0000, v106
    v_lshlrev_b32 v86, 16, v107
    v_and_b32 v87, 0xffff0000, v107
    v_lshlrev_b32 v88, 16, v108
    v_and_b32 v89, 0xffff0000, v108
    v_lshlrev_b32 v90, 16, v109
    v_and_b32 v91, 0xffff0000, v109
    v_lshlrev_b32 v92, 16, v110
    v_and_b32 v93, 0xffff0000, v110
    v_lshlrev_b32 v94, 16, v111
    v_and_b32 v95, 0xffff0000, v111
    ds_read_b64_tr_b16 v[32:33], v16 offset:0
    ds_read_b64_tr_b16 v[34:35], v16 offset:1024
    ds_read_b64_tr_b16 v[36:37], v17 offset:0
    ds_read_b64_tr_b16 v[38:39], v17 offset:1024
    ds_read_b64_tr_b16 v[40:41], v18 offset:0
    ds_read_b64_tr_b16 v[42:43], v18 offset:1024
    ds_read_b64_tr_b16 v[44:45], v19 offset:0
    ds_read_b64_tr_b16 v[46:47], v19 offset:1024
    ds_read_b64_tr_b16 v[48:49], v20 offset:0
    ds_read_b64_tr_b16 v[50:51], v20 offset:1024
    ds_read_b64_tr_b16 v[52:53], v21 offset:0
    ds_read_b64_tr_b16 v[54:55], v21 offset:1024
    ds_read_b64_tr_b16 v[56:57], v22 offset:0
    ds_read_b64_tr_b16 v[58:59], v22 offset:1024
    ds_read_b64_tr_b16 v[60:61], v23 offset:0
    ds_read_b64_tr_b16 v[62:63], v23 offset:1024
    v_lshlrev_b32 v12, 2, v4
    s_waitcnt vmcnt(0)
    s_mov_b32 s3, 0x40000
L_gg_pollk:
    v_cmp_eq_u32 vcc, 0, v249
    s_nop 4
    s_cbranch_vccz L_gg_pollk_x
    buffer_load_dword v249, v227, s[8:11], s57 offen sc1
    s_sub_u32 s3, s3, 1
    s_waitcnt vmcnt(0)
    s_cmp_lg_u32 s3, 0
    s_cbranch_scc1 L_gg_pollk
L_gg_pollk_x:
    ds_bpermute_b32 v235, v12, v249 offset:0
    ds_bpermute_b32 v239, v12, v249 offset:64
    ds_bpermute_b32 v243, v12, v249 offset:128
    ds_bpermute_b32 v247, v12, v249 offset:192
    buffer_load_dwordx4 a[0:3], v2, s[8:11], s55 offen offset:0 sc1
    buffer_load_dwordx4 a[4:7], v224, s[8:11], s55 offen offset:0 sc1
    buffer_load_dwordx4 a[8:11], v225, s[8:11], s55 offen offset:0 sc1
    buffer_load_dwordx4 a[12:15], v226, s[8:11], s55 offen offset:0 sc1
    s_waitcnt lgkmcnt(0)
    v_rcp_f32 v234, v235
    v_rcp_f32 v238, v239
    v_rcp_f32 v242, v243
    v_rcp_f32 v246, v247
    v_pk_mul_f32 v[160:161], v[64:65], v[234:235] op_sel_hi:[1,0]
    v_pk_mul_f32 v[162:163], v[66:67], v[234:235] op_sel_hi:[1,0]
    v_pk_mul_f32 v[164:165], v[64:65], v[238:239] op_sel_hi:[1,0]
    v_pk_mul_f32 v[166:167], v[66:67], v[238:239] op_sel_hi:[1,0]
    s_add_u32 m0, s46, 49152
    s_nop 0
    buffer_load_dwordx4 v7, s[12:15], s54 offen lds
    v_pk_mul_f32 v[168:169], v[64:65], v[242:243] op_sel_hi:[1,0]
    v_pk_mul_f32 v[170:171], v[66:67], v[242:243] op_sel_hi:[1,0]
    v_pk_mul_f32 v[172:173], v[64:65], v[246:247] op_sel_hi:[1,0]
    v_pk_mul_f32 v[174:175], v[66:67], v[246:247] op_sel_hi:[1,0]
    buffer_load_dwordx4 v8, s[12:15], s54 offen offset:1024 lds
    v_pk_mul_f32 v[176:177], v[68:69], v[234:235] op_sel_hi:[1,0]
    v_pk_mul_f32 v[178:179], v[70:71], v[234:235] op_sel_hi:[1,0]
    v_pk_mul_f32 v[180:181], v[68:69], v[238:239] op_sel_hi:[1,0]
    v_pk_mul_f32 v[182:183], v[70:71], v[238:239] op_sel_hi:[1,0]
    s_add_u32 s54, s54, 229376
    buffer_load_dwordx4 a[16:19], v2, s[8:11], s55 offen offset:1024 sc1
    v_pk_mul_f32 v[184:185], v[68:69], v[242:243] op_sel_hi:[1,0]
    v_pk_mul_f32 v[186:187], v[70:71], v[242:243] op_sel_hi:[1,0]
    v_pk_mul_f32 v[188:189], v[68:69], v[246:247] op_sel_hi:[1,0]
    v_pk_mul_f32 v[190:191], v[70:71], v[246:247] op_sel_hi:[1,0]
    buffer_load_dwordx4 a[20:23], v224, s[8:11], s55 offen offset:1024 sc1
    v_pk_mul_f32 v[192:193], v[72:73], v[234:235] op_sel_hi:[1,0]
    v_pk_mul_f32 v[194:195], v[74:75], v[234:235] op_sel_hi:[1,0]
    v_pk_mul_f32 v[196:197], v[72:73], v[238:239] op_sel_hi:[1,0]
    v_pk_mul_f32 v[198:199], v[74:75], v[238:239] op_sel_hi:[1,0]
    buffer_load_dwordx4 a[24:27], v225, s[8:11], s55 offen offset:1024 sc1
    v_pk_mul_f32 v[200:201], v[72:73], v[242:243] op_sel_hi:[1,0]
    v_pk_mul_f32 v[202:203], v[74:75], v[242:243] op_sel_hi:[1,0]
    v_pk_mul_f32 v[204:205], v[72:73], v[246:247] op_sel_hi:[1,0]
    v_pk_mul_f32 v[206:207], v[74:75], v[246:247] op_sel_hi:[1,0]
    buffer_load_dwordx4 a[28:31], v226, s[8:11], s55 offen offset:1024 sc1
    v_pk_mul_f32 v[208:209], v[76:77], v[234:235] op_sel_hi:[1,0]
    v_pk_mul_f32 v[210:211], v[78:79], v[234:235] op_sel_hi:[1,0]
    v_pk_mul_f32 v[212:213], v[76:77], v[238:239] op_sel_hi:[1,0]
    v_pk_mul_f32 v[214:215], v[78:79], v[238:239] op_sel_hi:[1,0]
    s_add_u32 m0, s46, 57344
    s_nop 0
    buffer_load_dwordx4 v7, s[12:15], s54 offen lds
    v_pk_mul_f32 v[216:217], v[76:77], v[242:243] op_sel_hi:[1,0]
    v_pk_mul_f32 v[218:219], v[78:79], v[242:243] op_sel_hi:[1,0]
    v_pk_mul_f32 v[220:221], v[76:77], v[246:247] op_sel_hi:[1,0]
    v_pk_mul_f32 v[222:223], v[78:79], v[246:247] op_sel_hi:[1,0]
    buffer_load_dwordx4 v8, s[12:15], s54 offen offset:1024 lds
    v_pk_mul_f32 v[96:97], v[80:81], v[234:235] op_sel_hi:[1,0]
    v_pk_mul_f32 v[98:99], v[82:83], v[234:235] op_sel_hi:[1,0]
    v_pk_mul_f32 v[100:101], v[80:81], v[238:239] op_sel_hi:[1,0]
    v_pk_mul_f32 v[102:103], v[82:83], v[238:239] op_sel_hi:[1,0]
    s_add_u32 s54, s54, 229376
    buffer_load_dwordx4 a[32:35], v2, s[8:11], s55 offen offset:2048 sc1
    v_pk_mul_f32 v[104:105], v[80:81], v[242:243] op_sel_hi:[1,0]
    v_pk_mul_f32 v[106:107], v[82:83], v[242:243] op_sel_hi:[1,0]
    v_pk_mul_f32 v[108:109], v[80:81], v[246:247] op_sel_hi:[1,0]
    v_pk_mul_f32 v[110:111], v[82:83], v[246:247] op_sel_hi:[1,0]
    buffer_load_dwordx4 a[36:39], v224, s[8:11], s55 offen offset:2048 sc1
    v_pk_mul_f32 v[112:113], v[84:85], v[234:235] op_sel_hi:[1,0]
    v_pk_mul_f32 v[114:115], v[86:87], v[234:235] op_sel_hi:[1,0]
    v_pk_mul_f32 v[116:117], v[84:85], v[238:239] op_sel_hi:[1,0]
    v_pk_mul_f32 v[118:119], v[86:87], v[238:239] op_sel_hi:[1,0]
    buffer_load_dwordx4 a[40:43], v225, s[8:11], s55 offen offset:2048 sc1
    v_pk_mul_f32 v[120:121], v[84:85], v[242:243] op_sel_hi:[1,0]
    v_pk_mul_f32 v[122:123], v[86:87], v[242:243] op_sel_hi:[1,0]
    v_pk_mul_f32 v[124:125], v[84:85], v[246:247] op_sel_hi:[1,0]
    v_pk_mul_f32 v[126:127], v[86:87], v[246:247] op_sel_hi:[1,0]
    buffer_load_dwordx4 a[44:47], v226, s[8:11], s55 offen offset:2048 sc1
    v_pk_mul_f32 v[128:129], v[88:89], v[234:235] op_sel_hi:[1,0]
    v_pk_mul_f32 v[130:131], v[90:91], v[234:235] op_sel_hi:[1,0]
    v_pk_mul_f32 v[132:133], v[88:89], v[238:239] op_sel_hi:[1,0]
    v_pk_mul_f32 v[134:135], v[90:91], v[238:239] op_sel_hi:[1,0]
    v_pk_mul_f32 v[136:137], v[88:89], v[242:243] op_sel_hi:[1,0]
    v_pk_mul_f32 v[138:139], v[90:91], v[242:243] op_sel_hi:[1,0]
    v_pk_mul_f32 v[140:141], v[88:89], v[246:247] op_sel_hi:[1,0]
    v_pk_mul_f32 v[142:143], v[90:91], v[246:247] op_sel_hi:[1,0]
    v_pk_mul_f32 v[144:145], v[92:93], v[234:235] op_sel_hi:[1,0]
    v_pk_mul_f32 v[146:147], v[94:95], v[234:235] op_sel_hi:[1,0]
    v_pk_mul_f32 v[148:149], v[92:93], v[238:239] op_sel_hi:[1,0]
    v_pk_mul_f32 v[150:151], v[94:95], v[238:239] op_sel_hi:[1,0]
    v_pk_mul_f32 v[152:153], v[92:93], v[242:243] op_sel_hi:[1,0]
    v_pk_mul_f32 v[154:155], v[94:95], v[242:243] op_sel_hi:[1,0]
    v_pk_mul_f32 v[156:157], v[92:93], v[246:247] op_sel_hi:[1,0]
    v_pk_mul_f32 v[158:159], v[94:95], v[246:247] op_sel_hi:[1,0]
    v_mul_f32 v233, 0xc0135761, v235
    v_mul_f32 v235, v235, v235
    v_mul_f32 v235, 0x3d372713, v235
    v_mul_f32 v232, v235, v233
    v_mul_f32 v237, 0xc0135761, v239
    v_mul_f32 v239, v239, v239
    v_mul_f32 v239, 0x3d372713, v239
    v_mul_f32 v236, v239, v237
    v_mul_f32 v241, 0xc0135761, v243
    v_mul_f32 v243, v243, v243
    v_mul_f32 v243, 0x3d372713, v243
    v_mul_f32 v240, v243, v241
    v_mul_f32 v245, 0xc0135761, v247
    v_mul_f32 v247, v247, v247
    v_mul_f32 v247, 0x3d372713, v247
    v_mul_f32 v244, v247, v245
.p2align 6
L_g1_loop:
    s_waitcnt vmcnt(12) lgkmcnt(8)
    v_mfma_f32_16x16x32_bf16 v[160:163], v[32:35], a[0:3], v[160:163]
    ds_read_b64_tr_b16 v[64:65], v16 offset:8192
    v_mfma_f32_16x16x32_bf16 v[164:167], v[32:35], a[4:7], v[164:167]
    s_add_u32 m0, s47, 0
    v_mfma_f32_16x16x32_bf16 v[168:171], v[32:35], a[8:11], v[168:171]
    ds_read_b64_tr_b16 v[66:67], v16 offset:9216
    v_mfma_f32_16x16x32_bf16 v[172:175], v[32:35], a[12:15], v[172:175]
    buffer_load_dwordx4 v7, s[12:15], s54 offen lds
    v_mfma_f32_16x16x32_bf16 v[188:191], v[36:39], a[12:15], v[188:191]
    ds_read_b64_tr_b16 v[68:69], v17 offset:8192
    v_mfma_f32_16x16x32_bf16 v[184:187], v[36:39], a[8:11], v[184:187]
    v_mfma_f32_16x16x32_bf16 v[180:183], v[36:39], a[4:7], v[180:183]
    ds_read_b64_tr_b16 v[70:71], v17 offset:9216
    v_mfma_f32_16x16x32_bf16 v[176:179], v[36:39], a[0:3], v[176:179]
    buffer_load_dwordx4 v8, s[12:15], s54 offen offset:1024 lds
    v_mfma_f32_16x16x32_bf16 v[192:195], v[40:43], a[0:3], v[192:195]
    ds_read_b64_tr_b16 v[72:73], v18 offset:8192
    v_mfma_f32_16x16x32_bf16 v[196:199], v[40:43], a[4:7], v[196:199]
    s_add_u32 s54, s54, 229376
    v_mfma_f32_16x16x32_bf16 v[200:203], v[40:43], a[8:11], v[200:203]
    ds_read_b64_tr_b16 v[74:75], v18 offset:9216
    v_mfma_f32_16x16x32_bf16 v[204:207], v[40:43], a[12:15], v[204:207]
    v_mfma_f32_16x16x32_bf16 v[220:223], v[44:47], a[12:15], v[220:223]
    ds_read_b64_tr_b16 v[76:77], v19 offset:8192
    v_mfma_f32_16x16x32_bf16 v[216:219], v[44:47], a[8:11], v[216:219]
    buffer_load_dwordx4 a[48:51], v2, s[8:11], s55 offen offset:3072 sc1
    v_mfma_f32_16x16x32_bf16 v[212:215], v[44:47], a[4:7], v[212:215]
    ds_read_b64_tr_b16 v[78:79], v19 offset:9216
    v_mfma_f32_16x16x32_bf16 v[208:211], v[44:47], a[0:3], v[208:211]
    s_waitcnt lgkmcnt(8)
    v_mfma_f32_16x16x32_bf16 v[96:99], v[48:51], a[0:3], v[96:99]
    ds_read_b64_tr_b16 v[80:81], v20 offset:8192
    v_mfma_f32_16x16x32_bf16 v[100:103], v[48:51], a[4:7], v[100:103]
    buffer_load_dwordx4 a[52:55], v224, s[8:11], s55 offen offset:3072 sc1
    v_mfma_f32_16x16x32_bf16 v[104:107], v[48:51], a[8:11], v[104:107]
    ds_read_b64_tr_b16 v[82:83], v20 offset:9216
    v_mfma_f32_16x16x32_bf16 v[108:111], v[48:51], a[12:15], v[108:111]
    v_mfma_f32_16x16x32_bf16 v[124:127], v[52:55], a[12:15], v[124:127]
    ds_read_b64_tr_b16 v[84:85], v21 offset:8192
    v_mfma_f32_16x16x32_bf16 v[120:123], v[52:55], a[8:11], v[120:123]
    v_mfma_f32_16x16x32_bf16 v[116:119], v[52:55], a[4:7], v[116:119]
    ds_read_b64_tr_b16 v[86:87], v21 offset:9216
    v_mfma_f32_16x16x32_bf16 v[112:115], v[52:55], a[0:3], v[112:115]
    buffer_load_dwordx4 a[56:59], v225, s[8:11], s55 offen offset:3072 sc1
    v_mfma_f32_16x16x32_bf16 v[128:131], v[56:59], a[0:3], v[128:131]
    ds_read_b64_tr_b16 v[88:89], v22 offset:8192
    v_mfma_f32_16x16x32_bf16 v[132:135], v[56:59], a[4:7], v[132:135]
    v_mfma_f32_16x16x32_bf16 v[136:139], v[56:59], a[8:11], v[136:139]
    ds_read_b64_tr_b16 v[90:91], v22 offset:9216
    v_mfma_f32_16x16x32_bf16 v[140:143], v[56:59], a[12:15], v[140:143]
    buffer_load_dwordx4 a[60:63], v226, s[8:11], s55 offen offset:3072 sc1
    v_mfma_f32_16x16x32_bf16 v[156:159], v[60:63], a[12:15], v[156:159]
    ds_read_b64_tr_b16 v[92:93], v23 offset:8192
    v_mfma_f32_16x16x32_bf16 v[152:155], v[60:63], a[8:11], v[152:155]
    s_add_u32 s55, s55, 4096
    v_mfma_f32_16x16x32_bf16 v[148:151], v[60:63], a[4:7], v[148:151]
    ds_read_b64_tr_b16 v[94:95], v23 offset:9216
    v_mfma_f32_16x16x32_bf16 v[144:147], v[60:63], a[0:3], v[144:147]
    s_waitcnt vmcnt(12) lgkmcnt(8)
    v_mfma_f32_16x16x32_bf16 v[160:163], v[64:67], a[16:19], v[160:163]
    ds_read_b64_tr_b16 v[32:33], v16 offset:16384
    v_mfma_f32_16x16x32_bf16 v[164:167], v[64:67], a[20:23], v[164:167]
    s_add_u32 m0, s47, 8192
    v_mfma_f32_16x16x32_bf16 v[168:171], v[64:67], a[24:27], v[168:171]
    ds_read_b64_tr_b16 v[34:35], v16 offset:17408
    v_mfma_f32_16x16x32_bf16 v[172:175], v[64:67], a[28:31], v[172:175]
    buffer_load_dwordx4 v7, s[12:15], s54 offen lds
    v_mfma_f32_16x16x32_bf16 v[188:191], v[68:71], a[28:31], v[188:191]
    ds_read_b64_tr_b16 v[36:37], v17 offset:16384
    v_mfma_f32_16x16x32_bf16 v[184:187], v[68:71], a[24:27], v[184:187]
    v_mfma_f32_16x16x32_bf16 v[180:183], v[68:71], a[20:23], v[180:183]
    ds_read_b64_tr_b16 v[38:39], v17 offset:17408
    v_mfma_f32_16x16x32_bf16 v[176:179], v[68:71], a[16:19], v[176:179]
    buffer_load_dwordx4 v8, s[12:15], s54 offen offset:1024 lds
    v_mfma_f32_16x16x32_bf16 v[192:195], v[72:75], a[16:19], v[192:195]
    ds_read_b64_tr_b16 v[40:41], v18 offset:16384
    v_mfma_f32_16x16x32_bf16 v[196:199], v[72:75], a[20:23], v[196:199]
    s_add_u32 s54, s54, 229376
    v_mfma_f32_16x16x32_bf16 v[200:203], v[72:75], a[24:27], v[200:203]
    ds_read_b64_tr_b16 v[42:43], v18 offset:17408
    v_mfma_f32_16x16x32_bf16 v[204:207], v[72:75], a[28:31], v[204:207]
    v_mfma_f32_16x16x32_bf16 v[220:223], v[76:79], a[28:31], v[220:223]
    ds_read_b64_tr_b16 v[44:45], v19 offset:16384
    v_mfma_f32_16x16x32_bf16 v[216:219], v[76:79], a[24:27], v[216:219]
    buffer_load_dwordx4 a[64:67], v2, s[8:11], s55 offen offset:0 sc1
    v_mfma_f32_16x16x32_bf16 v[212:215], v[76:79], a[20:23], v[212:215]
    ds_read_b64_tr_b16 v[46:47], v19 offset:17408
    v_mfma_f32_16x16x32_bf16 v[208:211], v[76:79], a[16:19], v[208:211]
    s_waitcnt lgkmcnt(8)
    v_mfma_f32_16x16x32_bf16 v[96:99], v[80:83], a[16:19], v[96:99]
    ds_read_b64_tr_b16 v[48:49], v20 offset:16384
    v_mfma_f32_16x16x32_bf16 v[100:103], v[80:83], a[20:23], v[100:103]
    buffer_load_dwordx4 a[68:71], v224, s[8:11], s55 offen offset:0 sc1
    v_mfma_f32_16x16x32_bf16 v[104:107], v[80:83], a[24:27], v[104:107]
    ds_read_b64_tr_b16 v[50:51], v20 offset:17408
    v_mfma_f32_16x16x32_bf16 v[108:111], v[80:83], a[28:31], v[108:111]
    v_mfma_f32_16x16x32_bf16 v[124:127], v[84:87], a[28:31], v[124:127]
    ds_read_b64_tr_b16 v[52:53], v21 offset:16384
    v_mfma_f32_16x16x32_bf16 v[120:123], v[84:87], a[24:27], v[120:123]
    v_mfma_f32_16x16x32_bf16 v[116:119], v[84:87], a[20:23], v[116:119]
    ds_read_b64_tr_b16 v[54:55], v21 offset:17408
    v_mfma_f32_16x16x32_bf16 v[112:115], v[84:87], a[16:19], v[112:115]
    buffer_load_dwordx4 a[72:75], v225, s[8:11], s55 offen offset:0 sc1
    v_mfma_f32_16x16x32_bf16 v[128:131], v[88:91], a[16:19], v[128:131]
    ds_read_b64_tr_b16 v[56:57], v22 offset:16384
    v_mfma_f32_16x16x32_bf16 v[132:135], v[88:91], a[20:23], v[132:135]
    v_mfma_f32_16x16x32_bf16 v[136:139], v[88:91], a[24:27], v[136:139]
    ds_read_b64_tr_b16 v[58:59], v22 offset:17408
    v_mfma_f32_16x16x32_bf16 v[140:143], v[88:91], a[28:31], v[140:143]
    buffer_load_dwordx4 a[76:79], v226, s[8:11], s55 offen offset:0 sc1
    v_mfma_f32_16x16x32_bf16 v[156:159], v[92:95], a[28:31], v[156:159]
    ds_read_b64_tr_b16 v[60:61], v23 offset:16384
    v_mfma_f32_16x16x32_bf16 v[152:155], v[92:95], a[24:27], v[152:155]
    v_mfma_f32_16x16x32_bf16 v[148:151], v[92:95], a[20:23], v[148:151]
    ds_read_b64_tr_b16 v[62:63], v23 offset:17408
    v_mfma_f32_16x16x32_bf16 v[144:147], v[92:95], a[16:19], v[144:147]
    s_waitcnt vmcnt(12) lgkmcnt(8)
    v_mfma_f32_16x16x32_bf16 v[160:163], v[32:35], a[32:35], v[160:163]
    ds_read_b64_tr_b16 v[64:65], v16 offset:24576
    v_mfma_f32_16x16x32_bf16 v[164:167], v[32:35], a[36:39], v[164:167]
    s_add_u32 m0, s47, 16384
    v_mfma_f32_16x16x32_bf16 v[168:171], v[32:35], a[40:43], v[168:171]
    ds_read_b64_tr_b16 v[66:67], v16 offset:25600
    v_mfma_f32_16x16x32_bf16 v[172:175], v[32:35], a[44:47], v[172:175]
    buffer_load_dwordx4 v7, s[12:15], s54 offen lds
    v_mfma_f32_16x16x32_bf16 v[188:191], v[36:39], a[44:47], v[188:191]
    ds_read_b64_tr_b16 v[68:69], v17 offset:24576
    v_mfma_f32_16x16x32_bf16 v[184:187], v[36:39], a[40:43], v[184:187]
    v_mfma_f32_16x16x32_bf16 v[180:183], v[36:39], a[36:39], v[180:183]
    ds_read_b64_tr_b16 v[70:71], v17 offset:25600
    v_mfma_f32_16x16x32_bf16 v[176:179], v[36:39], a[32:35], v[176:179]
    buffer_load_dwordx4 v8, s[12:15], s54 offen offset:1024 lds
    v_mfma_f32_16x16x32_bf16 v[192:195], v[40:43], a[32:35], v[192:195]
    ds_read_b64_tr_b16 v[72:73], v18 offset:24576
    v_mfma_f32_16x16x32_bf16 v[196:199], v[40:43], a[36:39], v[196:199]
    s_add_u32 s54, s54, 229376
    v_mfma_f32_16x16x32_bf16 v[200:203], v[40:43], a[40:43], v[200:203]
    ds_read_b64_tr_b16 v[74:75], v18 offset:25600
    v_mfma_f32_16x16x32_bf16 v[204:207], v[40:43], a[44:47], v[204:207]
    v_mfma_f32_16x16x32_bf16 v[220:223], v[44:47], a[44:47], v[220:223]
    ds_read_b64_tr_b16 v[76:77], v19 offset:24576
    v_mfma_f32_16x16x32_bf16 v[216:219], v[44:47], a[40:43], v[216:219]
    buffer_load_dwordx4 a[80:83], v2, s[8:11], s55 offen offset:1024 sc1
    v_mfma_f32_16x16x32_bf16 v[212:215], v[44:47], a[36:39], v[212:215]
    ds_read_b64_tr_b16 v[78:79], v19 offset:25600
    v_mfma_f32_16x16x32_bf16 v[208:211], v[44:47], a[32:35], v[208:211]
    s_waitcnt lgkmcnt(8)
    v_mfma_f32_16x16x32_bf16 v[96:99], v[48:51], a[32:35], v[96:99]
    ds_read_b64_tr_b16 v[80:81], v20 offset:24576
    v_mfma_f32_16x16x32_bf16 v[100:103], v[48:51], a[36:39], v[100:103]
    buffer_load_dwordx4 a[84:87], v224, s[8:11], s55 offen offset:1024 sc1
    v_mfma_f32_16x16x32_bf16 v[104:107], v[48:51], a[40:43], v[104:107]
    ds_read_b64_tr_b16 v[82:83], v20 offset:25600
    v_mfma_f32_16x16x32_bf16 v[108:111], v[48:51], a[44:47], v[108:111]
    v_mfma_f32_16x16x32_bf16 v[124:127], v[52:55], a[44:47], v[124:127]
    ds_read_b64_tr_b16 v[84:85], v21 offset:24576
    v_mfma_f32_16x16x32_bf16 v[120:123], v[52:55], a[40:43], v[120:123]
    v_mfma_f32_16x16x32_bf16 v[116:119], v[52:55], a[36:39], v[116:119]
    ds_read_b64_tr_b16 v[86:87], v21 offset:25600
    v_mfma_f32_16x16x32_bf16 v[112:115], v[52:55], a[32:35], v[112:115]
    buffer_load_dwordx4 a[88:91], v225, s[8:11], s55 offen offset:1024 sc1
    v_mfma_f32_16x16x32_bf16 v[128:131], v[56:59], a[32:35], v[128:131]
    ds_read_b64_tr_b16 v[88:89], v22 offset:24576
    v_mfma_f32_16x16x32_bf16 v[132:135], v[56:59], a[36:39], v[132:135]
    v_mfma_f32_16x16x32_bf16 v[136:139], v[56:59], a[40:43], v[136:139]
    ds_read_b64_tr_b16 v[90:91], v22 offset:25600
    v_mfma_f32_16x16x32_bf16 v[140:143], v[56:59], a[44:47], v[140:143]
    buffer_load_dwordx4 a[92:95], v226, s[8:11], s55 offen offset:1024 sc1
    v_mfma_f32_16x16x32_bf16 v[156:159], v[60:63], a[44:47], v[156:159]
    ds_read_b64_tr_b16 v[92:93], v23 offset:24576
    v_mfma_f32_16x16x32_bf16 v[152:155], v[60:63], a[40:43], v[152:155]
    v_mfma_f32_16x16x32_bf16 v[148:151], v[60:63], a[36:39], v[148:151]
    ds_read_b64_tr_b16 v[94:95], v23 offset:25600
    v_mfma_f32_16x16x32_bf16 v[144:147], v[60:63], a[32:35], v[144:147]
    s_waitcnt vmcnt(12)
    s_barrier
    s_waitcnt lgkmcnt(8)
    v_mfma_f32_16x16x32_bf16 v[160:163], v[64:67], a[48:51], v[160:163]
    ds_read_b64_tr_b16 v[32:33], v16 offset:32768
    v_mfma_f32_16x16x32_bf16 v[164:167], v[64:67], a[52:55], v[164:167]
    s_add_u32 m0, s47, 24576
    v_mfma_f32_16x16x32_bf16 v[168:171], v[64:67], a[56:59], v[168:171]
    ds_read_b64_tr_b16 v[34:35], v16 offset:33792
    v_mfma_f32_16x16x32_bf16 v[172:175], v[64:67], a[60:63], v[172:175]
    buffer_load_dwordx4 v7, s[12:15], s54 offen lds
    v_mfma_f32_16x16x32_bf16 v[188:191], v[68:71], a[60:63], v[188:191]
    ds_read_b64_tr_b16 v[36:37], v17 offset:32768
    v_mfma_f32_16x16x32_bf16 v[184:187], v[68:71], a[56:59], v[184:187]
    v_mfma_f32_16x16x32_bf16 v[180:183], v[68:71], a[52:55], v[180:183]
    ds_read_b64_tr_b16 v[38:39], v17 offset:33792
    v_mfma_f32_16x16x32_bf16 v[176:179], v[68:71], a[48:51], v[176:179]
    buffer_load_dwordx4 v8, s[12:15], s54 offen offset:1024 lds
    v_mfma_f32_16x16x32_bf16 v[192:195], v[72:75], a[48:51], v[192:195]
    ds_read_b64_tr_b16 v[40:41], v18 offset:32768
    v_mfma_f32_16x16x32_bf16 v[196:199], v[72:75], a[52:55], v[196:199]
    s_add_u32 s54, s54, 229376
    v_mfma_f32_16x16x32_bf16 v[200:203], v[72:75], a[56:59], v[200:203]
    ds_read_b64_tr_b16 v[42:43], v18 offset:33792
    v_mfma_f32_16x16x32_bf16 v[204:207], v[72:75], a[60:63], v[204:207]
    v_mfma_f32_16x16x32_bf16 v[220:223], v[76:79], a[60:63], v[220:223]
    ds_read_b64_tr_b16 v[44:45], v19 offset:32768
    v_mfma_f32_16x16x32_bf16 v[216:219], v[76:79], a[56:59], v[216:219]
    buffer_load_dwordx4 a[96:99], v2, s[8:11], s55 offen offset:2048 sc1
    v_mfma_f32_16x16x32_bf16 v[212:215], v[76:79], a[52:55], v[212:215]
    ds_read_b64_tr_b16 v[46:47], v19 offset:33792
    v_mfma_f32_16x16x32_bf16 v[208:211], v[76:79], a[48:51], v[208:211]
    s_waitcnt lgkmcnt(8)
    v_mfma_f32_16x16x32_bf16 v[96:99], v[80:83], a[48:51], v[96:99]
    ds_read_b64_tr_b16 v[48:49], v20 offset:32768
    v_mfma_f32_16x16x32_bf16 v[100:103], v[80:83], a[52:55], v[100:103]
    buffer_load_dwordx4 a[100:103], v224, s[8:11], s55 offen offset:2048 sc1
    v_mfma_f32_16x16x32_bf16 v[104:107], v[80:83], a[56:59], v[104:107]
    ds_read_b64_tr_b16 v[50:51], v20 offset:33792
    v_mfma_f32_16x16x32_bf16 v[108:111], v[80:83], a[60:63], v[108:111]
    v_mfma_f32_16x16x32_bf16 v[124:127], v[84:87], a[60:63], v[124:127]
    ds_read_b64_tr_b16 v[52:53], v21 offset:32768
    v_mfma_f32_16x16x32_bf16 v[120:123], v[84:87], a[56:59], v[120:123]
    v_mfma_f32_16x16x32_bf16 v[116:119], v[84:87], a[52:55], v[116:119]
    ds_read_b64_tr_b16 v[54:55], v21 offset:33792
    v_mfma_f32_16x16x32_bf16 v[112:115], v[84:87], a[48:51], v[112:115]
    buffer_load_dwordx4 a[104:107], v225, s[8:11], s55 offen offset:2048 sc1
    v_mfma_f32_16x16x32_bf16 v[128:131], v[88:91], a[48:51], v[128:131]
    ds_read_b64_tr_b16 v[56:57], v22 offset:32768
    v_mfma_f32_16x16x32_bf16 v[132:135], v[88:91], a[52:55], v[132:135]
    v_mfma_f32_16x16x32_bf16 v[136:139], v[88:91], a[56:59], v[136:139]
    ds_read_b64_tr_b16 v[58:59], v22 offset:33792
    v_mfma_f32_16x16x32_bf16 v[140:143], v[88:91], a[60:63], v[140:143]
    buffer_load_dwordx4 a[108:111], v226, s[8:11], s55 offen offset:2048 sc1
    v_mfma_f32_16x16x32_bf16 v[156:159], v[92:95], a[60:63], v[156:159]
    ds_read_b64_tr_b16 v[60:61], v23 offset:32768
    v_mfma_f32_16x16x32_bf16 v[152:155], v[92:95], a[56:59], v[152:155]
    v_mfma_f32_16x16x32_bf16 v[148:151], v[92:95], a[52:55], v[148:151]
    ds_read_b64_tr_b16 v[62:63], v23 offset:33792
    v_mfma_f32_16x16x32_bf16 v[144:147], v[92:95], a[48:51], v[144:147]
    s_waitcnt vmcnt(12) lgkmcnt(8)
    v_mfma_f32_16x16x32_bf16 v[160:163], v[32:35], a[64:67], v[160:163]
    ds_read_b64_tr_b16 v[64:65], v16 offset:40960
    v_mfma_f32_16x16x32_bf16 v[164:167], v[32:35], a[68:71], v[164:167]
    s_add_u32 m0, s47, 32768
    v_mfma_f32_16x16x32_bf16 v[168:171], v[32:35], a[72:75], v[168:171]
    ds_read_b64_tr_b16 v[66:67], v16 offset:41984
    v_mfma_f32_16x16x32_bf16 v[172:175], v[32:35], a[76:79], v[172:175]
    buffer_load_dwordx4 v7, s[12:15], s54 offen lds
    v_mfma_f32_16x16x32_bf16 v[188:191], v[36:39], a[76:79], v[188:191]
    ds_read_b64_tr_b16 v[68:69], v17 offset:40960
    v_mfma_f32_16x16x32_bf16 v[184:187], v[36:39], a[72:75], v[184:187]
    v_mfma_f32_16x16x32_bf16 v[180:183], v[36:39], a[68:71], v[180:183]
    ds_read_b64_tr_b16 v[70:71], v17 offset:41984
    v_mfma_f32_16x16x32_bf16 v[176:179], v[36:39], a[64:67], v[176:179]
    buffer_load_dwordx4 v8, s[12:15], s54 offen offset:1024 lds
    v_mfma_f32_16x16x32_bf16 v[192:195], v[40:43], a[64:67], v[192:195]
    ds_read_b64_tr_b16 v[72:73], v18 offset:40960
    v_mfma_f32_16x16x32_bf16 v[196:199], v[40:43], a[68:71], v[196:199]
    s_add_u32 s54, s54, 229376
    v_mfma_f32_16x16x32_bf16 v[200:203], v[40:43], a[72:75], v[200:203]
    ds_read_b64_tr_b16 v[74:75], v18 offset:41984
    v_mfma_f32_16x16x32_bf16 v[204:207], v[40:43], a[76:79], v[204:207]
    v_mfma_f32_16x16x32_bf16 v[220:223], v[44:47], a[76:79], v[220:223]
    ds_read_b64_tr_b16 v[76:77], v19 offset:40960
    v_mfma_f32_16x16x32_bf16 v[216:219], v[44:47], a[72:75], v[216:219]
    buffer_load_dwordx4 a[112:115], v2, s[8:11], s55 offen offset:3072 sc1
    v_mfma_f32_16x16x32_bf16 v[212:215], v[44:47], a[68:71], v[212:215]
    ds_read_b64_tr_b16 v[78:79], v19 offset:41984
    v_mfma_f32_16x16x32_bf16 v[208:211], v[44:47], a[64:67], v[208:211]
    s_waitcnt lgkmcnt(8)
    v_mfma_f32_16x16x32_bf16 v[96:99], v[48:51], a[64:67], v[96:99]
    ds_read_b64_tr_b16 v[80:81], v20 offset:40960
    v_mfma_f32_16x16x32_bf16 v[100:103], v[48:51], a[68:71], v[100:103]
    buffer_load_dwordx4 a[116:119], v224, s[8:11], s55 offen offset:3072 sc1
    v_mfma_f32_16x16x32_bf16 v[104:107], v[48:51], a[72:75], v[104:107]
    ds_read_b64_tr_b16 v[82:83], v20 offset:41984
    v_mfma_f32_16x16x32_bf16 v[108:111], v[48:51], a[76:79], v[108:111]
    v_mfma_f32_16x16x32_bf16 v[124:127], v[52:55], a[76:79], v[124:127]
    ds_read_b64_tr_b16 v[84:85], v21 offset:40960
    v_mfma_f32_16x16x32_bf16 v[120:123], v[52:55], a[72:75], v[120:123]
    v_mfma_f32_16x16x32_bf16 v[116:119], v[52:55], a[68:71], v[116:119]
    ds_read_b64_tr_b16 v[86:87], v21 offset:41984
    v_mfma_f32_16x16x32_bf16 v[112:115], v[52:55], a[64:67], v[112:115]
    buffer_load_dwordx4 a[120:123], v225, s[8:11], s55 offen offset:3072 sc1
    v_mfma_f32_16x16x32_bf16 v[128:131], v[56:59], a[64:67], v[128:131]
    ds_read_b64_tr_b16 v[88:89], v22 offset:40960
    v_mfma_f32_16x16x32_bf16 v[132:135], v[56:59], a[68:71], v[132:135]
    v_mfma_f32_16x16x32_bf16 v[136:139], v[56:59], a[72:75], v[136:139]
    ds_read_b64_tr_b16 v[90:91], v22 offset:41984
    v_mfma_f32_16x16x32_bf16 v[140:143], v[56:59], a[76:79], v[140:143]
    buffer_load_dwordx4 a[124:127], v226, s[8:11], s55 offen offset:3072 sc1
    v_mfma_f32_16x16x32_bf16 v[156:159], v[60:63], a[76:79], v[156:159]
    ds_read_b64_tr_b16 v[92:93], v23 offset:40960
    v_mfma_f32_16x16x32_bf16 v[152:155], v[60:63], a[72:75], v[152:155]
    s_add_u32 s55, s55, 4096
    v_mfma_f32_16x16x32_bf16 v[148:151], v[60:63], a[68:71], v[148:151]
    ds_read_b64_tr_b16 v[94:95], v23 offset:41984
    v_mfma_f32_16x16x32_bf16 v[144:147], v[60:63], a[64:67], v[144:147]
    s_waitcnt vmcnt(12) lgkmcnt(8)
    v_mfma_f32_16x16x32_bf16 v[160:163], v[64:67], a[80:83], v[160:163]
    ds_read_b64_tr_b16 v[32:33], v16 offset:49152
    v_mfma_f32_16x16x32_bf16 v[164:167], v[64:67], a[84:87], v[164:167]
    s_add_u32 m0, s47, 40960
    v_mfma_f32_16x16x32_bf16 v[168:171], v[64:67], a[88:91], v[168:171]
    ds_read_b64_tr_b16 v[34:35], v16 offset:50176
    v_mfma_f32_16x16x32_bf16 v[172:175], v[64:67], a[92:95], v[172:175]
    buffer_load_dwordx4 v7, s[12:15], s54 offen lds
    v_mfma_f32_16x16x32_bf16 v[188:191], v[68:71], a[92:95], v[188:191]
    ds_read_b64_tr_b16 v[36:37], v17 offset:49152
    v_mfma_f32_16x16x32_bf16 v[184:187], v[68:71], a[88:91], v[184:187]
    v_mfma_f32_16x16x32_bf16 v[180:183], v[68:71], a[84:87], v[180:183]
    ds_read_b64_tr_b16 v[38:39], v17 offset:50176
    v_mfma_f32_16x16x32_bf16 v[176:179], v[68:71], a[80:83], v[176:179]
    buffer_load_dwordx4 v8, s[12:15], s54 offen offset:1024 lds
    v_mfma_f32_16x16x32_bf16 v[192:195], v[72:75], a[80:83], v[192:195]
    ds_read_b64_tr_b16 v[40:41], v18 offset:49152
    v_mfma_f32_16x16x32_bf16 v[196:199], v[72:75], a[84:87], v[196:199]
    s_add_u32 s54, s54, 229376
    v_mfma_f32_16x16x32_bf16 v[200:203], v[72:75], a[88:91], v[200:203]
    ds_read_b64_tr_b16 v[42:43], v18 offset:50176
    v_mfma_f32_16x16x32_bf16 v[204:207], v[72:75], a[92:95], v[204:207]
    v_mfma_f32_16x16x32_bf16 v[220:223], v[76:79], a[92:95], v[220:223]
    ds_read_b64_tr_b16 v[44:45], v19 offset:49152
    v_mfma_f32_16x16x32_bf16 v[216:219], v[76:79], a[88:91], v[216:219]
    buffer_load_dwordx4 a[0:3], v2, s[8:11], s55 offen offset:0 sc1
    v_mfma_f32_16x16x32_bf16 v[212:215], v[76:79], a[84:87], v[212:215]
    ds_read_b64_tr_b16 v[46:47], v19 offset:50176
    v_mfma_f32_16x16x32_bf16 v[208:211], v[76:79], a[80:83], v[208:211]
    s_waitcnt lgkmcnt(8)
    v_mfma_f32_16x16x32_bf16 v[96:99], v[80:83], a[80:83], v[96:99]
    ds_read_b64_tr_b16 v[48:49], v20 offset:49152
    v_mfma_f32_16x16x32_bf16 v[100:103], v[80:83], a[84:87], v[100:103]
    buffer_load_dwordx4 a[4:7], v224, s[8:11], s55 offen offset:0 sc1
    v_mfma_f32_16x16x32_bf16 v[104:107], v[80:83], a[88:91], v[104:107]
    ds_read_b64_tr_b16 v[50:51], v20 offset:50176
    v_mfma_f32_16x16x32_bf16 v[108:111], v[80:83], a[92:95], v[108:111]
    v_mfma_f32_16x16x32_bf16 v[124:127], v[84:87], a[92:95], v[124:127]
    ds_read_b64_tr_b16 v[52:53], v21 offset:49152
    v_mfma_f32_16x16x32_bf16 v[120:123], v[84:87], a[88:91], v[120:123]
    v_mfma_f32_16x16x32_bf16 v[116:119], v[84:87], a[84:87], v[116:119]
    ds_read_b64_tr_b16 v[54:55], v21 offset:50176
    v_mfma_f32_16x16x32_bf16 v[112:115], v[84:87], a[80:83], v[112:115]
    buffer_load_dwordx4 a[8:11], v225, s[8:11], s55 offen offset:0 sc1
    v_mfma_f32_16x16x32_bf16 v[128:131], v[88:91], a[80:83], v[128:131]
    ds_read_b64_tr_b16 v[56:57], v22 offset:49152
    v_mfma_f32_16x16x32_bf16 v[132:135], v[88:91], a[84:87], v[132:135]
    v_mfma_f32_16x16x32_bf16 v[136:139], v[88:91], a[88:91], v[136:139]
    ds_read_b64_tr_b16 v[58:59], v22 offset:50176
    v_mfma_f32_16x16x32_bf16 v[140:143], v[88:91], a[92:95], v[140:143]
    buffer_load_dwordx4 a[12:15], v226, s[8:11], s55 offen offset:0 sc1
    v_mfma_f32_16x16x32_bf16 v[156:159], v[92:95], a[92:95], v[156:159]
    ds_read_b64_tr_b16 v[60:61], v23 offset:49152
    v_mfma_f32_16x16x32_bf16 v[152:155], v[92:95], a[88:91], v[152:155]
    v_mfma_f32_16x16x32_bf16 v[148:151], v[92:95], a[84:87], v[148:151]
    ds_read_b64_tr_b16 v[62:63], v23 offset:50176
    v_mfma_f32_16x16x32_bf16 v[144:147], v[92:95], a[80:83], v[144:147]
    s_waitcnt vmcnt(12) lgkmcnt(8)
    v_mfma_f32_16x16x32_bf16 v[160:163], v[32:35], a[96:99], v[160:163]
    ds_read_b64_tr_b16 v[64:65], v16 offset:57344
    v_mfma_f32_16x16x32_bf16 v[164:167], v[32:35], a[100:103], v[164:167]
    s_add_u32 m0, s47, 49152
    v_mfma_f32_16x16x32_bf16 v[168:171], v[32:35], a[104:107], v[168:171]
    ds_read_b64_tr_b16 v[66:67], v16 offset:58368
    v_mfma_f32_16x16x32_bf16 v[172:175], v[32:35], a[108:111], v[172:175]
    buffer_load_dwordx4 v7, s[12:15], s54 offen lds
    v_mfma_f32_16x16x32_bf16 v[188:191], v[36:39], a[108:111], v[188:191]
    ds_read_b64_tr_b16 v[68:69], v17 offset:57344
    v_mfma_f32_16x16x32_bf16 v[184:187], v[36:39], a[104:107], v[184:187]
    v_mfma_f32_16x16x32_bf16 v[180:183], v[36:39], a[100:103], v[180:183]
    ds_read_b64_tr_b16 v[70:71], v17 offset:58368
    v_mfma_f32_16x16x32_bf16 v[176:179], v[36:39], a[96:99], v[176:179]
    buffer_load_dwordx4 v8, s[12:15], s54 offen offset:1024 lds
    v_mfma_f32_16x16x32_bf16 v[192:195], v[40:43], a[96:99], v[192:195]
    ds_read_b64_tr_b16 v[72:73], v18 offset:57344
    v_mfma_f32_16x16x32_bf16 v[196:199], v[40:43], a[100:103], v[196:199]
    s_add_u32 s54, s54, 229376
    v_mfma_f32_16x16x32_bf16 v[200:203], v[40:43], a[104:107], v[200:203]
    ds_read_b64_tr_b16 v[74:75], v18 offset:58368
    v_mfma_f32_16x16x32_bf16 v[204:207], v[40:43], a[108:111], v[204:207]
    v_mfma_f32_16x16x32_bf16 v[220:223], v[44:47], a[108:111], v[220:223]
    ds_read_b64_tr_b16 v[76:77], v19 offset:57344
    v_mfma_f32_16x16x32_bf16 v[216:219], v[44:47], a[104:107], v[216:219]
    buffer_load_dwordx4 a[16:19], v2, s[8:11], s55 offen offset:1024 sc1
    v_mfma_f32_16x16x32_bf16 v[212:215], v[44:47], a[100:103], v[212:215]
    ds_read_b64_tr_b16 v[78:79], v19 offset:58368
    v_mfma_f32_16x16x32_bf16 v[208:211], v[44:47], a[96:99], v[208:211]
    s_waitcnt lgkmcnt(8)
    v_mfma_f32_16x16x32_bf16 v[96:99], v[48:51], a[96:99], v[96:99]
    ds_read_b64_tr_b16 v[80:81], v20 offset:57344
    v_mfma_f32_16x16x32_bf16 v[100:103], v[48:51], a[100:103], v[100:103]
    buffer_load_dwordx4 a[20:23], v224, s[8:11], s55 offen offset:1024 sc1
    v_mfma_f32_16x16x32_bf16 v[104:107], v[48:51], a[104:107], v[104:107]
    ds_read_b64_tr_b16 v[82:83], v20 offset:58368
    v_mfma_f32_16x16x32_bf16 v[108:111], v[48:51], a[108:111], v[108:111]
    v_mfma_f32_16x16x32_bf16 v[124:127], v[52:55], a[108:111], v[124:127]
    ds_read_b64_tr_b16 v[84:85], v21 offset:57344
    v_mfma_f32_16x16x32_bf16 v[120:123], v[52:55], a[104:107], v[120:123]
    v_mfma_f32_16x16x32_bf16 v[116:119], v[52:55], a[100:103], v[116:119]
    ds_read_b64_tr_b16 v[86:87], v21 offset:58368
    v_mfma_f32_16x16x32_bf16 v[112:115], v[52:55], a[96:99], v[112:115]
    buffer_load_dwordx4 a[24:27], v225, s[8:11], s55 offen offset:1024 sc1
    v_mfma_f32_16x16x32_bf16 v[128:131], v[56:59], a[96:99], v[128:131]
    ds_read_b64_tr_b16 v[88:89], v22 offset:57344
    v_mfma_f32_16x16x32_bf16 v[132:135], v[56:59], a[100:103], v[132:135]
    v_mfma_f32_16x16x32_bf16 v[136:139], v[56:59], a[104:107], v[136:139]
    ds_read_b64_tr_b16 v[90:91], v22 offset:58368
    v_mfma_f32_16x16x32_bf16 v[140:143], v[56:59], a[108:111], v[140:143]
    buffer_load_dwordx4 a[28:31], v226, s[8:11], s55 offen offset:1024 sc1
    v_mfma_f32_16x16x32_bf16 v[156:159], v[60:63], a[108:111], v[156:159]
    ds_read_b64_tr_b16 v[92:93], v23 offset:57344
    v_mfma_f32_16x16x32_bf16 v[152:155], v[60:63], a[104:107], v[152:155]
    v_mfma_f32_16x16x32_bf16 v[148:151], v[60:63], a[100:103], v[148:151]
    ds_read_b64_tr_b16 v[94:95], v23 offset:58368
    v_mfma_f32_16x16x32_bf16 v[144:147], v[60:63], a[96:99], v[144:147]
    s_waitcnt vmcnt(12)
    s_barrier
    s_waitcnt lgkmcnt(8)
    v_mfma_f32_16x16x32_bf16 v[160:163], v[64:67], a[112:115], v[160:163]
    v_xor_b32 v16, 0x10000, v16
    ds_read_b64_tr_b16 v[32:33], v16 offset:0
    v_mfma_f32_16x16x32_bf16 v[164:167], v[64:67], a[116:119], v[164:167]
    s_add_u32 m0, s47, 57344
    v_mfma_f32_16x16x32_bf16 v[168:171], v[64:67], a[120:123], v[168:171]
    ds_read_b64_tr_b16 v[34:35], v16 offset:1024
    v_mfma_f32_16x16x32_bf16 v[172:175], v[64:67], a[124:127], v[172:175]
    buffer_load_dwordx4 v7, s[12:15], s54 offen lds
    v_mfma_f32_16x16x32_bf16 v[188:191], v[68:71], a[124:127], v[188:191]
    v_xor_b32 v17, 0x10000, v17
    ds_read_b64_tr_b16 v[36:37], v17 offset:0
    v_mfma_f32_16x16x32_bf16 v[184:187], v[68:71], a[120:123], v[184:187]
    v_mfma_f32_16x16x32_bf16 v[180:183], v[68:71], a[116:119], v[180:183]
    ds_read_b64_tr_b16 v[38:39], v17 offset:1024
    v_mfma_f32_16x16x32_bf16 v[176:179], v[68:71], a[112:115], v[176:179]
    buffer_load_dwordx4 v8, s[12:15], s54 offen offset:1024 lds
    v_mfma_f32_16x16x32_bf16 v[192:195], v[72:75], a[112:115], v[192:195]
    v_xor_b32 v18, 0x10000, v18
    ds_read_b64_tr_b16 v[40:41], v18 offset:0
    v_mfma_f32_16x16x32_bf16 v[196:199], v[72:75], a[116:119], v[196:199]
    s_add_u32 s54, s54, 229376
    v_mfma_f32_16x16x32_bf16 v[200:203], v[72:75], a[120:123], v[200:203]
    ds_read_b64_tr_b16 v[42:43], v18 offset:1024
    v_mfma_f32_16x16x32_bf16 v[204:207], v[72:75], a[124:127], v[204:207]
    s_xor_b32 s46, s46, 0x10000
    v_mfma_f32_16x16x32_bf16 v[220:223], v[76:79], a[124:127], v[220:223]
    v_xor_b32 v19, 0x10000, v19
    ds_read_b64_tr_b16 v[44:45], v19 offset:0
    v_mfma_f32_16x16x32_bf16 v[216:219], v[76:79], a[120:123], v[216:219]
    buffer_load_dwordx4 a[32:35], v2, s[8:11], s55 offen offset:2048 sc1
    v_mfma_f32_16x16x32_bf16 v[212:215], v[76:79], a[116:119], v[212:215]
    ds_read_b64_tr_b16 v[46:47], v19 offset:1024
    v_mfma_f32_16x16x32_bf16 v[208:211], v[76:79], a[112:115], v[208:211]
    s_waitcnt lgkmcnt(8)
    v_mfma_f32_16x16x32_bf16 v[96:99], v[80:83], a[112:115], v[96:99]
    v_xor_b32 v20, 0x10000, v20
    ds_read_b64_tr_b16 v[48:49], v20 offset:0
    v_mfma_f32_16x16x32_bf16 v[100:103], v[80:83], a[116:119], v[100:103]
    buffer_load_dwordx4 a[36:39], v224, s[8:11], s55 offen offset:2048 sc1
    v_mfma_f32_16x16x32_bf16 v[104:107], v[80:83], a[120:123], v[104:107]
    ds_read_b64_tr_b16 v[50:51], v20 offset:1024
    v_mfma_f32_16x16x32_bf16 v[108:111], v[80:83], a[124:127], v[108:111]
    s_xor_b32 s47, s47, 0x10000
    v_mfma_f32_16x16x32_bf16 v[124:127], v[84:87], a[124:127], v[124:127]
    v_xor_b32 v21, 0x10000, v21
    ds_read_b64_tr_b16 v[52:53], v21 offset:0
    v_mfma_f32_16x16x32_bf16 v[120:123], v[84:87], a[120:123], v[120:123]
    v_mfma_f32_16x16x32_bf16 v[116:119], v[84:87], a[116:119], v[116:119]
    ds_read_b64_tr_b16 v[54:55], v21 offset:1024
    v_mfma_f32_16x16x32_bf16 v[112:115], v[84:87], a[112:115], v[112:115]
    buffer_load_dwordx4 a[40:43], v225, s[8:11], s55 offen offset:2048 sc1
    v_mfma_f32_16x16x32_bf16 v[128:131], v[88:91], a[112:115], v[128:131]
    v_xor_b32 v22, 0x10000, v22
    ds_read_b64_tr_b16 v[56:57], v22 offset:0
    v_mfma_f32_16x16x32_bf16 v[132:135], v[88:91], a[116:119], v[132:135]
    v_mfma_f32_16x16x32_bf16 v[136:139], v[88:91], a[120:123], v[136:139]
    ds_read_b64_tr_b16 v[58:59], v22 offset:1024
    v_mfma_f32_16x16x32_bf16 v[140:143], v[88:91], a[124:127], v[140:143]
    buffer_load_dwordx4 a[44:47], v226, s[8:11], s55 offen offset:2048 sc1
    v_mfma_f32_16x16x32_bf16 v[156:159], v[92:95], a[124:127], v[156:159]
    v_xor_b32 v23, 0x10000, v23
    ds_read_b64_tr_b16 v[60:61], v23 offset:0
    v_mfma_f32_16x16x32_bf16 v[152:155], v[92:95], a[120:123], v[152:155]
    v_mfma_f32_16x16x32_bf16 v[148:151], v[92:95], a[116:119], v[148:151]
    ds_read_b64_tr_b16 v[62:63], v23 offset:1024
    v_mfma_f32_16x16x32_bf16 v[144:147], v[92:95], a[112:115], v[144:147]
    s_sub_u32 s45, s45, 1
    s_cmp_lg_u32 s45, 0
    s_cbranch_scc1 L_g1_loop
    s_waitcnt vmcnt(12) lgkmcnt(8)
    v_mfma_f32_16x16x32_bf16 v[160:163], v[32:35], a[0:3], v[160:163]
    ds_read_b64_tr_b16 v[64:65], v16 offset:8192
    v_mfma_f32_16x16x32_bf16 v[164:167], v[32:35], a[4:7], v[164:167]
    buffer_load_dwordx4 a[48:51], v2, s[8:11], s55 offen offset:3072 sc1
    v_mfma_f32_16x16x32_bf16 v[168:171], v[32:35], a[8:11], v[168:171]
    ds_read_b64_tr_b16 v[66:67], v16 offset:9216
    v_mfma_f32_16x16x32_bf16 v[172:175], v[32:35], a[12:15], v[172:175]
    v_mfma_f32_16x16x32_bf16 v[188:191], v[36:39], a[12:15], v[188:191]
    ds_read_b64_tr_b16 v[68:69], v17 offset:8192
    v_mfma_f32_16x16x32_bf16 v[184:187], v[36:39], a[8:11], v[184:187]
    buffer_load_dwordx4 a[52:55], v224, s[8:11], s55 offen offset:3072 sc1
    v_mfma_f32_16x16x32_bf16 v[180:183], v[36:39], a[4:7], v[180:183]
    ds_read_b64_tr_b16 v[70:71], v17 offset:9216
    v_mfma_f32_16x16x32_bf16 v[176:179], v[36:39], a[0:3], v[176:179]
    v_mfma_f32_16x16x32_bf16 v[192:195], v[40:43], a[0:3], v[192:195]
    ds_read_b64_tr_b16 v[72:73], v18 offset:8192
    v_mfma_f32_16x16x32_bf16 v[196:199], v[40:43], a[4:7], v[196:199]
    buffer_load_dwordx4 a[56:59], v225, s[8:11], s55 offen offset:3072 sc1
    v_mfma_f32_16x16x32_bf16 v[200:203], v[40:43], a[8:11], v[200:203]
    ds_read_b64_tr_b16 v[74:75], v18 offset:9216
    v_mfma_f32_16x16x32_bf16 v[204:207], v[40:43], a[12:15], v[204:207]
    v_mfma_f32_16x16x32_bf16 v[220:223], v[44:47], a[12:15], v[220:223]
    ds_read_b64_tr_b16 v[76:77], v19 offset:8192
    v_mfma_f32_16x16x32_bf16 v[216:219], v[44:47], a[8:11], v[216:219]
    v_mfma_f32_16x16x32_bf16 v[212:215], v[44:47], a[4:7], v[212:215]
    ds_read_b64_tr_b16 v[78:79], v19 offset:9216
    v_mfma_f32_16x16x32_bf16 v[208:211], v[44:47], a[0:3], v[208:211]
    buffer_load_dwordx4 a[60:63], v226, s[8:11], s55 offen offset:3072 sc1
    s_waitcnt lgkmcnt(8)
    v_mfma_f32_16x16x32_bf16 v[96:99], v[48:51], a[0:3], v[96:99]
    ds_read_b64_tr_b16 v[80:81], v20 offset:8192
    v_mfma_f32_16x16x32_bf16 v[100:103], v[48:51], a[4:7], v[100:103]
    s_add_u32 s55, s55, 4096
    v_mfma_f32_16x16x32_bf16 v[104:107], v[48:51], a[8:11], v[104:107]
    ds_read_b64_tr_b16 v[82:83], v20 offset:9216
    v_mfma_f32_16x16x32_bf16 v[108:111], v[48:51], a[12:15], v[108:111]
    buffer_load_dwordx4 a[64:67], v2, s[8:11], s55 offen offset:0 sc1
    v_mfma_f32_16x16x32_bf16 v[124:127], v[52:55], a[12:15], v[124:127]
    ds_read_b64_tr_b16 v[84:85], v21 offset:8192
    v_mfma_f32_16x16x32_bf16 v[120:123], v[52:55], a[8:11], v[120:123]
    v_mfma_f32_16x16x32_bf16 v[116:119], v[52:55], a[4:7], v[116:119]
    ds_read_b64_tr_b16 v[86:87], v21 offset:9216
    v_mfma_f32_16x16x32_bf16 v[112:115], v[52:55], a[0:3], v[112:115]
    buffer_load_dwordx4 a[68:71], v224, s[8:11], s55 offen offset:0 sc1
    v_mfma_f32_16x16x32_bf16 v[128:131], v[56:59], a[0:3], v[128:131]
    ds_read_b64_tr_b16 v[88:89], v22 offset:8192
    v_mfma_f32_16x16x32_bf16 v[132:135], v[56:59], a[4:7], v[132:135]
    v_mfma_f32_16x16x32_bf16 v[136:139], v[56:59], a[8:11], v[136:139]
    ds_read_b64_tr_b16 v[90:91], v22 offset:9216
    v_mfma_f32_16x16x32_bf16 v[140:143], v[56:59], a[12:15], v[140:143]
    buffer_load_dwordx4 a[72:75], v225, s[8:11], s55 offen offset:0 sc1
    v_mfma_f32_16x16x32_bf16 v[156:159], v[60:63], a[12:15], v[156:159]
    ds_read_b64_tr_b16 v[92:93], v23 offset:8192
    v_mfma_f32_16x16x32_bf16 v[152:155], v[60:63], a[8:11], v[152:155]
    v_mfma_f32_16x16x32_bf16 v[148:151], v[60:63], a[4:7], v[148:151]
    ds_read_b64_tr_b16 v[94:95], v23 offset:9216
    v_mfma_f32_16x16x32_bf16 v[144:147], v[60:63], a[0:3], v[144:147]
    buffer_load_dword v249, v227, s[8:11], s88 offen sc1
    s_waitcnt vmcnt(14) lgkmcnt(8)
    v_mfma_f32_16x16x32_bf16 v[160:163], v[64:67], a[16:19], v[160:163]
    ds_read_b64_tr_b16 v[32:33], v16 offset:16384
    v_mfma_f32_16x16x32_bf16 v[164:167], v[64:67], a[20:23], v[164:167]
    buffer_load_dwordx4 a[76:79], v226, s[8:11], s55 offen offset:0 sc1
    v_mfma_f32_16x16x32_bf16 v[168:171], v[64:67], a[24:27], v[168:171]
    ds_read_b64_tr_b16 v[34:35], v16 offset:17408
    v_mfma_f32_16x16x32_bf16 v[172:175], v[64:67], a[28:31], v[172:175]
    v_mfma_f32_16x16x32_bf16 v[188:191], v[68:71], a[28:31], v[188:191]
    ds_read_b64_tr_b16 v[36:37], v17 offset:16384
    v_mfma_f32_16x16x32_bf16 v[184:187], v[68:71], a[24:27], v[184:187]
    buffer_load_dwordx4 a[80:83], v2, s[8:11], s55 offen offset:1024 sc1
    v_mfma_f32_16x16x32_bf16 v[180:183], v[68:71], a[20:23], v[180:183]
    ds_read_b64_tr_b16 v[38:39], v17 offset:17408
    v_mfma_f32_16x16x32_bf16 v[176:179], v[68:71], a[16:19], v[176:179]
    v_mfma_f32_16x16x32_bf16 v[192:195], v[72:75], a[16:19], v[192:195]
    ds_read_b64_tr_b16 v[40:41], v18 offset:16384
    v_mfma_f32_16x16x32_bf16 v[196:199], v[72:75], a[20:23], v[196:199]
    buffer_load_dwordx4 a[84:87], v224, s[8:11], s55 offen offset:1024 sc1
    v_mfma_f32_16x16x32_bf16 v[200:203], v[72:75], a[24:27], v[200:203]
    ds_read_b64_tr_b16 v[42:43], v18 offset:17408
    v_mfma_f32_16x16x32_bf16 v[204:207], v[72:75], a[28:31], v[204:207]
    v_mfma_f32_16x16x32_bf16 v[220:223], v[76:79], a[28:31], v[220:223]
    ds_read_b64_tr_b16 v[44:45], v19 offset:16384
    v_mfma_f32_16x16x32_bf16 v[216:219], v[76:79], a[24:27], v[216:219]
    v_mfma_f32_16x16x32_bf16 v[212:215], v[76:79], a[20:23], v[212:215]
    ds_read_b64_tr_b16 v[46:47], v19 offset:17408
    v_mfma_f32_16x16x32_bf16 v[208:211], v[76:79], a[16:19], v[208:211]
    buffer_load_dwordx4 a[88:91], v225, s[8:11], s55 offen offset:1024 sc1
    s_waitcnt lgkmcnt(8)
    v_mfma_f32_16x16x32_bf16 v[96:99], v[80:83], a[16:19], v[96:99]
    ds_read_b64_tr_b16 v[48:49], v20 offset:16384
    v_mfma_f32_16x16x32_bf16 v[100:103], v[80:83], a[20:23], v[100:103]
    v_mfma_f32_16x16x32_bf16 v[104:107], v[80:83], a[24:27], v[104:107]
    ds_read_b64_tr_b16 v[50:51], v20 offset:17408
    v_mfma_f32_16x16x32_bf16 v[108:111], v[80:83], a[28:31], v[108:111]
    buffer_load_dwordx4 a[92:95], v226, s[8:11], s55 offen offset:1024 sc1
    v_mfma_f32_16x16x32_bf16 v[124:127], v[84:87], a[28:31], v[124:127]
    ds_read_b64_tr_b16 v[52:53], v21 offset:16384
    v_mfma_f32_16x16x32_bf16 v[120:123], v[84:87], a[24:27], v[120:123]
    v_mfma_f32_16x16x32_bf16 v[116:119], v[84:87], a[20:23], v[116:119]
    ds_read_b64_tr_b16 v[54:55], v21 offset:17408
    v_mfma_f32_16x16x32_bf16 v[112:115], v[84:87], a[16:19], v[112:115]
    buffer_load_dwordx4 a[96:99], v2, s[8:11], s55 offen offset:2048 sc1
    v_mfma_f32_16x16x32_bf16 v[128:131], v[88:91], a[16:19], v[128:131]
    ds_read_b64_tr_b16 v[56:57], v22 offset:16384
    v_mfma_f32_16x16x32_bf16 v[132:135], v[88:91], a[20:23], v[132:135]
    v_mfma_f32_16x16x32_bf16 v[136:139], v[88:91], a[24:27], v[136:139]
    ds_read_b64_tr_b16 v[58:59], v22 offset:17408
    v_mfma_f32_16x16x32_bf16 v[140:143], v[88:91], a[28:31], v[140:143]
    buffer_load_dwordx4 a[100:103], v224, s[8:11], s55 offen offset:2048 sc1
    v_mfma_f32_16x16x32_bf16 v[156:159], v[92:95], a[28:31], v[156:159]
    ds_read_b64_tr_b16 v[60:61], v23 offset:16384
    v_mfma_f32_16x16x32_bf16 v[152:155], v[92:95], a[24:27], v[152:155]
    v_mfma_f32_16x16x32_bf16 v[148:151], v[92:95], a[20:23], v[148:151]
    ds_read_b64_tr_b16 v[62:63], v23 offset:17408
    v_mfma_f32_16x16x32_bf16 v[144:147], v[92:95], a[16:19], v[144:147]
    s_waitcnt vmcnt(15) lgkmcnt(8)
    v_mfma_f32_16x16x32_bf16 v[160:163], v[32:35], a[32:35], v[160:163]
    ds_read_b64_tr_b16 v[64:65], v16 offset:24576
    v_mfma_f32_16x16x32_bf16 v[164:167], v[32:35], a[36:39], v[164:167]
    buffer_load_dwordx4 a[104:107], v225, s[8:11], s55 offen offset:2048 sc1
    v_mfma_f32_16x16x32_bf16 v[168:171], v[32:35], a[40:43], v[168:171]
    ds_read_b64_tr_b16 v[66:67], v16 offset:25600
    v_mfma_f32_16x16x32_bf16 v[172:175], v[32:35], a[44:47], v[172:175]
    v_mfma_f32_16x16x32_bf16 v[188:191], v[36:39], a[44:47], v[188:191]
    ds_read_b64_tr_b16 v[68:69], v17 offset:24576
    v_mfma_f32_16x16x32_bf16 v[184:187], v[36:39], a[40:43], v[184:187]
    buffer_load_dwordx4 a[108:111], v226, s[8:11], s55 offen offset:2048 sc1
    v_mfma_f32_16x16x32_bf16 v[180:183], v[36:39], a[36:39], v[180:183]
    ds_read_b64_tr_b16 v[70:71], v17 offset:25600
    v_mfma_f32_16x16x32_bf16 v[176:179], v[36:39], a[32:35], v[176:179]
    v_mfma_f32_16x16x32_bf16 v[192:195], v[40:43], a[32:35], v[192:195]
    ds_read_b64_tr_b16 v[72:73], v18 offset:24576
    v_mfma_f32_16x16x32_bf16 v[196:199], v[40:43], a[36:39], v[196:199]
    buffer_load_dwordx4 a[112:115], v2, s[8:11], s55 offen offset:3072 sc1
    v_mfma_f32_16x16x32_bf16 v[200:203], v[40:43], a[40:43], v[200:203]
    ds_read_b64_tr_b16 v[74:75], v18 offset:25600
    v_mfma_f32_16x16x32_bf16 v[204:207], v[40:43], a[44:47], v[204:207]
    v_mfma_f32_16x16x32_bf16 v[220:223], v[44:47], a[44:47], v[220:223]
    ds_read_b64_tr_b16 v[76:77], v19 offset:24576
    v_mfma_f32_16x16x32_bf16 v[216:219], v[44:47], a[40:43], v[216:219]
    v_mfma_f32_16x16x32_bf16 v[212:215], v[44:47], a[36:39], v[212:215]
    ds_read_b64_tr_b16 v[78:79], v19 offset:25600
    v_mfma_f32_16x16x32_bf16 v[208:211], v[44:47], a[32:35], v[208:211]
    buffer_load_dwordx4 a[116:119], v224, s[8:11], s55 offen offset:3072 sc1
    s_waitcnt lgkmcnt(8)
    v_mfma_f32_16x16x32_bf16 v[96:99], v[48:51], a[32:35], v[96:99]
    ds_read_b64_tr_b16 v[80:81], v20 offset:24576
    v_mfma_f32_16x16x32_bf16 v[100:103], v[48:51], a[36:39], v[100:103]
    v_mfma_f32_16x16x32_bf16 v[104:107], v[48:51], a[40:43], v[104:107]
    ds_read_b64_tr_b16 v[82:83], v20 offset:25600
    v_mfma_f32_16x16x32_bf16 v[108:111], v[48:51], a[44:47], v[108:111]
    buffer_load_dwordx4 a[120:123], v225, s[8:11], s55 offen offset:3072 sc1
    v_mfma_f32_16x16x32_bf16 v[124:127], v[52:55], a[44:47], v[124:127]
    ds_read_b64_tr_b16 v[84:85], v21 offset:24576
    v_mfma_f32_16x16x32_bf16 v[120:123], v[52:55], a[40:43], v[120:123]
    v_mfma_f32_16x16x32_bf16 v[116:119], v[52:55], a[36:39], v[116:119]
    ds_read_b64_tr_b16 v[86:87], v21 offset:25600
    v_mfma_f32_16x16x32_bf16 v[112:115], v[52:55], a[32:35], v[112:115]
    buffer_load_dwordx4 a[124:127], v226, s[8:11], s55 offen offset:3072 sc1
    v_mfma_f32_16x16x32_bf16 v[128:131], v[56:59], a[32:35], v[128:131]
    ds_read_b64_tr_b16 v[88:89], v22 offset:24576
    v_mfma_f32_16x16x32_bf16 v[132:135], v[56:59], a[36:39], v[132:135]
    v_mfma_f32_16x16x32_bf16 v[136:139], v[56:59], a[40:43], v[136:139]
    ds_read_b64_tr_b16 v[90:91], v22 offset:25600
    v_mfma_f32_16x16x32_bf16 v[140:143], v[56:59], a[44:47], v[140:143]
    v_mfma_f32_16x16x32_bf16 v[156:159], v[60:63], a[44:47], v[156:159]
    ds_read_b64_tr_b16 v[92:93], v23 offset:24576
    v_mfma_f32_16x16x32_bf16 v[152:155], v[60:63], a[40:43], v[152:155]
    v_mfma_f32_16x16x32_bf16 v[148:151], v[60:63], a[36:39], v[148:151]
    ds_read_b64_tr_b16 v[94:95], v23 offset:25600
    v_mfma_f32_16x16x32_bf16 v[144:147], v[60:63], a[32:35], v[144:147]
    buffer_load_dword v252, v9, s[8:11], 0 offen offset:0 sc1
    s_waitcnt vmcnt(18)
    s_barrier
    s_waitcnt vmcnt(14)
    s_mov_b32 s3, 0x40000
L_gg_pollr:
    v_cmp_eq_u32 vcc, 0, v249
    s_nop 4
    s_cbranch_vccz L_gg_pollr_x
    buffer_load_dword v249, v227, s[8:11], s88 offen sc1
    s_sub_u32 s3, s3, 1
    s_waitcnt vmcnt(0)
    s_cmp_lg_u32 s3, 0
    s_cbranch_scc1 L_gg_pollr
L_gg_pollr_x:
    s_waitcnt lgkmcnt(8)
    v_mfma_f32_16x16x32_bf16 v[160:163], v[64:67], a[48:51], v[160:163]
    ds_read_b64_tr_b16 v[32:33], v16 offset:32768
    v_mfma_f32_16x16x32_bf16 v[164:167], v[64:67], a[52:55], v[164:167]
    v_lshlrev_b32 v230, 2, v1
    v_mfma_f32_16x16x32_bf16 v[168:171], v[64:67], a[56:59], v[168:171]
    ds_read_b64_tr_b16 v[34:35], v16 offset:33792
    v_mfma_f32_16x16x32_bf16 v[172:175], v[64:67], a[60:63], v[172:175]
    v_mfma_f32_16x16x32_bf16 v[188:191], v[68:71], a[60:63], v[188:191]
    ds_read_b64_tr_b16 v[36:37], v16 offset:40960
    v_mfma_f32_16x16x32_bf16 v[184:187], v[68:71], a[56:59], v[184:187]
    buffer_load_dword a128, v230, s[24:27], s63 offen
    v_mfma_f32_16x16x32_bf16 v[180:183], v[68:71], a[52:55], v[180:183]
    ds_read_b64_tr_b16 v[38:39], v16 offset:41984
    v_mfma_f32_16x16x32_bf16 v[176:179], v[68:71], a[48:51], v[176:179]
    v_mfma_f32_16x16x32_bf16 v[192:195], v[72:75], a[48:51], v[192:195]
    ds_read_b64_tr_b16 v[40:41], v16 offset:49152
    v_mfma_f32_16x16x32_bf16 v[196:199], v[72:75], a[52:55], v[196:199]
    v_lshlrev_b32 v231, 3, v4
    v_mfma_f32_16x16x32_bf16 v[200:203], v[72:75], a[56:59], v[200:203]
    ds_read_b64_tr_b16 v[42:43], v16 offset:50176
    v_mfma_f32_16x16x32_bf16 v[204:207], v[72:75], a[60:63], v[204:207]
    v_mfma_f32_16x16x32_bf16 v[220:223], v[76:79], a[60:63], v[220:223]
    ds_read_b64_tr_b16 v[44:45], v16 offset:57344
    v_mfma_f32_16x16x32_bf16 v[216:219], v[76:79], a[56:59], v[216:219]
    buffer_load_dword a144, v231, s[8:11], s43 offen offset:4 sc1
    v_mfma_f32_16x16x32_bf16 v[212:215], v[76:79], a[52:55], v[212:215]
    ds_read_b64_tr_b16 v[46:47], v16 offset:58368
    v_mfma_f32_16x16x32_bf16 v[208:211], v[76:79], a[48:51], v[208:211]
    s_waitcnt lgkmcnt(8)
    v_mfma_f32_16x16x32_bf16 v[96:99], v[80:83], a[48:51], v[96:99]
    ds_read_b64_tr_b16 v[48:49], v17 offset:32768
    v_mfma_f32_16x16x32_bf16 v[100:103], v[80:83], a[52:55], v[100:103]
    buffer_load_dwordx4 a[148:151], v2, s[8:11], s42 offen offset:0 sc1
    v_mfma_f32_16x16x32_bf16 v[104:107], v[80:83], a[56:59], v[104:107]
    ds_read_b64_tr_b16 v[50:51], v17 offset:33792
    v_mfma_f32_16x16x32_bf16 v[108:111], v[80:83], a[60:63], v[108:111]
    v_mfma_f32_16x16x32_bf16 v[124:127], v[84:87], a[60:63], v[124:127]
    ds_read_b64_tr_b16 v[52:53], v17 offset:40960
    v_mfma_f32_16x16x32_bf16 v[120:123], v[84:87], a[56:59], v[120:123]
    buffer_load_dwordx4 a[152:155], v2, s[8:11], s42 offen offset:1024 sc1
    v_mfma_f32_16x16x32_bf16 v[116:119], v[84:87], a[52:55], v[116:119]
    ds_read_b64_tr_b16 v[54:55], v17 offset:41984
    v_mfma_f32_16x16x32_bf16 v[112:115], v[84:87], a[48:51], v[112:115]
    v_mfma_f32_16x16x32_bf16 v[128:131], v[88:91], a[48:51], v[128:131]
    ds_read_b64_tr_b16 v[56:57], v17 offset:49152
    v_mfma_f32_16x16x32_bf16 v[132:135], v[88:91], a[52:55], v[132:135]
    buffer_load_dwordx4 a[156:159], v2, s[8:11], s42 offen offset:2048 sc1
    v_mfma_f32_16x16x32_bf16 v[136:139], v[88:91], a[56:59], v[136:139]
    ds_read_b64_tr_b16 v[58:59], v17 offset:50176
    v_mfma_f32_16x16x32_bf16 v[140:143], v[88:91], a[60:63], v[140:143]
    v_mfma_f32_16x16x32_bf16 v[156:159], v[92:95], a[60:63], v[156:159]
    ds_read_b64_tr_b16 v[60:61], v17 offset:57344
    v_mfma_f32_16x16x32_bf16 v[152:155], v[92:95], a[56:59], v[152:155]
    buffer_load_dwordx4 a[160:163], v2, s[8:11], s42 offen offset:3072 sc1
    v_mfma_f32_16x16x32_bf16 v[148:151], v[92:95], a[52:55], v[148:151]
    ds_read_b64_tr_b16 v[62:63], v17 offset:58368
    v_mfma_f32_16x16x32_bf16 v[144:147], v[92:95], a[48:51], v[144:147]
    buffer_load_dword v11, v253, s[96:99], 0 offen
    s_waitcnt vmcnt(6)
    s_mov_b32 s3, 0x40000
L_gg_pk1:
    v_cmp_gt_u32 vcc, s23, v252
    s_nop 4
    s_cbranch_vccz L_gg_pk1_x
    buffer_load_dword v252, v9, s[8:11], 0 offen offset:0 sc1
    s_sub_u32 s3, s3, 1
    s_waitcnt vmcnt(0)
    s_cmp_lg_u32 s3, 0
    s_cbranch_scc1 L_gg_pk1
L_gg_pk1_x:
    s_mov_b32 s54, s40
L_g1_epi:
    s_waitcnt lgkmcnt(8)
    v_mfma_f32_16x16x32_bf16 v[160:163], v[32:35], a[64:67], v[160:163]
    v_mfma_f32_16x16x32_bf16 v[164:167], v[32:35], a[68:71], v[164:167]
    s_add_u32 m0, s47, 0
    v_mfma_f32_16x16x32_bf16 v[168:171], v[32:35], a[72:75], v[168:171]
    v_mfma_f32_16x16x32_bf16 v[172:175], v[32:35], a[76:79], v[172:175]
    buffer_load_dwordx4 v2, s[8:11], s54 offen sc1 lds
    v_mfma_f32_16x16x32_bf16 v[172:175], v[36:39], a[92:95], v[172:175]
    v_mfma_f32_16x16x32_bf16 v[168:171], v[36:39], a[88:91], v[168:171]
    v_mfma_f32_16x16x32_bf16 v[164:167], v[36:39], a[84:87], v[164:167]
    v_mfma_f32_16x16x32_bf16 v[160:163], v[36:39], a[80:83], v[160:163]
    buffer_load_dwordx4 v2, s[8:11], s54 offen offset:1024 sc1 lds
    v_mfma_f32_16x16x32_bf16 v[160:163], v[40:43], a[96:99], v[160:163]
    v_mfma_f32_16x16x32_bf16 v[164:167], v[40:43], a[100:103], v[164:167]
    s_add_u32 s54, s54, 8192
    v_mfma_f32_16x16x32_bf16 v[168:171], v[40:43], a[104:107], v[168:171]
    v_mfma_f32_16x16x32_bf16 v[172:175], v[40:43], a[108:111], v[172:175]
    v_mfma_f32_16x16x32_bf16 v[172:175], v[44:47], a[124:127], v[172:175]
    v_mfma_f32_16x16x32_bf16 v[168:171], v[44:47], a[120:123], v[168:171]
    v_mfma_f32_16x16x32_bf16 v[164:167], v[44:47], a[116:119], v[164:167]
    v_mfma_f32_16x16x32_bf16 v[160:163], v[44:47], a[112:115], v[160:163]
    ds_read_b64_tr_b16 v[32:33], v18 offset:32768
    ds_read_b64_tr_b16 v[34:35], v18 offset:33792
    ds_read_b64_tr_b16 v[36:37], v18 offset:40960
    ds_read_b64_tr_b16 v[38:39], v18 offset:41984
    ds_read_b64_tr_b16 v[40:41], v18 offset:49152
    ds_read_b64_tr_b16 v[42:43], v18 offset:50176
    ds_read_b64_tr_b16 v[44:45], v18 offset:57344
    ds_read_b64_tr_b16 v[46:47], v18 offset:58368
    v_pk_mul_f32 v[224:225], v[160:161], v[160:161]
    v_pk_mul_f32 v[226:227], v[162:163], v[162:163]
    v_pk_mul_f32 v[228:229], v[164:165], v[164:165]
    v_pk_mul_f32 v[230:231], v[166:167], v[166:167]
    v_pk_fma_f32 v[224:225], v[224:225], v[232:233], v[232:233] op_sel:[0,0,1] op_sel_hi:[1,0,1]
    v_pk_fma_f32 v[226:227], v[226:227], v[232:233], v[232:233] op_sel:[0,0,1] op_sel_hi:[1,0,1]
    v_pk_fma_f32 v[228:229], v[228:229], v[236:237], v[236:237] op_sel:[0,0,1] op_sel_hi:[1,0,1]
    v_pk_fma_f32 v[230:231], v[230:231], v[236:237], v[236:237] op_sel:[0,0,1] op_sel_hi:[1,0,1]
    v_pk_mul_f32 v[224:225], v[224:225], v[160:161]
    v_pk_mul_f32 v[226:227], v[226:227], v[162:163]
    v_pk_mul_f32 v[228:229], v[228:229], v[164:165]
    v_pk_mul_f32 v[230:231], v[230:231], v[166:167]
    v_pk_mul_f32 v[88:89], v[168:169], v[168:169]
    v_pk_mul_f32 v[90:91], v[170:171], v[170:171]
    v_pk_mul_f32 v[92:93], v[172:173], v[172:173]
    v_pk_mul_f32 v[94:95], v[174:175], v[174:175]
    v_pk_fma_f32 v[88:89], v[88:89], v[240:241], v[240:241] op_sel:[0,0,1] op_sel_hi:[1,0,1]
    v_pk_fma_f32 v[90:91], v[90:91], v[240:241], v[240:241] op_sel:[0,0,1] op_sel_hi:[1,0,1]
    v_pk_fma_f32 v[92:93], v[92:93], v[244:245], v[244:245] op_sel:[0,0,1] op_sel_hi:[1,0,1]
    v_pk_fma_f32 v[94:95], v[94:95], v[244:245], v[244:245] op_sel:[0,0,1] op_sel_hi:[1,0,1]
    v_pk_mul_f32 v[88:89], v[88:89], v[168:169]
    v_pk_mul_f32 v[90:91], v[90:91], v[170:171]
    v_pk_mul_f32 v[92:93], v[92:93], v[172:173]
    v_pk_mul_f32 v[94:95], v[94:95], v[174:175]
    s_waitcnt lgkmcnt(8)
    v_mfma_f32_16x16x32_bf16 v[176:179], v[48:51], a[64:67], v[176:179]
    v_exp_f32 v224, v224
    v_mfma_f32_16x16x32_bf16 v[180:183], v[48:51], a[68:71], v[180:183]
    v_exp_f32 v225, v225
    s_add_u32 m0, s47, 8192
    v_mfma_f32_16x16x32_bf16 v[184:187], v[48:51], a[72:75], v[184:187]
    v_exp_f32 v226, v226
    v_mfma_f32_16x16x32_bf16 v[188:191], v[48:51], a[76:79], v[188:191]
    v_exp_f32 v227, v227
    buffer_load_dwordx4 v2, s[8:11], s54 offen sc1 lds
    v_mfma_f32_16x16x32_bf16 v[188:191], v[52:55], a[92:95], v[188:191]
    v_exp_f32 v228, v228
    v_mfma_f32_16x16x32_bf16 v[184:187], v[52:55], a[88:91], v[184:187]
    v_exp_f32 v229, v229
    v_mfma_f32_16x16x32_bf16 v[180:183], v[52:55], a[84:87], v[180:183]
    v_exp_f32 v230, v230
    v_mfma_f32_16x16x32_bf16 v[176:179], v[52:55], a[80:83], v[176:179]
    v_exp_f32 v231, v231
    buffer_load_dwordx4 v2, s[8:11], s54 offen offset:1024 sc1 lds
    v_mfma_f32_16x16x32_bf16 v[176:179], v[56:59], a[96:99], v[176:179]
    v_exp_f32 v88, v88
    v_mfma_f32_16x16x32_bf16 v[180:183], v[56:59], a[100:103], v[180:183]
    v_exp_f32 v89, v89
    s_add_u32 s54, s54, 8192
    v_mfma_f32_16x16x32_bf16 v[184:187], v[56:59], a[104:107], v[184:187]
    v_exp_f32 v90, v90
    v_mfma_f32_16x16x32_bf16 v[188:191], v[56:59], a[108:111], v[188:191]
    v_exp_f32 v91, v91
    v_mfma_f32_16x16x32_bf16 v[188:191], v[60:63], a[124:127], v[188:191]
    v_exp_f32 v92, v92
    v_mfma_f32_16x16x32_bf16 v[184:187], v[60:63], a[120:123], v[184:187]
    v_exp_f32 v93, v93
    v_mfma_f32_16x16x32_bf16 v[180:183], v[60:63], a[116:119], v[180:183]
    v_exp_f32 v94, v94
    v_mfma_f32_16x16x32_bf16 v[176:179], v[60:63], a[112:115], v[176:179]
    v_exp_f32 v95, v95
    v_pk_fma_f32 v[224:225], v[224:225], v[234:235], v[234:235] op_sel_hi:[1,0,0]
    v_pk_fma_f32 v[226:227], v[226:227], v[234:235], v[234:235] op_sel_hi:[1,0,0]
    v_pk_fma_f32 v[228:229], v[228:229], v[238:239], v[238:239] op_sel_hi:[1,0,0]
    v_pk_fma_f32 v[230:231], v[230:231], v[238:239], v[238:239] op_sel_hi:[1,0,0]
    v_rcp_f32 v224, v224
    ds_read_b64_tr_b16 v[48:49], v19 offset:32768
    v_rcp_f32 v225, v225
    ds_read_b64_tr_b16 v[50:51], v19 offset:33792
    v_rcp_f32 v226, v226
    ds_read_b64_tr_b16 v[52:53], v19 offset:40960
    v_rcp_f32 v227, v227
    ds_read_b64_tr_b16 v[54:55], v19 offset:41984
    v_rcp_f32 v228, v228
    ds_read_b64_tr_b16 v[56:57], v19 offset:49152
    v_rcp_f32 v229, v229
    ds_read_b64_tr_b16 v[58:59], v19 offset:50176
    v_rcp_f32 v230, v230
    ds_read_b64_tr_b16 v[60:61], v19 offset:57344
    v_rcp_f32 v231, v231
    ds_read_b64_tr_b16 v[62:63], v19 offset:58368
    v_pk_mul_f32 v[160:161], v[224:225], v[160:161]
    v_pk_mul_f32 v[162:163], v[226:227], v[162:163]
    v_pk_mul_f32 v[164:165], v[228:229], v[164:165]
    v_pk_mul_f32 v[166:167], v[230:231], v[166:167]
    v_cvt_pk_bf16_f32 v64, v160, v161
    v_cvt_pk_bf16_f32 v65, v162, v163
    v_cvt_pk_bf16_f32 v66, v164, v165
    v_cvt_pk_bf16_f32 v67, v166, v167
    v_pk_fma_f32 v[88:89], v[88:89], v[242:243], v[242:243] op_sel_hi:[1,0,0]
    v_pk_fma_f32 v[90:91], v[90:91], v[242:243], v[242:243] op_sel_hi:[1,0,0]
    v_permlane32_swap_b32 v64, v66
    v_permlane32_swap_b32 v65, v67
    buffer_store_dwordx4 v[64:67], v6, s[8:11], s36 offen offset:0 sc1
    v_pk_fma_f32 v[92:93], v[92:93], v[246:247], v[246:247] op_sel_hi:[1,0,0]
    v_pk_fma_f32 v[94:95], v[94:95], v[246:247], v[246:247] op_sel_hi:[1,0,0]
    v_rcp_f32 v88, v88
    v_rcp_f32 v89, v89
    v_rcp_f32 v90, v90
    v_rcp_f32 v91, v91
    v_rcp_f32 v92, v92
    v_rcp_f32 v93, v93
    v_rcp_f32 v94, v94
    v_rcp_f32 v95, v95
    v_pk_mul_f32 v[168:169], v[88:89], v[168:169]
    v_pk_mul_f32 v[170:171], v[90:91], v[170:171]
    v_pk_mul_f32 v[172:173], v[92:93], v[172:173]
    v_pk_mul_f32 v[174:175], v[94:95], v[174:175]
    v_cvt_pk_bf16_f32 v68, v168, v169
    v_cvt_pk_bf16_f32 v69, v170, v171
    v_cvt_pk_bf16_f32 v70, v172, v173
    v_cvt_pk_bf16_f32 v71, v174, v175
    v_pk_mul_f32 v[224:225], v[176:177], v[176:177]
    v_pk_mul_f32 v[226:227], v[178:179], v[178:179]
    v_permlane32_swap_b32 v68, v70
    v_permlane32_swap_b32 v69, v71
    buffer_store_dwordx4 v[68:71], v6, s[8:11], s37 offen offset:0 sc1
    v_pk_mul_f32 v[228:229], v[180:181], v[180:181]
    v_pk_mul_f32 v[230:231], v[182:183], v[182:183]
    v_pk_fma_f32 v[224:225], v[224:225], v[232:233], v[232:233] op_sel:[0,0,1] op_sel_hi:[1,0,1]
    v_pk_fma_f32 v[226:227], v[226:227], v[232:233], v[232:233] op_sel:[0,0,1] op_sel_hi:[1,0,1]
    v_pk_fma_f32 v[228:229], v[228:229], v[236:237], v[236:237] op_sel:[0,0,1] op_sel_hi:[1,0,1]
    v_pk_fma_f32 v[230:231], v[230:231], v[236:237], v[236:237] op_sel:[0,0,1] op_sel_hi:[1,0,1]
    v_pk_mul_f32 v[224:225], v[224:225], v[176:177]
    v_pk_mul_f32 v[226:227], v[226:227], v[178:179]
    v_pk_mul_f32 v[228:229], v[228:229], v[180:181]
    v_pk_mul_f32 v[230:231], v[230:231], v[182:183]
    v_pk_mul_f32 v[88:89], v[184:185], v[184:185]
    v_pk_mul_f32 v[90:91], v[186:187], v[186:187]
    v_pk_mul_f32 v[92:93], v[188:189], v[188:189]
    v_pk_mul_f32 v[94:95], v[190:191], v[190:191]
    v_pk_fma_f32 v[88:89], v[88:89], v[240:241], v[240:241] op_sel:[0,0,1] op_sel_hi:[1,0,1]
    v_pk_fma_f32 v[90:91], v[90:91], v[240:241], v[240:241] op_sel:[0,0,1] op_sel_hi:[1,0,1]
    v_pk_fma_f32 v[92:93], v[92:93], v[244:245], v[244:245] op_sel:[0,0,1] op_sel_hi:[1,0,1]
    v_pk_fma_f32 v[94:95], v[94:95], v[244:245], v[244:245] op_sel:[0,0,1] op_sel_hi:[1,0,1]
    v_pk_mul_f32 v[88:89], v[88:89], v[184:185]
    v_pk_mul_f32 v[90:91], v[90:91], v[186:187]
    v_pk_mul_f32 v[92:93], v[92:93], v[188:189]
    v_pk_mul_f32 v[94:95], v[94:95], v[190:191]
    s_waitcnt lgkmcnt(8)
    v_mfma_f32_16x16x32_bf16 v[192:195], v[32:35], a[64:67], v[192:195]
    v_exp_f32 v224, v224
    v_mfma_f32_16x16x32_bf16 v[196:199], v[32:35], a[68:71], v[196:199]
    v_exp_f32 v225, v225
    s_add_u32 m0, s47, 16384
    v_mfma_f32_16x16x32_bf16 v[200:203], v[32:35], a[72:75], v[200:203]
    v_exp_f32 v226, v226
    v_mfma_f32_16x16x32_bf16 v[204:207], v[32:35], a[76:79], v[204:207]
    v_exp_f32 v227, v227
    buffer_load_dwordx4 v2, s[8:11], s54 offen sc1 lds
    v_mfma_f32_16x16x32_bf16 v[204:207], v[36:39], a[92:95], v[204:207]
    v_exp_f32 v228, v228
    v_mfma_f32_16x16x32_bf16 v[200:203], v[36:39], a[88:91], v[200:203]
    v_exp_f32 v229, v229
    v_mfma_f32_16x16x32_bf16 v[196:199], v[36:39], a[84:87], v[196:199]
    v_exp_f32 v230, v230
    v_mfma_f32_16x16x32_bf16 v[192:195], v[36:39], a[80:83], v[192:195]
    v_exp_f32 v231, v231
    buffer_load_dwordx4 v2, s[8:11], s54 offen offset:1024 sc1 lds
    v_mfma_f32_16x16x32_bf16 v[192:195], v[40:43], a[96:99], v[192:195]
    v_exp_f32 v88, v88
    v_mfma_f32_16x16x32_bf16 v[196:199], v[40:43], a[100:103], v[196:199]
    v_exp_f32 v89, v89
    s_add_u32 s54, s54, 8192
    v_mfma_f32_16x16x32_bf16 v[200:203], v[40:43], a[104:107], v[200:203]
    v_exp_f32 v90, v90
    v_mfma_f32_16x16x32_bf16 v[204:207], v[40:43], a[108:111], v[204:207]
    v_exp_f32 v91, v91
    v_mfma_f32_16x16x32_bf16 v[204:207], v[44:47], a[124:127], v[204:207]
    v_exp_f32 v92, v92
    v_mfma_f32_16x16x32_bf16 v[200:203], v[44:47], a[120:123], v[200:203]
    v_exp_f32 v93, v93
    v_mfma_f32_16x16x32_bf16 v[196:199], v[44:47], a[116:119], v[196:199]
    v_exp_f32 v94, v94
    v_mfma_f32_16x16x32_bf16 v[192:195], v[44:47], a[112:115], v[192:195]
    v_exp_f32 v95, v95
    v_pk_fma_f32 v[224:225], v[224:225], v[234:235], v[234:235] op_sel_hi:[1,0,0]
    v_pk_fma_f32 v[226:227], v[226:227], v[234:235], v[234:235] op_sel_hi:[1,0,0]
    v_pk_fma_f32 v[228:229], v[228:229], v[238:239], v[238:239] op_sel_hi:[1,0,0]
    v_pk_fma_f32 v[230:231], v[230:231], v[238:239], v[238:239] op_sel_hi:[1,0,0]
    v_rcp_f32 v224, v224
    ds_read_b64_tr_b16 v[32:33], v20 offset:32768
    v_rcp_f32 v225, v225
    ds_read_b64_tr_b16 v[34:35], v20 offset:33792
    v_rcp_f32 v226, v226
    ds_read_b64_tr_b16 v[36:37], v20 offset:40960
    v_rcp_f32 v227, v227
    ds_read_b64_tr_b16 v[38:39], v20 offset:41984
    v_rcp_f32 v228, v228
    ds_read_b64_tr_b16 v[40:41], v20 offset:49152
    v_rcp_f32 v229, v229
    ds_read_b64_tr_b16 v[42:43], v20 offset:50176
    v_rcp_f32 v230, v230
    ds_read_b64_tr_b16 v[44:45], v20 offset:57344
    v_rcp_f32 v231, v231
    ds_read_b64_tr_b16 v[46:47], v20 offset:58368
    v_pk_mul_f32 v[176:177], v[224:225], v[176:177]
    v_pk_mul_f32 v[178:179], v[226:227], v[178:179]
    v_pk_mul_f32 v[180:181], v[228:229], v[180:181]
    v_pk_mul_f32 v[182:183], v[230:231], v[182:183]
    v_cvt_pk_bf16_f32 v72, v176, v177
    v_cvt_pk_bf16_f32 v73, v178, v179
    v_cvt_pk_bf16_f32 v74, v180, v181
    v_cvt_pk_bf16_f32 v75, v182, v183
    v_pk_fma_f32 v[88:89], v[88:89], v[242:243], v[242:243] op_sel_hi:[1,0,0]
    v_pk_fma_f32 v[90:91], v[90:91], v[242:243], v[242:243] op_sel_hi:[1,0,0]
    v_permlane32_swap_b32 v72, v74
    v_permlane32_swap_b32 v73, v75
    buffer_store_dwordx4 v[72:75], v6, s[8:11], s36 offen offset:512 sc1
    v_pk_fma_f32 v[92:93], v[92:93], v[246:247], v[246:247] op_sel_hi:[1,0,0]
    v_pk_fma_f32 v[94:95], v[94:95], v[246:247], v[246:247] op_sel_hi:[1,0,0]
    v_rcp_f32 v88, v88
    v_rcp_f32 v89, v89
    v_rcp_f32 v90, v90
    v_rcp_f32 v91, v91
    v_rcp_f32 v92, v92
    v_rcp_f32 v93, v93
    v_rcp_f32 v94, v94
    v_rcp_f32 v95, v95
    v_pk_mul_f32 v[184:185], v[88:89], v[184:185]
    v_pk_mul_f32 v[186:187], v[90:91], v[186:187]
    v_pk_mul_f32 v[188:189], v[92:93], v[188:189]
    v_pk_mul_f32 v[190:191], v[94:95], v[190:191]
    v_cvt_pk_bf16_f32 v76, v184, v185
    v_cvt_pk_bf16_f32 v77, v186, v187
    v_cvt_pk_bf16_f32 v78, v188, v189
    v_cvt_pk_bf16_f32 v79, v190, v191
    v_pk_mul_f32 v[224:225], v[192:193], v[192:193]
    v_pk_mul_f32 v[226:227], v[194:195], v[194:195]
    v_permlane32_swap_b32 v76, v78
    v_permlane32_swap_b32 v77, v79
    buffer_store_dwordx4 v[76:79], v6, s[8:11], s37 offen offset:512 sc1
    v_pk_mul_f32 v[228:229], v[196:197], v[196:197]
    v_pk_mul_f32 v[230:231], v[198:199], v[198:199]
    v_pk_fma_f32 v[224:225], v[224:225], v[232:233], v[232:233] op_sel:[0,0,1] op_sel_hi:[1,0,1]
    v_pk_fma_f32 v[226:227], v[226:227], v[232:233], v[232:233] op_sel:[0,0,1] op_sel_hi:[1,0,1]
    v_pk_fma_f32 v[228:229], v[228:229], v[236:237], v[236:237] op_sel:[0,0,1] op_sel_hi:[1,0,1]
    v_pk_fma_f32 v[230:231], v[230:231], v[236:237], v[236:237] op_sel:[0,0,1] op_sel_hi:[1,0,1]
    v_pk_mul_f32 v[224:225], v[224:225], v[192:193]
    v_pk_mul_f32 v[226:227], v[226:227], v[194:195]
    v_pk_mul_f32 v[228:229], v[228:229], v[196:197]
    v_pk_mul_f32 v[230:231], v[230:231], v[198:199]
    v_pk_mul_f32 v[88:89], v[200:201], v[200:201]
    v_pk_mul_f32 v[90:91], v[202:203], v[202:203]
    v_pk_mul_f32 v[92:93], v[204:205], v[204:205]
    v_pk_mul_f32 v[94:95], v[206:207], v[206:207]
    v_pk_fma_f32 v[88:89], v[88:89], v[240:241], v[240:241] op_sel:[0,0,1] op_sel_hi:[1,0,1]
    v_pk_fma_f32 v[90:91], v[90:91], v[240:241], v[240:241] op_sel:[0,0,1] op_sel_hi:[1,0,1]
    v_pk_fma_f32 v[92:93], v[92:93], v[244:245], v[244:245] op_sel:[0,0,1] op_sel_hi:[1,0,1]
    v_pk_fma_f32 v[94:95], v[94:95], v[244:245], v[244:245] op_sel:[0,0,1] op_sel_hi:[1,0,1]
    v_pk_mul_f32 v[88:89], v[88:89], v[200:201]
    v_pk_mul_f32 v[90:91], v[90:91], v[202:203]
    v_pk_mul_f32 v[92:93], v[92:93], v[204:205]
    v_pk_mul_f32 v[94:95], v[94:95], v[206:207]
    s_waitcnt lgkmcnt(8)
    v_mfma_f32_16x16x32_bf16 v[208:211], v[48:51], a[64:67], v[208:211]
    v_exp_f32 v224, v224
    v_mfma_f32_16x16x32_bf16 v[212:215], v[48:51], a[68:71], v[212:215]
    v_exp_f32 v225, v225
    s_add_u32 m0, s47, 24576
    v_mfma_f32_16x16x32_bf16 v[216:219], v[48:51], a[72:75], v[216:219]
    v_exp_f32 v226, v226
    v_mfma_f32_16x16x32_bf16 v[220:223], v[48:51], a[76:79], v[220:223]
    v_exp_f32 v227, v227
    buffer_load_dwordx4 v2, s[8:11], s54 offen sc1 lds
    v_mfma_f32_16x16x32_bf16 v[220:223], v[52:55], a[92:95], v[220:223]
    v_exp_f32 v228, v228
    v_mfma_f32_16x16x32_bf16 v[216:219], v[52:55], a[88:91], v[216:219]
    v_exp_f32 v229, v229
    v_mfma_f32_16x16x32_bf16 v[212:215], v[52:55], a[84:87], v[212:215]
    v_exp_f32 v230, v230
    v_mfma_f32_16x16x32_bf16 v[208:211], v[52:55], a[80:83], v[208:211]
    v_exp_f32 v231, v231
    buffer_load_dwordx4 v2, s[8:11], s54 offen offset:1024 sc1 lds
    v_mfma_f32_16x16x32_bf16 v[208:211], v[56:59], a[96:99], v[208:211]
    v_exp_f32 v88, v88
    v_mfma_f32_16x16x32_bf16 v[212:215], v[56:59], a[100:103], v[212:215]
    v_exp_f32 v89, v89
    s_add_u32 s54, s54, 8192
    v_mfma_f32_16x16x32_bf16 v[216:219], v[56:59], a[104:107], v[216:219]
    v_exp_f32 v90, v90
    v_mfma_f32_16x16x32_bf16 v[220:223], v[56:59], a[108:111], v[220:223]
    v_exp_f32 v91, v91
    v_mfma_f32_16x16x32_bf16 v[220:223], v[60:63], a[124:127], v[220:223]
    v_exp_f32 v92, v92
    v_mfma_f32_16x16x32_bf16 v[216:219], v[60:63], a[120:123], v[216:219]
    v_exp_f32 v93, v93
    v_mfma_f32_16x16x32_bf16 v[212:215], v[60:63], a[116:119], v[212:215]
    v_exp_f32 v94, v94
    v_mfma_f32_16x16x32_bf16 v[208:211], v[60:63], a[112:115], v[208:211]
    v_exp_f32 v95, v95
    v_pk_fma_f32 v[224:225], v[224:225], v[234:235], v[234:235] op_sel_hi:[1,0,0]
    v_pk_fma_f32 v[226:227], v[226:227], v[234:235], v[234:235] op_sel_hi:[1,0,0]
    v_pk_fma_f32 v[228:229], v[228:229], v[238:239], v[238:239] op_sel_hi:[1,0,0]
    v_pk_fma_f32 v[230:231], v[230:231], v[238:239], v[238:239] op_sel_hi:[1,0,0]
    v_rcp_f32 v224, v224
    ds_read_b64_tr_b16 v[48:49], v21 offset:32768
    v_rcp_f32 v225, v225
    ds_read_b64_tr_b16 v[50:51], v21 offset:33792
    v_rcp_f32 v226, v226
    ds_read_b64_tr_b16 v[52:53], v21 offset:40960
    v_rcp_f32 v227, v227
    ds_read_b64_tr_b16 v[54:55], v21 offset:41984
    v_rcp_f32 v228, v228
    ds_read_b64_tr_b16 v[56:57], v21 offset:49152
    v_rcp_f32 v229, v229
    ds_read_b64_tr_b16 v[58:59], v21 offset:50176
    v_rcp_f32 v230, v230
    ds_read_b64_tr_b16 v[60:61], v21 offset:57344
    v_rcp_f32 v231, v231
    ds_read_b64_tr_b16 v[62:63], v21 offset:58368
    v_pk_mul_f32 v[192:193], v[224:225], v[192:193]
    v_pk_mul_f32 v[194:195], v[226:227], v[194:195]
    v_pk_mul_f32 v[196:197], v[228:229], v[196:197]
    v_pk_mul_f32 v[198:199], v[230:231], v[198:199]
    v_cvt_pk_bf16_f32 v80, v192, v193
    v_cvt_pk_bf16_f32 v81, v194, v195
    v_cvt_pk_bf16_f32 v82, v196, v197
    v_cvt_pk_bf16_f32 v83, v198, v199
    v_pk_fma_f32 v[88:89], v[88:89], v[242:243], v[242:243] op_sel_hi:[1,0,0]
    v_pk_fma_f32 v[90:91], v[90:91], v[242:243], v[242:243] op_sel_hi:[1,0,0]
    v_permlane32_swap_b32 v80, v82
    v_permlane32_swap_b32 v81, v83
    buffer_store_dwordx4 v[80:83], v6, s[8:11], s36 offen offset:1024 sc1
    v_pk_fma_f32 v[92:93], v[92:93], v[246:247], v[246:247] op_sel_hi:[1,0,0]
    v_pk_fma_f32 v[94:95], v[94:95], v[246:247], v[246:247] op_sel_hi:[1,0,0]
    v_rcp_f32 v88, v88
    v_rcp_f32 v89, v89
    v_rcp_f32 v90, v90
    v_rcp_f32 v91, v91
    v_rcp_f32 v92, v92
    v_rcp_f32 v93, v93
    v_rcp_f32 v94, v94
    v_rcp_f32 v95, v95
    v_pk_mul_f32 v[200:201], v[88:89], v[200:201]
    v_pk_mul_f32 v[202:203], v[90:91], v[202:203]
    v_pk_mul_f32 v[204:205], v[92:93], v[204:205]
    v_pk_mul_f32 v[206:207], v[94:95], v[206:207]
    v_cvt_pk_bf16_f32 v84, v200, v201
    v_cvt_pk_bf16_f32 v85, v202, v203
    v_cvt_pk_bf16_f32 v86, v204, v205
    v_cvt_pk_bf16_f32 v87, v206, v207
    v_pk_mul_f32 v[224:225], v[208:209], v[208:209]
    v_pk_mul_f32 v[226:227], v[210:211], v[210:211]
    v_permlane32_swap_b32 v84, v86
    v_permlane32_swap_b32 v85, v87
    buffer_store_dwordx4 v[84:87], v6, s[8:11], s37 offen offset:1024 sc1
    v_pk_mul_f32 v[228:229], v[212:213], v[212:213]
    v_pk_mul_f32 v[230:231], v[214:215], v[214:215]
    v_pk_fma_f32 v[224:225], v[224:225], v[232:233], v[232:233] op_sel:[0,0,1] op_sel_hi:[1,0,1]
    v_pk_fma_f32 v[226:227], v[226:227], v[232:233], v[232:233] op_sel:[0,0,1] op_sel_hi:[1,0,1]
    v_pk_fma_f32 v[228:229], v[228:229], v[236:237], v[236:237] op_sel:[0,0,1] op_sel_hi:[1,0,1]
    v_pk_fma_f32 v[230:231], v[230:231], v[236:237], v[236:237] op_sel:[0,0,1] op_sel_hi:[1,0,1]
    v_pk_mul_f32 v[224:225], v[224:225], v[208:209]
    v_pk_mul_f32 v[226:227], v[226:227], v[210:211]
    v_pk_mul_f32 v[228:229], v[228:229], v[212:213]
    v_pk_mul_f32 v[230:231], v[230:231], v[214:215]
    v_pk_mul_f32 v[88:89], v[216:217], v[216:217]
    v_pk_mul_f32 v[90:91], v[218:219], v[218:219]
    v_pk_mul_f32 v[92:93], v[220:221], v[220:221]
    v_pk_mul_f32 v[94:95], v[222:223], v[222:223]
    v_pk_fma_f32 v[88:89], v[88:89], v[240:241], v[240:241] op_sel:[0,0,1] op_sel_hi:[1,0,1]
    v_pk_fma_f32 v[90:91], v[90:91], v[240:241], v[240:241] op_sel:[0,0,1] op_sel_hi:[1,0,1]
    v_pk_fma_f32 v[92:93], v[92:93], v[244:245], v[244:245] op_sel:[0,0,1] op_sel_hi:[1,0,1]
    v_pk_fma_f32 v[94:95], v[94:95], v[244:245], v[244:245] op_sel:[0,0,1] op_sel_hi:[1,0,1]
    v_pk_mul_f32 v[88:89], v[88:89], v[216:217]
    v_pk_mul_f32 v[90:91], v[90:91], v[218:219]
    v_pk_mul_f32 v[92:93], v[92:93], v[220:221]
    v_pk_mul_f32 v[94:95], v[94:95], v[222:223]
    s_waitcnt lgkmcnt(8)
    v_mfma_f32_16x16x32_bf16 v[96:99], v[32:35], a[64:67], v[96:99]
    v_exp_f32 v224, v224
    v_mfma_f32_16x16x32_bf16 v[100:103], v[32:35], a[68:71], v[100:103]
    v_exp_f32 v225, v225
    s_add_u32 m0, s47, 32768
    v_mfma_f32_16x16x32_bf16 v[104:107], v[32:35], a[72:75], v[104:107]
    v_exp_f32 v226, v226
    v_mfma_f32_16x16x32_bf16 v[108:111], v[32:35], a[76:79], v[108:111]
    v_exp_f32 v227, v227
    buffer_load_dwordx4 v2, s[8:11], s54 offen sc1 lds
    v_mfma_f32_16x16x32_bf16 v[108:111], v[36:39], a[92:95], v[108:111]
    v_exp_f32 v228, v228
    v_mfma_f32_16x16x32_bf16 v[104:107], v[36:39], a[88:91], v[104:107]
    v_exp_f32 v229, v229
    v_mfma_f32_16x16x32_bf16 v[100:103], v[36:39], a[84:87], v[100:103]
    v_exp_f32 v230, v230
    v_mfma_f32_16x16x32_bf16 v[96:99], v[36:39], a[80:83], v[96:99]
    v_exp_f32 v231, v231
    buffer_load_dwordx4 v2, s[8:11], s54 offen offset:1024 sc1 lds
    v_mfma_f32_16x16x32_bf16 v[96:99], v[40:43], a[96:99], v[96:99]
    v_exp_f32 v88, v88
    v_mfma_f32_16x16x32_bf16 v[100:103], v[40:43], a[100:103], v[100:103]
    v_exp_f32 v89, v89
    s_add_u32 s54, s54, 8192
    v_mfma_f32_16x16x32_bf16 v[104:107], v[40:43], a[104:107], v[104:107]
    v_exp_f32 v90, v90
    v_mfma_f32_16x16x32_bf16 v[108:111], v[40:43], a[108:111], v[108:111]
    v_exp_f32 v91, v91
    v_mfma_f32_16x16x32_bf16 v[108:111], v[44:47], a[124:127], v[108:111]
    v_exp_f32 v92, v92
    v_mfma_f32_16x16x32_bf16 v[104:107], v[44:47], a[120:123], v[104:107]
    v_exp_f32 v93, v93
    v_mfma_f32_16x16x32_bf16 v[100:103], v[44:47], a[116:119], v[100:103]
    v_exp_f32 v94, v94
    v_mfma_f32_16x16x32_bf16 v[96:99], v[44:47], a[112:115], v[96:99]
    v_exp_f32 v95, v95
    v_pk_fma_f32 v[224:225], v[224:225], v[234:235], v[234:235] op_sel_hi:[1,0,0]
    v_pk_fma_f32 v[226:227], v[226:227], v[234:235], v[234:235] op_sel_hi:[1,0,0]
    v_pk_fma_f32 v[228:229], v[228:229], v[238:239], v[238:239] op_sel_hi:[1,0,0]
    v_pk_fma_f32 v[230:231], v[230:231], v[238:239], v[238:239] op_sel_hi:[1,0,0]
    v_rcp_f32 v224, v224
    ds_read_b64_tr_b16 v[32:33], v22 offset:32768
    v_rcp_f32 v225, v225
    ds_read_b64_tr_b16 v[34:35], v22 offset:33792
    v_rcp_f32 v226, v226
    ds_read_b64_tr_b16 v[36:37], v22 offset:40960
    v_rcp_f32 v227, v227
    ds_read_b64_tr_b16 v[38:39], v22 offset:41984
    v_rcp_f32 v228, v228
    ds_read_b64_tr_b16 v[40:41], v22 offset:49152
    v_rcp_f32 v229, v229
    ds_read_b64_tr_b16 v[42:43], v22 offset:50176
    v_rcp_f32 v230, v230
    ds_read_b64_tr_b16 v[44:45], v22 offset:57344
    v_rcp_f32 v231, v231
    ds_read_b64_tr_b16 v[46:47], v22 offset:58368
    v_pk_mul_f32 v[208:209], v[224:225], v[208:209]
    v_pk_mul_f32 v[210:211], v[226:227], v[210:211]
    v_pk_mul_f32 v[212:213], v[228:229], v[212:213]
    v_pk_mul_f32 v[214:215], v[230:231], v[214:215]
    v_cvt_pk_bf16_f32 v64, v208, v209
    v_cvt_pk_bf16_f32 v65, v210, v211
    v_cvt_pk_bf16_f32 v66, v212, v213
    v_cvt_pk_bf16_f32 v67, v214, v215
    v_pk_fma_f32 v[88:89], v[88:89], v[242:243], v[242:243] op_sel_hi:[1,0,0]
    v_pk_fma_f32 v[90:91], v[90:91], v[242:243], v[242:243] op_sel_hi:[1,0,0]
    v_permlane32_swap_b32 v64, v66
    v_permlane32_swap_b32 v65, v67
    buffer_store_dwordx4 v[64:67], v6, s[8:11], s36 offen offset:1536 sc1
    v_pk_fma_f32 v[92:93], v[92:93], v[246:247], v[246:247] op_sel_hi:[1,0,0]
    v_pk_fma_f32 v[94:95], v[94:95], v[246:247], v[246:247] op_sel_hi:[1,0,0]
    v_rcp_f32 v88, v88
    v_rcp_f32 v89, v89
    v_rcp_f32 v90, v90
    v_rcp_f32 v91, v91
    v_rcp_f32 v92, v92
    v_rcp_f32 v93, v93
    v_rcp_f32 v94, v94
    v_rcp_f32 v95, v95
    v_pk_mul_f32 v[216:217], v[88:89], v[216:217]
    v_pk_mul_f32 v[218:219], v[90:91], v[218:219]
    v_pk_mul_f32 v[220:221], v[92:93], v[220:221]
    v_pk_mul_f32 v[222:223], v[94:95], v[222:223]
    v_cvt_pk_bf16_f32 v68, v216, v217
    v_cvt_pk_bf16_f32 v69, v218, v219
    v_cvt_pk_bf16_f32 v70, v220, v221
    v_cvt_pk_bf16_f32 v71, v222, v223
    v_pk_mul_f32 v[224:225], v[96:97], v[96:97]
    v_pk_mul_f32 v[226:227], v[98:99], v[98:99]
    v_permlane32_swap_b32 v68, v70
    v_permlane32_swap_b32 v69, v71
    buffer_store_dwordx4 v[68:71], v6, s[8:11], s37 offen offset:1536 sc1
    v_pk_mul_f32 v[228:229], v[100:101], v[100:101]
    v_pk_mul_f32 v[230:231], v[102:103], v[102:103]
    v_pk_fma_f32 v[224:225], v[224:225], v[232:233], v[232:233] op_sel:[0,0,1] op_sel_hi:[1,0,1]
    v_pk_fma_f32 v[226:227], v[226:227], v[232:233], v[232:233] op_sel:[0,0,1] op_sel_hi:[1,0,1]
    v_pk_fma_f32 v[228:229], v[228:229], v[236:237], v[236:237] op_sel:[0,0,1] op_sel_hi:[1,0,1]
    v_pk_fma_f32 v[230:231], v[230:231], v[236:237], v[236:237] op_sel:[0,0,1] op_sel_hi:[1,0,1]
    v_pk_mul_f32 v[224:225], v[224:225], v[96:97]
    v_pk_mul_f32 v[226:227], v[226:227], v[98:99]
    v_pk_mul_f32 v[228:229], v[228:229], v[100:101]
    v_pk_mul_f32 v[230:231], v[230:231], v[102:103]
    v_pk_mul_f32 v[88:89], v[104:105], v[104:105]
    v_pk_mul_f32 v[90:91], v[106:107], v[106:107]
    v_pk_mul_f32 v[92:93], v[108:109], v[108:109]
    v_pk_mul_f32 v[94:95], v[110:111], v[110:111]
    v_pk_fma_f32 v[88:89], v[88:89], v[240:241], v[240:241] op_sel:[0,0,1] op_sel_hi:[1,0,1]
    v_pk_fma_f32 v[90:91], v[90:91], v[240:241], v[240:241] op_sel:[0,0,1] op_sel_hi:[1,0,1]
    v_pk_fma_f32 v[92:93], v[92:93], v[244:245], v[244:245] op_sel:[0,0,1] op_sel_hi:[1,0,1]
    v_pk_fma_f32 v[94:95], v[94:95], v[244:245], v[244:245] op_sel:[0,0,1] op_sel_hi:[1,0,1]
    v_pk_mul_f32 v[88:89], v[88:89], v[104:105]
    v_pk_mul_f32 v[90:91], v[90:91], v[106:107]
    v_pk_mul_f32 v[92:93], v[92:93], v[108:109]
    v_pk_mul_f32 v[94:95], v[94:95], v[110:111]
    s_waitcnt lgkmcnt(8)
    v_mfma_f32_16x16x32_bf16 v[112:115], v[48:51], a[64:67], v[112:115]
    v_exp_f32 v224, v224
    v_mfma_f32_16x16x32_bf16 v[116:119], v[48:51], a[68:71], v[116:119]
    v_exp_f32 v225, v225
    s_add_u32 m0, s47, 40960
    v_mfma_f32_16x16x32_bf16 v[120:123], v[48:51], a[72:75], v[120:123]
    v_exp_f32 v226, v226
    v_mfma_f32_16x16x32_bf16 v[124:127], v[48:51], a[76:79], v[124:127]
    v_exp_f32 v227, v227
    buffer_load_dwordx4 v2, s[8:11], s54 offen sc1 lds
    v_mfma_f32_16x16x32_bf16 v[124:127], v[52:55], a[92:95], v[124:127]
    v_exp_f32 v228, v228
    v_mfma_f32_16x16x32_bf16 v[120:123], v[52:55], a[88:91], v[120:123]
    v_exp_f32 v229, v229
    v_mfma_f32_16x16x32_bf16 v[116:119], v[52:55], a[84:87], v[116:119]
    v_exp_f32 v230, v230
    v_mfma_f32_16x16x32_bf16 v[112:115], v[52:55], a[80:83], v[112:115]
    v_exp_f32 v231, v231
    buffer_load_dwordx4 v2, s[8:11], s54 offen offset:1024 sc1 lds
    v_mfma_f32_16x16x32_bf16 v[112:115], v[56:59], a[96:99], v[112:115]
    v_exp_f32 v88, v88
    v_mfma_f32_16x16x32_bf16 v[116:119], v[56:59], a[100:103], v[116:119]
    v_exp_f32 v89, v89
    s_add_u32 s54, s54, 8192
    v_mfma_f32_16x16x32_bf16 v[120:123], v[56:59], a[104:107], v[120:123]
    v_exp_f32 v90, v90
    v_mfma_f32_16x16x32_bf16 v[124:127], v[56:59], a[108:111], v[124:127]
    v_exp_f32 v91, v91
    v_mfma_f32_16x16x32_bf16 v[124:127], v[60:63], a[124:127], v[124:127]
    v_exp_f32 v92, v92
    v_mfma_f32_16x16x32_bf16 v[120:123], v[60:63], a[120:123], v[120:123]
    v_exp_f32 v93, v93
    v_mfma_f32_16x16x32_bf16 v[116:119], v[60:63], a[116:119], v[116:119]
    v_exp_f32 v94, v94
    v_mfma_f32_16x16x32_bf16 v[112:115], v[60:63], a[112:115], v[112:115]
    v_exp_f32 v95, v95
    v_pk_fma_f32 v[224:225], v[224:225], v[234:235], v[234:235] op_sel_hi:[1,0,0]
    v_pk_fma_f32 v[226:227], v[226:227], v[234:235], v[234:235] op_sel_hi:[1,0,0]
    v_pk_fma_f32 v[228:229], v[228:229], v[238:239], v[238:239] op_sel_hi:[1,0,0]
    v_pk_fma_f32 v[230:231], v[230:231], v[238:239], v[238:239] op_sel_hi:[1,0,0]
    v_rcp_f32 v224, v224
    ds_read_b64_tr_b16 v[48:49], v23 offset:32768
    v_rcp_f32 v225, v225
    ds_read_b64_tr_b16 v[50:51], v23 offset:33792
    v_rcp_f32 v226, v226
    ds_read_b64_tr_b16 v[52:53], v23 offset:40960
    v_rcp_f32 v227, v227
    ds_read_b64_tr_b16 v[54:55], v23 offset:41984
    v_rcp_f32 v228, v228
    ds_read_b64_tr_b16 v[56:57], v23 offset:49152
    v_rcp_f32 v229, v229
    ds_read_b64_tr_b16 v[58:59], v23 offset:50176
    v_rcp_f32 v230, v230
    ds_read_b64_tr_b16 v[60:61], v23 offset:57344
    v_rcp_f32 v231, v231
    ds_read_b64_tr_b16 v[62:63], v23 offset:58368
    v_pk_mul_f32 v[96:97], v[224:225], v[96:97]
    v_pk_mul_f32 v[98:99], v[226:227], v[98:99]
    v_pk_mul_f32 v[100:101], v[228:229], v[100:101]
    v_pk_mul_f32 v[102:103], v[230:231], v[102:103]
    v_cvt_pk_bf16_f32 v72, v96, v97
    v_cvt_pk_bf16_f32 v73, v98, v99
    v_cvt_pk_bf16_f32 v74, v100, v101
    v_cvt_pk_bf16_f32 v75, v102, v103
    v_pk_fma_f32 v[88:89], v[88:89], v[242:243], v[242:243] op_sel_hi:[1,0,0]
    v_pk_fma_f32 v[90:91], v[90:91], v[242:243], v[242:243] op_sel_hi:[1,0,0]
    v_permlane32_swap_b32 v72, v74
    v_permlane32_swap_b32 v73, v75
    buffer_store_dwordx4 v[72:75], v6, s[8:11], s38 offen offset:0 sc1
    v_pk_fma_f32 v[92:93], v[92:93], v[246:247], v[246:247] op_sel_hi:[1,0,0]
    v_pk_fma_f32 v[94:95], v[94:95], v[246:247], v[246:247] op_sel_hi:[1,0,0]
    v_rcp_f32 v88, v88
    v_rcp_f32 v89, v89
    v_rcp_f32 v90, v90
    v_rcp_f32 v91, v91
    v_rcp_f32 v92, v92
    v_rcp_f32 v93, v93
    v_rcp_f32 v94, v94
    v_rcp_f32 v95, v95
    v_pk_mul_f32 v[104:105], v[88:89], v[104:105]
    v_pk_mul_f32 v[106:107], v[90:91], v[106:107]
    v_pk_mul_f32 v[108:109], v[92:93], v[108:109]
    v_pk_mul_f32 v[110:111], v[94:95], v[110:111]
    v_cvt_pk_bf16_f32 v76, v104, v105
    v_cvt_pk_bf16_f32 v77, v106, v107
    v_cvt_pk_bf16_f32 v78, v108, v109
    v_cvt_pk_bf16_f32 v79, v110, v111
    v_pk_mul_f32 v[224:225], v[112:113], v[112:113]
    v_pk_mul_f32 v[226:227], v[114:115], v[114:115]
    v_permlane32_swap_b32 v76, v78
    v_permlane32_swap_b32 v77, v79
    buffer_store_dwordx4 v[76:79], v6, s[8:11], s39 offen offset:0 sc1
    v_pk_mul_f32 v[228:229], v[116:117], v[116:117]
    v_pk_mul_f32 v[230:231], v[118:119], v[118:119]
    v_pk_fma_f32 v[224:225], v[224:225], v[232:233], v[232:233] op_sel:[0,0,1] op_sel_hi:[1,0,1]
    v_pk_fma_f32 v[226:227], v[226:227], v[232:233], v[232:233] op_sel:[0,0,1] op_sel_hi:[1,0,1]
    v_pk_fma_f32 v[228:229], v[228:229], v[236:237], v[236:237] op_sel:[0,0,1] op_sel_hi:[1,0,1]
    v_pk_fma_f32 v[230:231], v[230:231], v[236:237], v[236:237] op_sel:[0,0,1] op_sel_hi:[1,0,1]
    v_pk_mul_f32 v[224:225], v[224:225], v[112:113]
    v_pk_mul_f32 v[226:227], v[226:227], v[114:115]
    v_pk_mul_f32 v[228:229], v[228:229], v[116:117]
    v_pk_mul_f32 v[230:231], v[230:231], v[118:119]
    v_pk_mul_f32 v[88:89], v[120:121], v[120:121]
    v_pk_mul_f32 v[90:91], v[122:123], v[122:123]
    v_pk_mul_f32 v[92:93], v[124:125], v[124:125]
    v_pk_mul_f32 v[94:95], v[126:127], v[126:127]
    v_pk_fma_f32 v[88:89], v[88:89], v[240:241], v[240:241] op_sel:[0,0,1] op_sel_hi:[1,0,1]
    v_pk_fma_f32 v[90:91], v[90:91], v[240:241], v[240:241] op_sel:[0,0,1] op_sel_hi:[1,0,1]
    v_pk_fma_f32 v[92:93], v[92:93], v[244:245], v[244:245] op_sel:[0,0,1] op_sel_hi:[1,0,1]
    v_pk_fma_f32 v[94:95], v[94:95], v[244:245], v[244:245] op_sel:[0,0,1] op_sel_hi:[1,0,1]
    v_pk_mul_f32 v[88:89], v[88:89], v[120:121]
    v_pk_mul_f32 v[90:91], v[90:91], v[122:123]
    v_pk_mul_f32 v[92:93], v[92:93], v[124:125]
    v_pk_mul_f32 v[94:95], v[94:95], v[126:127]
    s_waitcnt vmcnt(4)
    s_mov_b64 exec, 1
    buffer_atomic_add v251, v250, s[8:11], s44 offen offset:0 sc1
    s_mov_b64 exec, -1
    s_waitcnt lgkmcnt(8)
    v_mfma_f32_16x16x32_bf16 v[128:131], v[32:35], a[64:67], v[128:131]
    v_exp_f32 v224, v224
    v_mfma_f32_16x16x32_bf16 v[132:135], v[32:35], a[68:71], v[132:135]
    v_exp_f32 v225, v225
    s_add_u32 m0, s47, 49152
    v_mfma_f32_16x16x32_bf16 v[136:139], v[32:35], a[72:75], v[136:139]
    v_exp_f32 v226, v226
    v_mfma_f32_16x16x32_bf16 v[140:143], v[32:35], a[76:79], v[140:143]
    v_exp_f32 v227, v227
    buffer_load_dwordx4 v2, s[8:11], s54 offen sc1 lds
    v_mfma_f32_16x16x32_bf16 v[140:143], v[36:39], a[92:95], v[140:143]
    v_exp_f32 v228, v228
    v_mfma_f32_16x16x32_bf16 v[136:139], v[36:39], a[88:91], v[136:139]
    v_exp_f32 v229, v229
    v_mfma_f32_16x16x32_bf16 v[132:135], v[36:39], a[84:87], v[132:135]
    v_exp_f32 v230, v230
    v_mfma_f32_16x16x32_bf16 v[128:131], v[36:39], a[80:83], v[128:131]
    v_exp_f32 v231, v231
    buffer_load_dwordx4 v2, s[8:11], s54 offen offset:1024 sc1 lds
    v_mfma_f32_16x16x32_bf16 v[128:131], v[40:43], a[96:99], v[128:131]
    v_exp_f32 v88, v88
    v_mfma_f32_16x16x32_bf16 v[132:135], v[40:43], a[100:103], v[132:135]
    v_exp_f32 v89, v89
    s_add_u32 s54, s54, 8192
    v_mfma_f32_16x16x32_bf16 v[136:139], v[40:43], a[104:107], v[136:139]
    v_exp_f32 v90, v90
    v_mfma_f32_16x16x32_bf16 v[140:143], v[40:43], a[108:111], v[140:143]
    v_exp_f32 v91, v91
    v_mfma_f32_16x16x32_bf16 v[140:143], v[44:47], a[124:127], v[140:143]
    v_exp_f32 v92, v92
    v_mfma_f32_16x16x32_bf16 v[136:139], v[44:47], a[120:123], v[136:139]
    v_exp_f32 v93, v93
    v_mfma_f32_16x16x32_bf16 v[132:135], v[44:47], a[116:119], v[132:135]
    v_exp_f32 v94, v94
    v_mfma_f32_16x16x32_bf16 v[128:131], v[44:47], a[112:115], v[128:131]
    v_exp_f32 v95, v95
    v_pk_fma_f32 v[224:225], v[224:225], v[234:235], v[234:235] op_sel_hi:[1,0,0]
    v_pk_fma_f32 v[226:227], v[226:227], v[234:235], v[234:235] op_sel_hi:[1,0,0]
    v_pk_fma_f32 v[228:229], v[228:229], v[238:239], v[238:239] op_sel_hi:[1,0,0]
    v_pk_fma_f32 v[230:231], v[230:231], v[238:239], v[238:239] op_sel_hi:[1,0,0]
    v_rcp_f32 v224, v224
    v_rcp_f32 v225, v225
    v_rcp_f32 v226, v226
    v_rcp_f32 v227, v227
    v_rcp_f32 v228, v228
    v_rcp_f32 v229, v229
    v_rcp_f32 v230, v230
    v_rcp_f32 v231, v231
    v_pk_mul_f32 v[112:113], v[224:225], v[112:113]
    v_pk_mul_f32 v[114:115], v[226:227], v[114:115]
    v_pk_mul_f32 v[116:117], v[228:229], v[116:117]
    v_pk_mul_f32 v[118:119], v[230:231], v[118:119]
    v_cvt_pk_bf16_f32 v80, v112, v113
    v_cvt_pk_bf16_f32 v81, v114, v115
    v_cvt_pk_bf16_f32 v82, v116, v117
    v_cvt_pk_bf16_f32 v83, v118, v119
    v_pk_fma_f32 v[88:89], v[88:89], v[242:243], v[242:243] op_sel_hi:[1,0,0]
    v_pk_fma_f32 v[90:91], v[90:91], v[242:243], v[242:243] op_sel_hi:[1,0,0]
    v_permlane32_swap_b32 v80, v82
    v_permlane32_swap_b32 v81, v83
    buffer_store_dwordx4 v[80:83], v6, s[8:11], s38 offen offset:512 sc1
    v_pk_fma_f32 v[92:93], v[92:93], v[246:247], v[246:247] op_sel_hi:[1,0,0]
    v_pk_fma_f32 v[94:95], v[94:95], v[246:247], v[246:247] op_sel_hi:[1,0,0]
    v_rcp_f32 v88, v88
    v_rcp_f32 v89, v89
    v_rcp_f32 v90, v90
    v_rcp_f32 v91, v91
    v_rcp_f32 v92, v92
    v_rcp_f32 v93, v93
    v_rcp_f32 v94, v94
    v_rcp_f32 v95, v95
    v_pk_mul_f32 v[120:121], v[88:89], v[120:121]
    v_pk_mul_f32 v[122:123], v[90:91], v[122:123]
    v_pk_mul_f32 v[124:125], v[92:93], v[124:125]
    v_pk_mul_f32 v[126:127], v[94:95], v[126:127]
    v_cvt_pk_bf16_f32 v84, v120, v121
    v_cvt_pk_bf16_f32 v85, v122, v123
    v_cvt_pk_bf16_f32 v86, v124, v125
    v_cvt_pk_bf16_f32 v87, v126, v127
    v_pk_mul_f32 v[224:225], v[128:129], v[128:129]
    v_pk_mul_f32 v[226:227], v[130:131], v[130:131]
    v_permlane32_swap_b32 v84, v86
    v_permlane32_swap_b32 v85, v87
    buffer_store_dwordx4 v[84:87], v6, s[8:11], s39 offen offset:512 sc1
    v_pk_mul_f32 v[228:229], v[132:133], v[132:133]
    v_pk_mul_f32 v[230:231], v[134:135], v[134:135]
    v_pk_fma_f32 v[224:225], v[224:225], v[232:233], v[232:233] op_sel:[0,0,1] op_sel_hi:[1,0,1]
    v_pk_fma_f32 v[226:227], v[226:227], v[232:233], v[232:233] op_sel:[0,0,1] op_sel_hi:[1,0,1]
    v_pk_fma_f32 v[228:229], v[228:229], v[236:237], v[236:237] op_sel:[0,0,1] op_sel_hi:[1,0,1]
    v_pk_fma_f32 v[230:231], v[230:231], v[236:237], v[236:237] op_sel:[0,0,1] op_sel_hi:[1,0,1]
    v_pk_mul_f32 v[224:225], v[224:225], v[128:129]
    v_pk_mul_f32 v[226:227], v[226:227], v[130:131]
    v_pk_mul_f32 v[228:229], v[228:229], v[132:133]
    v_pk_mul_f32 v[230:231], v[230:231], v[134:135]
    v_pk_mul_f32 v[88:89], v[136:137], v[136:137]
    v_pk_mul_f32 v[90:91], v[138:139], v[138:139]
    v_pk_mul_f32 v[92:93], v[140:141], v[140:141]
    v_pk_mul_f32 v[94:95], v[142:143], v[142:143]
    v_pk_fma_f32 v[88:89], v[88:89], v[240:241], v[240:241] op_sel:[0,0,1] op_sel_hi:[1,0,1]
    v_pk_fma_f32 v[90:91], v[90:91], v[240:241], v[240:241] op_sel:[0,0,1] op_sel_hi:[1,0,1]
    v_pk_fma_f32 v[92:93], v[92:93], v[244:245], v[244:245] op_sel:[0,0,1] op_sel_hi:[1,0,1]
    v_pk_fma_f32 v[94:95], v[94:95], v[244:245], v[244:245] op_sel:[0,0,1] op_sel_hi:[1,0,1]
    v_pk_mul_f32 v[88:89], v[88:89], v[136:137]
    v_pk_mul_f32 v[90:91], v[90:91], v[138:139]
    v_pk_mul_f32 v[92:93], v[92:93], v[140:141]
    v_pk_mul_f32 v[94:95], v[94:95], v[142:143]
    s_waitcnt lgkmcnt(0)
    v_mfma_f32_16x16x32_bf16 v[144:147], v[48:51], a[64:67], v[144:147]
    v_exp_f32 v224, v224
    v_mfma_f32_16x16x32_bf16 v[148:151], v[48:51], a[68:71], v[148:151]
    v_exp_f32 v225, v225
    s_add_u32 m0, s47, 57344
    v_mfma_f32_16x16x32_bf16 v[152:155], v[48:51], a[72:75], v[152:155]
    v_exp_f32 v226, v226
    v_mfma_f32_16x16x32_bf16 v[156:159], v[48:51], a[76:79], v[156:159]
    v_exp_f32 v227, v227
    buffer_load_dwordx4 v2, s[8:11], s54 offen sc1 lds
    v_mfma_f32_16x16x32_bf16 v[156:159], v[52:55], a[92:95], v[156:159]
    v_exp_f32 v228, v228
    v_mfma_f32_16x16x32_bf16 v[152:155], v[52:55], a[88:91], v[152:155]
    v_exp_f32 v229, v229
    v_mfma_f32_16x16x32_bf16 v[148:151], v[52:55], a[84:87], v[148:151]
    v_exp_f32 v230, v230
    v_mfma_f32_16x16x32_bf16 v[144:147], v[52:55], a[80:83], v[144:147]
    v_exp_f32 v231, v231
    buffer_load_dwordx4 v2, s[8:11], s54 offen offset:1024 sc1 lds
    v_mfma_f32_16x16x32_bf16 v[144:147], v[56:59], a[96:99], v[144:147]
    v_exp_f32 v88, v88
    v_mfma_f32_16x16x32_bf16 v[148:151], v[56:59], a[100:103], v[148:151]
    v_exp_f32 v89, v89
    s_add_u32 s54, s54, 8192
    v_mfma_f32_16x16x32_bf16 v[152:155], v[56:59], a[104:107], v[152:155]
    v_exp_f32 v90, v90
    v_mfma_f32_16x16x32_bf16 v[156:159], v[56:59], a[108:111], v[156:159]
    v_exp_f32 v91, v91
    v_mfma_f32_16x16x32_bf16 v[156:159], v[60:63], a[124:127], v[156:159]
    v_exp_f32 v92, v92
    v_mfma_f32_16x16x32_bf16 v[152:155], v[60:63], a[120:123], v[152:155]
    v_exp_f32 v93, v93
    v_mfma_f32_16x16x32_bf16 v[148:151], v[60:63], a[116:119], v[148:151]
    v_exp_f32 v94, v94
    v_mfma_f32_16x16x32_bf16 v[144:147], v[60:63], a[112:115], v[144:147]
    v_exp_f32 v95, v95
    v_pk_fma_f32 v[224:225], v[224:225], v[234:235], v[234:235] op_sel_hi:[1,0,0]
    v_pk_fma_f32 v[226:227], v[226:227], v[234:235], v[234:235] op_sel_hi:[1,0,0]
    v_pk_fma_f32 v[228:229], v[228:229], v[238:239], v[238:239] op_sel_hi:[1,0,0]
    v_pk_fma_f32 v[230:231], v[230:231], v[238:239], v[238:239] op_sel_hi:[1,0,0]
    v_rcp_f32 v224, v224
    v_rcp_f32 v225, v225
    v_rcp_f32 v226, v226
    v_rcp_f32 v227, v227
    v_rcp_f32 v228, v228
    v_rcp_f32 v229, v229
    v_rcp_f32 v230, v230
    v_rcp_f32 v231, v231
    v_pk_mul_f32 v[128:129], v[224:225], v[128:129]
    v_pk_mul_f32 v[130:131], v[226:227], v[130:131]
    v_pk_mul_f32 v[132:133], v[228:229], v[132:133]
    v_pk_mul_f32 v[134:135], v[230:231], v[134:135]
    v_cvt_pk_bf16_f32 v64, v128, v129
    v_cvt_pk_bf16_f32 v65, v130, v131
    v_cvt_pk_bf16_f32 v66, v132, v133
    v_cvt_pk_bf16_f32 v67, v134, v135
    v_pk_fma_f32 v[88:89], v[88:89], v[242:243], v[242:243] op_sel_hi:[1,0,0]
    v_pk_fma_f32 v[90:91], v[90:91], v[242:243], v[242:243] op_sel_hi:[1,0,0]
    v_permlane32_swap_b32 v64, v66
    v_permlane32_swap_b32 v65, v67
    buffer_store_dwordx4 v[64:67], v6, s[8:11], s38 offen offset:1024 sc1
    v_pk_fma_f32 v[92:93], v[92:93], v[246:247], v[246:247] op_sel_hi:[1,0,0]
    v_pk_fma_f32 v[94:95], v[94:95], v[246:247], v[246:247] op_sel_hi:[1,0,0]
    v_rcp_f32 v88, v88
    v_rcp_f32 v89, v89
    v_rcp_f32 v90, v90
    v_rcp_f32 v91, v91
    v_rcp_f32 v92, v92
    v_rcp_f32 v93, v93
    v_rcp_f32 v94, v94
    v_rcp_f32 v95, v95
    v_pk_mul_f32 v[136:137], v[88:89], v[136:137]
    v_pk_mul_f32 v[138:139], v[90:91], v[138:139]
    v_pk_mul_f32 v[140:141], v[92:93], v[140:141]
    v_pk_mul_f32 v[142:143], v[94:95], v[142:143]
    v_cvt_pk_bf16_f32 v68, v136, v137
    v_cvt_pk_bf16_f32 v69, v138, v139
    v_cvt_pk_bf16_f32 v70, v140, v141
    v_cvt_pk_bf16_f32 v71, v142, v143
    v_pk_mul_f32 v[224:225], v[144:145], v[144:145]
    v_pk_mul_f32 v[226:227], v[146:147], v[146:147]
    v_permlane32_swap_b32 v68, v70
    v_permlane32_swap_b32 v69, v71
    buffer_store_dwordx4 v[68:71], v6, s[8:11], s39 offen offset:1024 sc1
    v_pk_mul_f32 v[228:229], v[148:149], v[148:149]
    v_pk_mul_f32 v[230:231], v[150:151], v[150:151]
    v_pk_fma_f32 v[224:225], v[224:225], v[232:233], v[232:233] op_sel:[0,0,1] op_sel_hi:[1,0,1]
    v_pk_fma_f32 v[226:227], v[226:227], v[232:233], v[232:233] op_sel:[0,0,1] op_sel_hi:[1,0,1]
    v_pk_fma_f32 v[228:229], v[228:229], v[236:237], v[236:237] op_sel:[0,0,1] op_sel_hi:[1,0,1]
    v_pk_fma_f32 v[230:231], v[230:231], v[236:237], v[236:237] op_sel:[0,0,1] op_sel_hi:[1,0,1]
    v_pk_mul_f32 v[224:225], v[224:225], v[144:145]
    v_pk_mul_f32 v[226:227], v[226:227], v[146:147]
    v_pk_mul_f32 v[228:229], v[228:229], v[148:149]
    v_pk_mul_f32 v[230:231], v[230:231], v[150:151]
    v_pk_mul_f32 v[88:89], v[152:153], v[152:153]
    v_pk_mul_f32 v[90:91], v[154:155], v[154:155]
    v_pk_mul_f32 v[92:93], v[156:157], v[156:157]
    v_pk_mul_f32 v[94:95], v[158:159], v[158:159]
    v_pk_fma_f32 v[88:89], v[88:89], v[240:241], v[240:241] op_sel:[0,0,1] op_sel_hi:[1,0,1]
    v_pk_fma_f32 v[90:91], v[90:91], v[240:241], v[240:241] op_sel:[0,0,1] op_sel_hi:[1,0,1]
    v_pk_fma_f32 v[92:93], v[92:93], v[244:245], v[244:245] op_sel:[0,0,1] op_sel_hi:[1,0,1]
    v_pk_fma_f32 v[94:95], v[94:95], v[244:245], v[244:245] op_sel:[0,0,1] op_sel_hi:[1,0,1]
    v_pk_mul_f32 v[88:89], v[88:89], v[152:153]
    v_pk_mul_f32 v[90:91], v[90:91], v[154:155]
    v_pk_mul_f32 v[92:93], v[92:93], v[156:157]
    v_pk_mul_f32 v[94:95], v[94:95], v[158:159]
    buffer_load_dword v252, v9, s[8:11], 0 offen offset:64 sc1
    v_exp_f32 v224, v224
    v_exp_f32 v225, v225
    v_exp_f32 v226, v226
    v_exp_f32 v227, v227
    v_exp_f32 v228, v228
    v_exp_f32 v229, v229
    v_exp_f32 v230, v230
    v_exp_f32 v231, v231
    v_exp_f32 v88, v88
    v_exp_f32 v89, v89
    v_exp_f32 v90, v90
    v_exp_f32 v91, v91
    v_exp_f32 v92, v92
    v_exp_f32 v93, v93
    v_exp_f32 v94, v94
    v_exp_f32 v95, v95
    buffer_load_dword v249, v250, s[8:11], s62 offen offset:0 sc1
    v_pk_fma_f32 v[224:225], v[224:225], v[234:235], v[234:235] op_sel_hi:[1,0,0]
    v_pk_fma_f32 v[226:227], v[226:227], v[234:235], v[234:235] op_sel_hi:[1,0,0]
    v_pk_fma_f32 v[228:229], v[228:229], v[238:239], v[238:239] op_sel_hi:[1,0,0]
    v_pk_fma_f32 v[230:231], v[230:231], v[238:239], v[238:239] op_sel_hi:[1,0,0]
    v_rcp_f32 v224, v224
    v_rcp_f32 v225, v225
    v_rcp_f32 v226, v226
    v_rcp_f32 v227, v227
    v_rcp_f32 v228, v228
    v_rcp_f32 v229, v229
    v_rcp_f32 v230, v230
    v_rcp_f32 v231, v231
    v_pk_mul_f32 v[144:145], v[224:225], v[144:145]
    v_pk_mul_f32 v[146:147], v[226:227], v[146:147]
    v_pk_mul_f32 v[148:149], v[228:229], v[148:149]
    v_pk_mul_f32 v[150:151], v[230:231], v[150:151]
    v_cvt_pk_bf16_f32 v72, v144, v145
    v_cvt_pk_bf16_f32 v73, v146, v147
    v_cvt_pk_bf16_f32 v74, v148, v149
    v_cvt_pk_bf16_f32 v75, v150, v151
    v_pk_fma_f32 v[88:89], v[88:89], v[242:243], v[242:243] op_sel_hi:[1,0,0]
    v_pk_fma_f32 v[90:91], v[90:91], v[242:243], v[242:243] op_sel_hi:[1,0,0]
    v_permlane32_swap_b32 v72, v74
    v_permlane32_swap_b32 v73, v75
    buffer_store_dwordx4 v[72:75], v6, s[8:11], s38 offen offset:1536 sc1
    v_pk_fma_f32 v[92:93], v[92:93], v[246:247], v[246:247] op_sel_hi:[1,0,0]
    v_pk_fma_f32 v[94:95], v[94:95], v[246:247], v[246:247] op_sel_hi:[1,0,0]
    v_rcp_f32 v88, v88
    v_rcp_f32 v89, v89
    v_rcp_f32 v90, v90
    v_rcp_f32 v91, v91
    v_rcp_f32 v92, v92
    v_rcp_f32 v93, v93
    v_rcp_f32 v94, v94
    v_rcp_f32 v95, v95
    v_pk_mul_f32 v[152:153], v[88:89], v[152:153]
    v_pk_mul_f32 v[154:155], v[90:91], v[154:155]
    v_pk_mul_f32 v[156:157], v[92:93], v[156:157]
    v_pk_mul_f32 v[158:159], v[94:95], v[158:159]
    v_cvt_pk_bf16_f32 v76, v152, v153
    v_cvt_pk_bf16_f32 v77, v154, v155
    v_cvt_pk_bf16_f32 v78, v156, v157
    v_cvt_pk_bf16_f32 v79, v158, v159
    s_nop 0
    v_permlane32_swap_b32 v76, v78
    v_permlane32_swap_b32 v77, v79
    buffer_store_dwordx4 v[76:79], v6, s[8:11], s39 offen offset:1536 sc1
    s_xor_b32 s46, s46, 0x10000
    s_xor_b32 s47, s47, 0x10000
L_gg_g2:
    s_mov_b32 s55, s41
    s_mov_b32 s45, 5
    s_mul_i32 s3, s22, 4352
    s_add_u32 s3, s3, 131072
    v_lshl_add_u32 v12, v1, 2, s3
    v_add_u32 v13, s3, v5
    ds_write_b32 v12, a128
    v_accvgpr_read_b32 v14, a144
    s_waitcnt lgkmcnt(0)
    ds_read_b64 v[64:65], v13 offset:0
    ds_read_b64 v[66:67], v13 offset:32
    ds_read_b64 v[68:69], v13 offset:64
    ds_read_b64 v[70:71], v13 offset:96
    ds_read_b64 v[72:73], v13 offset:128
    ds_read_b64 v[74:75], v13 offset:160
    ds_read_b64 v[76:77], v13 offset:192
    ds_read_b64 v[78:79], v13 offset:224
    v_pk_mul_f32 v[100:101], v[24:25], 0 op_sel_hi:[1,0]
    v_pk_mul_f32 v[102:103], v[24:25], 0 op_sel_hi:[1,0]
    v_pk_mul_f32 v[108:109], v[24:25], 0 op_sel_hi:[1,0]
    v_pk_mul_f32 v[110:111], v[24:25], 0 op_sel_hi:[1,0]
    v_pk_mul_f32 v[116:117], v[24:25], 0 op_sel_hi:[1,0]
    v_pk_mul_f32 v[118:119], v[24:25], 0 op_sel_hi:[1,0]
    v_pk_mul_f32 v[124:125], v[24:25], 0 op_sel_hi:[1,0]
    v_pk_mul_f32 v[126:127], v[24:25], 0 op_sel_hi:[1,0]
    v_pk_mul_f32 v[132:133], v[24:25], 0 op_sel_hi:[1,0]
    v_pk_mul_f32 v[134:135], v[24:25], 0 op_sel_hi:[1,0]
    v_pk_mul_f32 v[140:141], v[24:25], 0 op_sel_hi:[1,0]
    v_pk_mul_f32 v[142:143], v[24:25], 0 op_sel_hi:[1,0]
    v_pk_mul_f32 v[148:149], v[24:25], 0 op_sel_hi:[1,0]
    v_pk_mul_f32 v[150:151], v[24:25], 0 op_sel_hi:[1,0]
    v_pk_mul_f32 v[156:157], v[24:25], 0 op_sel_hi:[1,0]
    v_pk_mul_f32 v[158:159], v[24:25], 0 op_sel_hi:[1,0]
    s_waitcnt lgkmcnt(0)
    v_lshlrev_b32 v12, 16, v64
    v_and_b32 v13, 0xffff0000, v64
    v_pk_add_f32 v[96:97], v[12:13], v[14:15] op_sel_hi:[1,0]
    v_lshlrev_b32 v12, 16, v65
    v_and_b32 v13, 0xffff0000, v65
    v_pk_add_f32 v[98:99], v[12:13], v[14:15] op_sel_hi:[1,0]
    v_lshlrev_b32 v12, 16, v66
    v_and_b32 v13, 0xffff0000, v66
    v_pk_add_f32 v[104:105], v[12:13], v[14:15] op_sel_hi:[1,0]
    v_lshlrev_b32 v12, 16, v67
    v_and_b32 v13, 0xffff0000, v67
    v_pk_add_f32 v[106:107], v[12:13], v[14:15] op_sel_hi:[1,0]
    v_lshlrev_b32 v12, 16, v68
    v_and_b32 v13, 0xffff0000, v68
    v_pk_add_f32 v[112:113], v[12:13], v[14:15] op_sel_hi:[1,0]
    v_lshlrev_b32 v12, 16, v69
    v_and_b32 v13, 0xffff0000, v69
    v_pk_add_f32 v[114:115], v[12:13], v[14:15] op_sel_hi:[1,0]
    v_lshlrev_b32 v12, 16, v70
    v_and_b32 v13, 0xffff0000, v70
    v_pk_add_f32 v[120:121], v[12:13], v[14:15] op_sel_hi:[1,0]
    v_lshlrev_b32 v12, 16, v71
    v_and_b32 v13, 0xffff0000, v71
    v_pk_add_f32 v[122:123], v[12:13], v[14:15] op_sel_hi:[1,0]
    v_lshlrev_b32 v12, 16, v72
    v_and_b32 v13, 0xffff0000, v72
    v_pk_add_f32 v[128:129], v[12:13], v[14:15] op_sel_hi:[1,0]
    v_lshlrev_b32 v12, 16, v73
    v_and_b32 v13, 0xffff0000, v73
    v_pk_add_f32 v[130:131], v[12:13], v[14:15] op_sel_hi:[1,0]
    v_lshlrev_b32 v12, 16, v74
    v_and_b32 v13, 0xffff0000, v74
    v_pk_add_f32 v[136:137], v[12:13], v[14:15] op_sel_hi:[1,0]
    v_lshlrev_b32 v12, 16, v75
    v_and_b32 v13, 0xffff0000, v75
    v_pk_add_f32 v[138:139], v[12:13], v[14:15] op_sel_hi:[1,0]
    v_lshlrev_b32 v12, 16, v76
    v_and_b32 v13, 0xffff0000, v76
    v_pk_add_f32 v[144:145], v[12:13], v[14:15] op_sel_hi:[1,0]
    v_lshlrev_b32 v12, 16, v77
    v_and_b32 v13, 0xffff0000, v77
    v_pk_add_f32 v[146:147], v[12:13], v[14:15] op_sel_hi:[1,0]
    v_lshlrev_b32 v12, 16, v78
    v_and_b32 v13, 0xffff0000, v78
    v_pk_add_f32 v[152:153], v[12:13], v[14:15] op_sel_hi:[1,0]
    v_lshlrev_b32 v12, 16, v79
    v_and_b32 v13, 0xffff0000, v79
    v_pk_add_f32 v[154:155], v[12:13], v[14:15] op_sel_hi:[1,0]
    v_mfma_f32_16x16x32_bf16 v[96:99], v[24:27], a[148:151], v[96:99]
    v_mfma_f32_16x16x32_bf16 v[104:107], v[28:31], a[148:151], v[104:107]
    v_mfma_f32_16x16x32_bf16 v[112:115], v[24:27], a[152:155], v[112:115]
    v_mfma_f32_16x16x32_bf16 v[120:123], v[28:31], a[152:155], v[120:123]
    v_mfma_f32_16x16x32_bf16 v[128:131], v[24:27], a[156:159], v[128:131]
    v_mfma_f32_16x16x32_bf16 v[136:139], v[28:31], a[156:159], v[136:139]
    v_mfma_f32_16x16x32_bf16 v[144:147], v[24:27], a[160:163], v[144:147]
    v_mfma_f32_16x16x32_bf16 v[152:155], v[28:31], a[160:163], v[152:155]
    s_waitcnt vmcnt(2)
    s_mov_b32 s3, 0x40000
L_gg_pk4:
    v_cmp_gt_u32 vcc, s23, v252
    s_nop 4
    s_cbranch_vccz L_gg_pk4_x
    buffer_load_dword v252, v9, s[8:11], 0 offen offset:64 sc1
    s_sub_u32 s3, s3, 1
    s_waitcnt vmcnt(0)
    s_cmp_lg_u32 s3, 0
    s_cbranch_scc1 L_gg_pk4
L_gg_pk4_x:
    s_mov_b32 s3, 0x40000
L_gg_poll1:
    v_readfirstlane_b32 s95, v249
    s_nop 0
    s_cmp_ge_u32 s95, 14
    s_cbranch_scc1 L_gg_poll1_x
    buffer_load_dword v249, v250, s[8:11], s62 offen offset:0 sc1
    s_sub_u32 s3, s3, 1
    s_waitcnt vmcnt(0)
    s_cmp_lg_u32 s3, 0
    s_cbranch_scc1 L_gg_poll1
L_gg_poll1_x:
    buffer_load_dwordx4 a[0:3], v254, s[8:11], s55 offen offset:0 sc1
    buffer_load_dwordx4 a[4:7], v255, s[8:11], s55 offen offset:0 sc1
    buffer_load_dwordx4 a[8:11], v254, s[8:11], s55 offen offset:1024 sc1
    buffer_load_dwordx4 a[12:15], v255, s[8:11], s55 offen offset:1024 sc1
    buffer_load_dwordx4 a[16:19], v254, s[8:11], s55 offen offset:2048 sc1
    buffer_load_dwordx4 a[20:23], v255, s[8:11], s55 offen offset:2048 sc1
    buffer_load_dwordx4 a[24:27], v254, s[8:11], s55 offen offset:3072 sc1
    buffer_load_dwordx4 a[28:31], v255, s[8:11], s55 offen offset:3072 sc1
    s_add_u32 s55, s55, 4096
    s_barrier
    ds_read_b128 v[32:35], v10 offset:0
    ds_read_b128 v[36:39], v10 offset:1024
    ds_read_b128 v[40:43], v10 offset:2048
    ds_read_b128 v[44:47], v10 offset:3072
    ds_read_b128 v[48:51], v10 offset:4096
    ds_read_b128 v[52:55], v10 offset:5120
    ds_read_b128 v[56:59], v10 offset:6144
    ds_read_b128 v[60:63], v10 offset:7168
    s_waitcnt vmcnt(0)
    s_mov_b64 exec, 1
    buffer_atomic_add v251, v250, s[8:11], s44 offen offset:256 sc1
    s_mov_b64 exec, -1
.p2align 6
L_g2_loop:
    s_waitcnt vmcnt(12) lgkmcnt(4)
    v_mfma_f32_16x16x32_bf16 v[96:99], v[32:35], a[0:3], v[96:99]
    s_bitcmp1_b32 4, s45
    s_cbranch_scc1 L_g2_hook0_0
L_g2_back0_0:
    ds_read_b128 v[64:67], v10 offset:8192
    v_mfma_f32_16x16x32_bf16 v[100:103], v[32:35], a[4:7], v[100:103]
    s_add_u32 m0, s47, 0
    v_mfma_f32_16x16x32_bf16 v[108:111], v[36:39], a[4:7], v[108:111]
    ds_read_b128 v[68:71], v10 offset:9216
    v_mfma_f32_16x16x32_bf16 v[104:107], v[36:39], a[0:3], v[104:107]
    buffer_load_dwordx4 v2, s[8:11], s54 offen sc1 lds
    v_mfma_f32_16x16x32_bf16 v[112:115], v[40:43], a[0:3], v[112:115]
    ds_read_b128 v[72:75], v10 offset:10240
    v_mfma_f32_16x16x32_bf16 v[116:119], v[40:43], a[4:7], v[116:119]
    buffer_load_dwordx4 v2, s[8:11], s54 offen offset:1024 sc1 lds
    v_mfma_f32_16x16x32_bf16 v[124:127], v[44:47], a[4:7], v[124:127]
    ds_read_b128 v[76:79], v10 offset:11264
    v_mfma_f32_16x16x32_bf16 v[120:123], v[44:47], a[0:3], v[120:123]
    s_add_u32 s54, s54, 8192
    s_waitcnt lgkmcnt(4)
    v_mfma_f32_16x16x32_bf16 v[128:131], v[48:51], a[0:3], v[128:131]
    ds_read_b128 v[80:83], v10 offset:12288
    v_mfma_f32_16x16x32_bf16 v[132:135], v[48:51], a[4:7], v[132:135]
    buffer_load_dwordx4 a[32:35], v254, s[8:11], s55 offen offset:0 sc1
    v_mfma_f32_16x16x32_bf16 v[140:143], v[52:55], a[4:7], v[140:143]
    ds_read_b128 v[84:87], v10 offset:13312
    v_mfma_f32_16x16x32_bf16 v[136:139], v[52:55], a[0:3], v[136:139]
    v_mfma_f32_16x16x32_bf16 v[144:147], v[56:59], a[0:3], v[144:147]
    ds_read_b128 v[88:91], v10 offset:14336
    v_mfma_f32_16x16x32_bf16 v[148:151], v[56:59], a[4:7], v[148:151]
    buffer_load_dwordx4 a[36:39], v255, s[8:11], s55 offen offset:0 sc1
    v_mfma_f32_16x16x32_bf16 v[156:159], v[60:63], a[4:7], v[156:159]
    ds_read_b128 v[92:95], v10 offset:15360
    v_mfma_f32_16x16x32_bf16 v[152:155], v[60:63], a[0:3], v[152:155]
    s_waitcnt vmcnt(12) lgkmcnt(4)
    v_mfma_f32_16x16x32_bf16 v[96:99], v[64:67], a[8:11], v[96:99]
    ds_read_b128 v[32:35], v10 offset:16384
    v_mfma_f32_16x16x32_bf16 v[100:103], v[64:67], a[12:15], v[100:103]
    s_add_u32 m0, s47, 8192
    v_mfma_f32_16x16x32_bf16 v[108:111], v[68:71], a[12:15], v[108:111]
    ds_read_b128 v[36:39], v10 offset:17408
    v_mfma_f32_16x16x32_bf16 v[104:107], v[68:71], a[8:11], v[104:107]
    buffer_load_dwordx4 v2, s[8:11], s54 offen sc1 lds
    v_mfma_f32_16x16x32_bf16 v[112:115], v[72:75], a[8:11], v[112:115]
    ds_read_b128 v[40:43], v10 offset:18432
    v_mfma_f32_16x16x32_bf16 v[116:119], v[72:75], a[12:15], v[116:119]
    buffer_load_dwordx4 v2, s[8:11], s54 offen offset:1024 sc1 lds
    v_mfma_f32_16x16x32_bf16 v[124:127], v[76:79], a[12:15], v[124:127]
    ds_read_b128 v[44:47], v10 offset:19456
    v_mfma_f32_16x16x32_bf16 v[120:123], v[76:79], a[8:11], v[120:123]
    s_add_u32 s54, s54, 8192
    s_waitcnt lgkmcnt(4)
    v_mfma_f32_16x16x32_bf16 v[128:131], v[80:83], a[8:11], v[128:131]
    ds_read_b128 v[48:51], v10 offset:20480
    v_mfma_f32_16x16x32_bf16 v[132:135], v[80:83], a[12:15], v[132:135]
    buffer_load_dwordx4 a[40:43], v254, s[8:11], s55 offen offset:1024 sc1
    v_mfma_f32_16x16x32_bf16 v[140:143], v[84:87], a[12:15], v[140:143]
    ds_read_b128 v[52:55], v10 offset:21504
    v_mfma_f32_16x16x32_bf16 v[136:139], v[84:87], a[8:11], v[136:139]
    v_mfma_f32_16x16x32_bf16 v[144:147], v[88:91], a[8:11], v[144:147]
    ds_read_b128 v[56:59], v10 offset:22528
    v_mfma_f32_16x16x32_bf16 v[148:151], v[88:91], a[12:15], v[148:151]
    buffer_load_dwordx4 a[44:47], v255, s[8:11], s55 offen offset:1024 sc1
    v_mfma_f32_16x16x32_bf16 v[156:159], v[92:95], a[12:15], v[156:159]
    ds_read_b128 v[60:63], v10 offset:23552
    v_mfma_f32_16x16x32_bf16 v[152:155], v[92:95], a[8:11], v[152:155]
    s_waitcnt vmcnt(12) lgkmcnt(4)
    v_mfma_f32_16x16x32_bf16 v[96:99], v[32:35], a[16:19], v[96:99]
    ds_read_b128 v[64:67], v10 offset:24576
    v_mfma_f32_16x16x32_bf16 v[100:103], v[32:35], a[20:23], v[100:103]
    s_add_u32 m0, s47, 16384
    v_mfma_f32_16x16x32_bf16 v[108:111], v[36:39], a[20:23], v[108:111]
    ds_read_b128 v[68:71], v10 offset:25600
    v_mfma_f32_16x16x32_bf16 v[104:107], v[36:39], a[16:19], v[104:107]
    buffer_load_dwordx4 v2, s[8:11], s54 offen sc1 lds
    v_mfma_f32_16x16x32_bf16 v[112:115], v[40:43], a[16:19], v[112:115]
    ds_read_b128 v[72:75], v10 offset:26624
    v_mfma_f32_16x16x32_bf16 v[116:119], v[40:43], a[20:23], v[116:119]
    buffer_load_dwordx4 v2, s[8:11], s54 offen offset:1024 sc1 lds
    v_mfma_f32_16x16x32_bf16 v[124:127], v[44:47], a[20:23], v[124:127]
    ds_read_b128 v[76:79], v10 offset:27648
    v_mfma_f32_16x16x32_bf16 v[120:123], v[44:47], a[16:19], v[120:123]
    s_add_u32 s54, s54, 8192
    s_waitcnt lgkmcnt(4)
    v_mfma_f32_16x16x32_bf16 v[128:131], v[48:51], a[16:19], v[128:131]
    ds_read_b128 v[80:83], v10 offset:28672
    v_mfma_f32_16x16x32_bf16 v[132:135], v[48:51], a[20:23], v[132:135]
    buffer_load_dwordx4 a[48:51], v254, s[8:11], s55 offen offset:2048 sc1
    v_mfma_f32_16x16x32_bf16 v[140:143], v[52:55], a[20:23], v[140:143]
    ds_read_b128 v[84:87], v10 offset:29696
    v_mfma_f32_16x16x32_bf16 v[136:139], v[52:55], a[16:19], v[136:139]
    v_mfma_f32_16x16x32_bf16 v[144:147], v[56:59], a[16:19], v[144:147]
    ds_read_b128 v[88:91], v10 offset:30720
    v_mfma_f32_16x16x32_bf16 v[148:151], v[56:59], a[20:23], v[148:151]
    buffer_load_dwordx4 a[52:55], v255, s[8:11], s55 offen offset:2048 sc1
    v_mfma_f32_16x16x32_bf16 v[156:159], v[60:63], a[20:23], v[156:159]
    ds_read_b128 v[92:95], v10 offset:31744
    v_mfma_f32_16x16x32_bf16 v[152:155], v[60:63], a[16:19], v[152:155]
    s_waitcnt vmcnt(12)
    s_barrier
    s_waitcnt lgkmcnt(4)
    v_mfma_f32_16x16x32_bf16 v[96:99], v[64:67], a[24:27], v[96:99]
    ds_read_b128 v[32:35], v10 offset:32768
    v_mfma_f32_16x16x32_bf16 v[100:103], v[64:67], a[28:31], v[100:103]
    s_add_u32 m0, s47, 24576
    v_mfma_f32_16x16x32_bf16 v[108:111], v[68:71], a[28:31], v[108:111]
    ds_read_b128 v[36:39], v10 offset:33792
    v_mfma_f32_16x16x32_bf16 v[104:107], v[68:71], a[24:27], v[104:107]
    buffer_load_dwordx4 v2, s[8:11], s54 offen sc1 lds
    v_mfma_f32_16x16x32_bf16 v[112:115], v[72:75], a[24:27], v[112:115]
    ds_read_b128 v[40:43], v10 offset:34816
    v_mfma_f32_16x16x32_bf16 v[116:119], v[72:75], a[28:31], v[116:119]
    buffer_load_dwordx4 v2, s[8:11], s54 offen offset:1024 sc1 lds
    v_mfma_f32_16x16x32_bf16 v[124:127], v[76:79], a[28:31], v[124:127]
    ds_read_b128 v[44:47], v10 offset:35840
    v_mfma_f32_16x16x32_bf16 v[120:123], v[76:79], a[24:27], v[120:123]
    s_add_u32 s54, s54, 8192
    s_waitcnt lgkmcnt(4)
    v_mfma_f32_16x16x32_bf16 v[128:131], v[80:83], a[24:27], v[128:131]
    ds_read_b128 v[48:51], v10 offset:36864
    v_mfma_f32_16x16x32_bf16 v[132:135], v[80:83], a[28:31], v[132:135]
    buffer_load_dwordx4 a[56:59], v254, s[8:11], s55 offen offset:3072 sc1
    v_mfma_f32_16x16x32_bf16 v[140:143], v[84:87], a[28:31], v[140:143]
    ds_read_b128 v[52:55], v10 offset:37888
    v_mfma_f32_16x16x32_bf16 v[136:139], v[84:87], a[24:27], v[136:139]
    v_mfma_f32_16x16x32_bf16 v[144:147], v[88:91], a[24:27], v[144:147]
    ds_read_b128 v[56:59], v10 offset:38912
    v_mfma_f32_16x16x32_bf16 v[148:151], v[88:91], a[28:31], v[148:151]
    buffer_load_dwordx4 a[60:63], v255, s[8:11], s55 offen offset:3072 sc1
    v_mfma_f32_16x16x32_bf16 v[156:159], v[92:95], a[28:31], v[156:159]
    ds_read_b128 v[60:63], v10 offset:39936
    v_mfma_f32_16x16x32_bf16 v[152:155], v[92:95], a[24:27], v[152:155]
    s_add_u32 s55, s55, 4096
    s_waitcnt vmcnt(12) lgkmcnt(4)
    v_mfma_f32_16x16x32_bf16 v[96:99], v[32:35], a[32:35], v[96:99]
    s_bitcmp1_b32 8, s45
    s_cbranch_scc1 L_g2_hook4_0
L_g2_back4_0:
    ds_read_b128 v[64:67], v10 offset:40960
    v_mfma_f32_16x16x32_bf16 v[100:103], v[32:35], a[36:39], v[100:103]
    s_add_u32 m0, s47, 32768
    v_mfma_f32_16x16x32_bf16 v[108:111], v[36:39], a[36:39], v[108:111]
    ds_read_b128 v[68:71], v10 offset:41984
    v_mfma_f32_16x16x32_bf16 v[104:107], v[36:39], a[32:35], v[104:107]
    buffer_load_dwordx4 v2, s[8:11], s54 offen sc1 lds
    v_mfma_f32_16x16x32_bf16 v[112:115], v[40:43], a[32:35], v[112:115]
    ds_read_b128 v[72:75], v10 offset:43008
    v_mfma_f32_16x16x32_bf16 v[116:119], v[40:43], a[36:39], v[116:119]
    buffer_load_dwordx4 v2, s[8:11], s54 offen offset:1024 sc1 lds
    v_mfma_f32_16x16x32_bf16 v[124:127], v[44:47], a[36:39], v[124:127]
    ds_read_b128 v[76:79], v10 offset:44032
    v_mfma_f32_16x16x32_bf16 v[120:123], v[44:47], a[32:35], v[120:123]
    s_add_u32 s54, s54, 8192
    s_waitcnt lgkmcnt(4)
    v_mfma_f32_16x16x32_bf16 v[128:131], v[48:51], a[32:35], v[128:131]
    ds_read_b128 v[80:83], v10 offset:45056
    v_mfma_f32_16x16x32_bf16 v[132:135], v[48:51], a[36:39], v[132:135]
    buffer_load_dwordx4 a[0:3], v254, s[8:11], s55 offen offset:0 sc1
    v_mfma_f32_16x16x32_bf16 v[140:143], v[52:55], a[36:39], v[140:143]
    ds_read_b128 v[84:87], v10 offset:46080
    v_mfma_f32_16x16x32_bf16 v[136:139], v[52:55], a[32:35], v[136:139]
    v_mfma_f32_16x16x32_bf16 v[144:147], v[56:59], a[32:35], v[144:147]
    ds_read_b128 v[88:91], v10 offset:47104
    v_mfma_f32_16x16x32_bf16 v[148:151], v[56:59], a[36:39], v[148:151]
    buffer_load_dwordx4 a[4:7], v255, s[8:11], s55 offen offset:0 sc1
    v_mfma_f32_16x16x32_bf16 v[156:159], v[60:63], a[36:39], v[156:159]
    ds_read_b128 v[92:95], v10 offset:48128
    v_mfma_f32_16x16x32_bf16 v[152:155], v[60:63], a[32:35], v[152:155]
    s_waitcnt vmcnt(12) lgkmcnt(4)
    v_mfma_f32_16x16x32_bf16 v[96:99], v[64:67], a[40:43], v[96:99]
    ds_read_b128 v[32:35], v10 offset:49152
    v_mfma_f32_16x16x32_bf16 v[100:103], v[64:67], a[44:47], v[100:103]
    s_add_u32 m0, s47, 40960
    v_mfma_f32_16x16x32_bf16 v[108:111], v[68:71], a[44:47], v[108:111]
    ds_read_b128 v[36:39], v10 offset:50176
    v_mfma_f32_16x16x32_bf16 v[104:107], v[68:71], a[40:43], v[104:107]
    buffer_load_dwordx4 v2, s[8:11], s54 offen sc1 lds
    v_mfma_f32_16x16x32_bf16 v[112:115], v[72:75], a[40:43], v[112:115]
    ds_read_b128 v[40:43], v10 offset:51200
    v_mfma_f32_16x16x32_bf16 v[116:119], v[72:75], a[44:47], v[116:119]
    buffer_load_dwordx4 v2, s[8:11], s54 offen offset:1024 sc1 lds
    v_mfma_f32_16x16x32_bf16 v[124:127], v[76:79], a[44:47], v[124:127]
    ds_read_b128 v[44:47], v10 offset:52224
    v_mfma_f32_16x16x32_bf16 v[120:123], v[76:79], a[40:43], v[120:123]
    s_add_u32 s54, s54, 8192
    s_waitcnt lgkmcnt(4)
    v_mfma_f32_16x16x32_bf16 v[128:131], v[80:83], a[40:43], v[128:131]
    ds_read_b128 v[48:51], v10 offset:53248
    v_mfma_f32_16x16x32_bf16 v[132:135], v[80:83], a[44:47], v[132:135]
    buffer_load_dwordx4 a[8:11], v254, s[8:11], s55 offen offset:1024 sc1
    v_mfma_f32_16x16x32_bf16 v[140:143], v[84:87], a[44:47], v[140:143]
    ds_read_b128 v[52:55], v10 offset:54272
    v_mfma_f32_16x16x32_bf16 v[136:139], v[84:87], a[40:43], v[136:139]
    v_mfma_f32_16x16x32_bf16 v[144:147], v[88:91], a[40:43], v[144:147]
    ds_read_b128 v[56:59], v10 offset:55296
    v_mfma_f32_16x16x32_bf16 v[148:151], v[88:91], a[44:47], v[148:151]
    buffer_load_dwordx4 a[12:15], v255, s[8:11], s55 offen offset:1024 sc1
    v_mfma_f32_16x16x32_bf16 v[156:159], v[92:95], a[44:47], v[156:159]
    ds_read_b128 v[60:63], v10 offset:56320
    v_mfma_f32_16x16x32_bf16 v[152:155], v[92:95], a[40:43], v[152:155]
    s_waitcnt vmcnt(12) lgkmcnt(4)
    v_mfma_f32_16x16x32_bf16 v[96:99], v[32:35], a[48:51], v[96:99]
    ds_read_b128 v[64:67], v10 offset:57344
    v_mfma_f32_16x16x32_bf16 v[100:103], v[32:35], a[52:55], v[100:103]
    s_add_u32 m0, s47, 49152
    v_mfma_f32_16x16x32_bf16 v[108:111], v[36:39], a[52:55], v[108:111]
    ds_read_b128 v[68:71], v10 offset:58368
    v_mfma_f32_16x16x32_bf16 v[104:107], v[36:39], a[48:51], v[104:107]
    buffer_load_dwordx4 v2, s[8:11], s54 offen sc1 lds
    v_mfma_f32_16x16x32_bf16 v[112:115], v[40:43], a[48:51], v[112:115]
    ds_read_b128 v[72:75], v10 offset:59392
    v_mfma_f32_16x16x32_bf16 v[116:119], v[40:43], a[52:55], v[116:119]
    buffer_load_dwordx4 v2, s[8:11], s54 offen offset:1024 sc1 lds
    v_mfma_f32_16x16x32_bf16 v[124:127], v[44:47], a[52:55], v[124:127]
    ds_read_b128 v[76:79], v10 offset:60416
    v_mfma_f32_16x16x32_bf16 v[120:123], v[44:47], a[48:51], v[120:123]
    s_add_u32 s54, s54, 8192
    s_waitcnt lgkmcnt(4)
    v_mfma_f32_16x16x32_bf16 v[128:131], v[48:51], a[48:51], v[128:131]
    ds_read_b128 v[80:83], v10 offset:61440
    v_mfma_f32_16x16x32_bf16 v[132:135], v[48:51], a[52:55], v[132:135]
    buffer_load_dwordx4 a[16:19], v254, s[8:11], s55 offen offset:2048 sc1
    v_mfma_f32_16x16x32_bf16 v[140:143], v[52:55], a[52:55], v[140:143]
    ds_read_b128 v[84:87], v10 offset:62464
    v_mfma_f32_16x16x32_bf16 v[136:139], v[52:55], a[48:51], v[136:139]
    v_mfma_f32_16x16x32_bf16 v[144:147], v[56:59], a[48:51], v[144:147]
    ds_read_b128 v[88:91], v10 offset:63488
    v_mfma_f32_16x16x32_bf16 v[148:151], v[56:59], a[52:55], v[148:151]
    buffer_load_dwordx4 a[20:23], v255, s[8:11], s55 offen offset:2048 sc1
    v_mfma_f32_16x16x32_bf16 v[156:159], v[60:63], a[52:55], v[156:159]
    ds_read_b128 v[92:95], v10 offset:64512
    v_mfma_f32_16x16x32_bf16 v[152:155], v[60:63], a[48:51], v[152:155]
    s_waitcnt vmcnt(12)
    s_barrier
    s_waitcnt lgkmcnt(4)
    v_mfma_f32_16x16x32_bf16 v[96:99], v[64:67], a[56:59], v[96:99]
    v_xor_b32 v10, 0x10000, v10
    ds_read_b128 v[32:35], v10 offset:0
    v_mfma_f32_16x16x32_bf16 v[100:103], v[64:67], a[60:63], v[100:103]
    s_add_u32 m0, s47, 57344
    v_mfma_f32_16x16x32_bf16 v[108:111], v[68:71], a[60:63], v[108:111]
    ds_read_b128 v[36:39], v10 offset:1024
    v_mfma_f32_16x16x32_bf16 v[104:107], v[68:71], a[56:59], v[104:107]
    buffer_load_dwordx4 v2, s[8:11], s54 offen sc1 lds
    v_mfma_f32_16x16x32_bf16 v[112:115], v[72:75], a[56:59], v[112:115]
    ds_read_b128 v[40:43], v10 offset:2048
    v_mfma_f32_16x16x32_bf16 v[116:119], v[72:75], a[60:63], v[116:119]
    buffer_load_dwordx4 v2, s[8:11], s54 offen offset:1024 sc1 lds
    v_mfma_f32_16x16x32_bf16 v[124:127], v[76:79], a[60:63], v[124:127]
    ds_read_b128 v[44:47], v10 offset:3072
    v_mfma_f32_16x16x32_bf16 v[120:123], v[76:79], a[56:59], v[120:123]
    s_add_u32 s54, s54, 8192
    s_xor_b32 s46, s46, 0x10000
    s_waitcnt lgkmcnt(4)
    v_mfma_f32_16x16x32_bf16 v[128:131], v[80:83], a[56:59], v[128:131]
    ds_read_b128 v[48:51], v10 offset:4096
    v_mfma_f32_16x16x32_bf16 v[132:135], v[80:83], a[60:63], v[132:135]
    buffer_load_dwordx4 a[24:27], v254, s[8:11], s55 offen offset:3072 sc1
    v_mfma_f32_16x16x32_bf16 v[140:143], v[84:87], a[60:63], v[140:143]
    ds_read_b128 v[52:55], v10 offset:5120
    v_mfma_f32_16x16x32_bf16 v[136:139], v[84:87], a[56:59], v[136:139]
    s_xor_b32 s47, s47, 0x10000
    v_mfma_f32_16x16x32_bf16 v[144:147], v[88:91], a[56:59], v[144:147]
    ds_read_b128 v[56:59], v10 offset:6144
    v_mfma_f32_16x16x32_bf16 v[148:151], v[88:91], a[60:63], v[148:151]
    buffer_load_dwordx4 a[28:31], v255, s[8:11], s55 offen offset:3072 sc1
    v_mfma_f32_16x16x32_bf16 v[156:159], v[92:95], a[60:63], v[156:159]
    ds_read_b128 v[60:63], v10 offset:7168
    v_mfma_f32_16x16x32_bf16 v[152:155], v[92:95], a[56:59], v[152:155]
    s_add_u32 s55, s55, 4096
    s_sub_u32 s45, s45, 1
    s_cmp_lg_u32 s45, 0
    s_cbranch_scc1 L_g2_loop
L_g2_epi:
    s_add_u32 s60, s55, 4096
    s_add_u32 s61, s55, 8192
    s_waitcnt vmcnt(12) lgkmcnt(6)
    v_mfma_f32_16x16x32_bf16 v[100:103], v[32:35], a[4:7], v[100:103]
    ds_read_b128 v[64:67], v10 offset:8192
    v_mfma_f32_16x16x32_bf16 v[108:111], v[36:39], a[4:7], v[108:111]
    ds_read_b128 v[68:71], v10 offset:9216
    buffer_load_dwordx4 a[64:67], v255, s[8:11], s55 offen offset:0 sc1
    s_waitcnt lgkmcnt(6)
    v_mfma_f32_16x16x32_bf16 v[116:119], v[40:43], a[4:7], v[116:119]
    ds_read_b128 v[72:75], v10 offset:10240
    v_mfma_f32_16x16x32_bf16 v[124:127], v[44:47], a[4:7], v[124:127]
    ds_read_b128 v[76:79], v10 offset:11264
    buffer_load_dwordx4 a[68:71], v255, s[8:11], s55 offen offset:1024 sc1
    s_waitcnt lgkmcnt(6)
    v_mfma_f32_16x16x32_bf16 v[132:135], v[48:51], a[4:7], v[132:135]
    ds_read_b128 v[80:83], v10 offset:12288
    v_mfma_f32_16x16x32_bf16 v[140:143], v[52:55], a[4:7], v[140:143]
    ds_read_b128 v[84:87], v10 offset:13312
    buffer_load_dwordx4 a[72:75], v255, s[8:11], s55 offen offset:2048 sc1
    s_waitcnt lgkmcnt(6)
    v_mfma_f32_16x16x32_bf16 v[148:151], v[56:59], a[4:7], v[148:151]
    ds_read_b128 v[88:91], v10 offset:14336
    v_mfma_f32_16x16x32_bf16 v[156:159], v[60:63], a[4:7], v[156:159]
    ds_read_b128 v[92:95], v10 offset:15360
    buffer_load_dwordx4 a[76:79], v255, s[8:11], s55 offen offset:3072 sc1
    s_waitcnt vmcnt(12) lgkmcnt(6)
    v_mfma_f32_16x16x32_bf16 v[100:103], v[64:67], a[12:15], v[100:103]
    ds_read_b128 v[32:35], v10 offset:16384
    v_mfma_f32_16x16x32_bf16 v[108:111], v[68:71], a[12:15], v[108:111]
    ds_read_b128 v[36:39], v10 offset:17408
    s_add_u32 m0, s47, 0
    s_nop 0
    buffer_load_dwordx4 v2, s[8:11], s54 offen sc1 lds
    s_waitcnt lgkmcnt(6)
    v_mfma_f32_16x16x32_bf16 v[116:119], v[72:75], a[12:15], v[116:119]
    ds_read_b128 v[40:43], v10 offset:18432
    v_mfma_f32_16x16x32_bf16 v[124:127], v[76:79], a[12:15], v[124:127]
    ds_read_b128 v[44:47], v10 offset:19456
    s_lshl_b32 s52, s2, 2
    s_waitcnt lgkmcnt(6)
    v_mfma_f32_16x16x32_bf16 v[132:135], v[80:83], a[12:15], v[132:135]
    ds_read_b128 v[48:51], v10 offset:20480
    v_mfma_f32_16x16x32_bf16 v[140:143], v[84:87], a[12:15], v[140:143]
    ds_read_b128 v[52:55], v10 offset:21504
    buffer_load_dwordx4 v2, s[8:11], s54 offen offset:1024 sc1 lds
    s_add_u32 s54, s54, 8192
    s_waitcnt lgkmcnt(6)
    v_mfma_f32_16x16x32_bf16 v[148:151], v[88:91], a[12:15], v[148:151]
    ds_read_b128 v[56:59], v10 offset:22528
    v_mfma_f32_16x16x32_bf16 v[156:159], v[92:95], a[12:15], v[156:159]
    ds_read_b128 v[60:63], v10 offset:23552
    s_add_u32 s52, s52, s22
    s_waitcnt vmcnt(10) lgkmcnt(6)
    v_mfma_f32_16x16x32_bf16 v[100:103], v[32:35], a[20:23], v[100:103]
    ds_read_b128 v[64:67], v10 offset:24576
    v_mfma_f32_16x16x32_bf16 v[108:111], v[36:39], a[20:23], v[108:111]
    ds_read_b128 v[68:71], v10 offset:25600
    buffer_load_dwordx4 a[80:83], v255, s[8:11], s60 offen offset:0 sc1
    s_waitcnt lgkmcnt(6)
    v_mfma_f32_16x16x32_bf16 v[116:119], v[40:43], a[20:23], v[116:119]
    ds_read_b128 v[72:75], v10 offset:26624
    v_mfma_f32_16x16x32_bf16 v[124:127], v[44:47], a[20:23], v[124:127]
    ds_read_b128 v[76:79], v10 offset:27648
    s_lshl_b32 s59, s52, 12
    s_waitcnt lgkmcnt(6)
    v_mfma_f32_16x16x32_bf16 v[132:135], v[48:51], a[20:23], v[132:135]
    ds_read_b128 v[80:83], v10 offset:28672
    v_mfma_f32_16x16x32_bf16 v[140:143], v[52:55], a[20:23], v[140:143]
    ds_read_b128 v[84:87], v10 offset:29696
    s_add_u32 m0, s47, 8192
    s_nop 0
    buffer_load_dwordx4 v2, s[8:11], s54 offen sc1 lds
    s_waitcnt lgkmcnt(6)
    v_mfma_f32_16x16x32_bf16 v[148:151], v[56:59], a[20:23], v[148:151]
    ds_read_b128 v[88:91], v10 offset:30720
    v_mfma_f32_16x16x32_bf16 v[156:159], v[60:63], a[20:23], v[156:159]
    ds_read_b128 v[92:95], v10 offset:31744
    s_add_u32 s59, s59, s21
    s_waitcnt vmcnt(8) lgkmcnt(6)
    v_mfma_f32_16x16x32_bf16 v[100:103], v[64:67], a[28:31], v[100:103]
    ds_read_b128 v[32:35], v10 offset:0
    v_mfma_f32_16x16x32_bf16 v[108:111], v[68:71], a[28:31], v[108:111]
    ds_read_b128 v[36:39], v10 offset:1024
    buffer_load_dwordx4 v2, s[8:11], s54 offen offset:1024 sc1 lds
    s_add_u32 s54, s54, 8192
    s_waitcnt lgkmcnt(6)
    v_mfma_f32_16x16x32_bf16 v[116:119], v[72:75], a[28:31], v[116:119]
    ds_read_b128 v[40:43], v10 offset:2048
    v_mfma_f32_16x16x32_bf16 v[124:127], v[76:79], a[28:31], v[124:127]
    ds_read_b128 v[44:47], v10 offset:3072
    s_add_u32 s59, s59, 16777216
    s_waitcnt lgkmcnt(6)
    v_mfma_f32_16x16x32_bf16 v[132:135], v[80:83], a[28:31], v[132:135]
    ds_read_b128 v[48:51], v10 offset:4096
    v_mfma_f32_16x16x32_bf16 v[140:143], v[84:87], a[28:31], v[140:143]
    ds_read_b128 v[52:55], v10 offset:5120
    buffer_load_dwordx4 a[84:87], v255, s[8:11], s60 offen offset:1024 sc1
    s_waitcnt lgkmcnt(6)
    v_mfma_f32_16x16x32_bf16 v[148:151], v[88:91], a[28:31], v[148:151]
    ds_read_b128 v[56:59], v10 offset:6144
    v_mfma_f32_16x16x32_bf16 v[156:159], v[92:95], a[28:31], v[156:159]
    ds_read_b128 v[60:63], v10 offset:7168
    s_xor_b32 s53, s59, 0x10000
    s_waitcnt lgkmcnt(6)
    v_mfma_f32_16x16x32_bf16 v[96:99], v[32:35], a[0:3], v[96:99]
    ds_read_b128 v[64:67], v10 offset:8192
    v_mfma_f32_16x16x32_bf16 v[104:107], v[36:39], a[0:3], v[104:107]
    ds_read_b128 v[68:71], v10 offset:9216
    s_add_u32 m0, s47, 16384
    s_nop 0
    buffer_load_dwordx4 v2, s[8:11], s54 offen sc1 lds
    s_waitcnt lgkmcnt(6)
    v_mfma_f32_16x16x32_bf16 v[112:115], v[40:43], a[0:3], v[112:115]
    ds_read_b128 v[72:75], v10 offset:10240
    v_mfma_f32_16x16x32_bf16 v[120:123], v[44:47], a[0:3], v[120:123]
    ds_read_b128 v[76:79], v10 offset:11264
    s_lshl_b32 s51, s52, 6
    s_waitcnt lgkmcnt(6)
    v_mfma_f32_16x16x32_bf16 v[128:131], v[48:51], a[0:3], v[128:131]
    ds_read_b128 v[80:83], v10 offset:12288
    v_mfma_f32_16x16x32_bf16 v[136:139], v[52:55], a[0:3], v[136:139]
    ds_read_b128 v[84:87], v10 offset:13312
    buffer_load_dwordx4 v2, s[8:11], s54 offen offset:1024 sc1 lds
    s_add_u32 s54, s54, 8192
    s_waitcnt lgkmcnt(6)
    v_mfma_f32_16x16x32_bf16 v[144:147], v[56:59], a[0:3], v[144:147]
    ds_read_b128 v[88:91], v10 offset:14336
    v_mfma_f32_16x16x32_bf16 v[152:155], v[60:63], a[0:3], v[152:155]
    ds_read_b128 v[92:95], v10 offset:15360
    s_add_u32 s56, s56, s51
    s_barrier
    s_waitcnt lgkmcnt(6)
    v_mfma_f32_16x16x32_bf16 v[96:99], v[64:67], a[8:11], v[96:99]
    ds_read_b128 v[32:35], v10 offset:32768
    v_mfma_f32_16x16x32_bf16 v[104:107], v[68:71], a[8:11], v[104:107]
    ds_read_b128 v[36:39], v10 offset:33792
    buffer_load_dwordx4 a[88:91], v255, s[8:11], s60 offen offset:2048 sc1
    s_waitcnt lgkmcnt(6)
    v_mfma_f32_16x16x32_bf16 v[112:115], v[72:75], a[8:11], v[112:115]
    ds_read_b128 v[40:43], v10 offset:34816
    v_mfma_f32_16x16x32_bf16 v[120:123], v[76:79], a[8:11], v[120:123]
    ds_read_b128 v[44:47], v10 offset:35840
    s_add_u32 s56, s56, 65536
    s_waitcnt lgkmcnt(6)
    v_mfma_f32_16x16x32_bf16 v[128:131], v[80:83], a[8:11], v[128:131]
    ds_read_b128 v[48:51], v10 offset:36864
    v_mfma_f32_16x16x32_bf16 v[136:139], v[84:87], a[8:11], v[136:139]
    ds_read_b128 v[52:55], v10 offset:37888
    s_add_u32 m0, s47, 24576
    s_nop 0
    buffer_load_dwordx4 v2, s[8:11], s54 offen sc1 lds
    s_waitcnt lgkmcnt(6)
    v_mfma_f32_16x16x32_bf16 v[144:147], v[88:91], a[8:11], v[144:147]
    ds_read_b128 v[56:59], v10 offset:38912
    v_mfma_f32_16x16x32_bf16 v[152:155], v[92:95], a[8:11], v[152:155]
    ds_read_b128 v[60:63], v10 offset:39936
    s_xor_b32 s51, s56, 0x400
    s_waitcnt vmcnt(13) lgkmcnt(6)
    v_mfma_f32_16x16x32_bf16 v[100:103], v[32:35], a[64:67], v[100:103]
    ds_read_b128 v[64:67], v10 offset:40960
    v_mfma_f32_16x16x32_bf16 v[108:111], v[36:39], a[64:67], v[108:111]
    ds_read_b128 v[68:71], v10 offset:41984
    buffer_load_dwordx4 v2, s[8:11], s54 offen offset:1024 sc1 lds
    s_add_u32 s54, s54, 8192
    s_waitcnt lgkmcnt(6)
    v_mfma_f32_16x16x32_bf16 v[116:119], v[40:43], a[64:67], v[116:119]
    ds_read_b128 v[72:75], v10 offset:43008
    v_mfma_f32_16x16x32_bf16 v[124:127], v[44:47], a[64:67], v[124:127]
    ds_read_b128 v[76:79], v10 offset:44032
    v_mul_u32_u24 v9, 272, v4
    s_waitcnt lgkmcnt(6)
    v_mfma_f32_16x16x32_bf16 v[132:135], v[48:51], a[64:67], v[132:135]
    ds_read_b128 v[80:83], v10 offset:45056
    v_mfma_f32_16x16x32_bf16 v[140:143], v[52:55], a[64:67], v[140:143]
    ds_read_b128 v[84:87], v10 offset:46080
    buffer_load_dwordx4 a[92:95], v255, s[8:11], s60 offen offset:3072 sc1
    s_waitcnt lgkmcnt(6)
    v_mfma_f32_16x16x32_bf16 v[148:151], v[56:59], a[64:67], v[148:151]
    ds_read_b128 v[88:91], v10 offset:47104
    v_mfma_f32_16x16x32_bf16 v[156:159], v[60:63], a[64:67], v[156:159]
    ds_read_b128 v[92:95], v10 offset:48128
    v_lshl_add_u32 v9, v3, 4, v9
    s_waitcnt vmcnt(14) lgkmcnt(6)
    v_mfma_f32_16x16x32_bf16 v[100:103], v[64:67], a[68:71], v[100:103]
    ds_read_b128 v[32:35], v10 offset:49152
    v_mfma_f32_16x16x32_bf16 v[108:111], v[68:71], a[68:71], v[108:111]
    ds_read_b128 v[36:39], v10 offset:50176
    s_add_u32 m0, s47, 32768
    s_nop 0
    buffer_load_dwordx4 v2, s[8:11], s54 offen sc1 lds
    s_waitcnt lgkmcnt(6)
    v_mfma_f32_16x16x32_bf16 v[116:119], v[72:75], a[68:71], v[116:119]
    ds_read_b128 v[40:43], v10 offset:51200
    v_mfma_f32_16x16x32_bf16 v[124:127], v[76:79], a[68:71], v[124:127]
    ds_read_b128 v[44:47], v10 offset:52224
    s_mul_i32 s58, s22, 4352
    s_waitcnt lgkmcnt(6)
    v_mfma_f32_16x16x32_bf16 v[132:135], v[80:83], a[68:71], v[132:135]
    ds_read_b128 v[48:51], v10 offset:53248
    v_mfma_f32_16x16x32_bf16 v[140:143], v[84:87], a[68:71], v[140:143]
    ds_read_b128 v[52:55], v10 offset:54272
    buffer_load_dwordx4 v2, s[8:11], s54 offen offset:1024 sc1 lds
    s_add_u32 s54, s54, 8192
    s_waitcnt lgkmcnt(6)
    v_mfma_f32_16x16x32_bf16 v[148:151], v[88:91], a[68:71], v[148:151]
    ds_read_b128 v[56:59], v10 offset:55296
    v_mfma_f32_16x16x32_bf16 v[156:159], v[92:95], a[68:71], v[156:159]
    ds_read_b128 v[60:63], v10 offset:56320
    s_add_u32 s58, s58, 131072
    s_waitcnt vmcnt(15) lgkmcnt(6)
    v_mfma_f32_16x16x32_bf16 v[100:103], v[32:35], a[72:75], v[100:103]
    ds_read_b128 v[64:67], v10 offset:57344
    v_mfma_f32_16x16x32_bf16 v[108:111], v[36:39], a[72:75], v[108:111]
    ds_read_b128 v[68:71], v10 offset:58368
    buffer_load_dwordx4 a[96:99], v255, s[8:11], s61 offen offset:0 sc1
    s_waitcnt lgkmcnt(6)
    v_mfma_f32_16x16x32_bf16 v[116:119], v[40:43], a[72:75], v[116:119]
    ds_read_b128 v[72:75], v10 offset:59392
    v_mfma_f32_16x16x32_bf16 v[124:127], v[44:47], a[72:75], v[124:127]
    ds_read_b128 v[76:79], v10 offset:60416
    v_add_u32 v9, s58, v9
    s_waitcnt lgkmcnt(6)
    v_mfma_f32_16x16x32_bf16 v[132:135], v[48:51], a[72:75], v[132:135]
    ds_read_b128 v[80:83], v10 offset:61440
    v_mfma_f32_16x16x32_bf16 v[140:143], v[52:55], a[72:75], v[140:143]
    ds_read_b128 v[84:87], v10 offset:62464
    s_add_u32 m0, s47, 40960
    s_nop 0
    buffer_load_dwordx4 v2, s[8:11], s54 offen sc1 lds
    s_waitcnt lgkmcnt(6)
    v_mfma_f32_16x16x32_bf16 v[148:151], v[56:59], a[72:75], v[148:151]
    ds_read_b128 v[88:91], v10 offset:63488
    v_mfma_f32_16x16x32_bf16 v[156:159], v[60:63], a[72:75], v[156:159]
    ds_read_b128 v[92:95], v10 offset:64512
    v_mul_u32_u24 v8, 272, v3
    s_waitcnt vmcnt(16) lgkmcnt(6)
    v_mfma_f32_16x16x32_bf16 v[100:103], v[64:67], a[76:79], v[100:103]
    ds_read_b128 v[32:35], v10 offset:16384
    v_mfma_f32_16x16x32_bf16 v[108:111], v[68:71], a[76:79], v[108:111]
    ds_read_b128 v[36:39], v10 offset:17408
    buffer_load_dwordx4 v2, s[8:11], s54 offen offset:1024 sc1 lds
    s_add_u32 s54, s54, 8192
    s_waitcnt lgkmcnt(6)
    v_mfma_f32_16x16x32_bf16 v[116:119], v[72:75], a[76:79], v[116:119]
    ds_read_b128 v[40:43], v10 offset:18432
    v_mfma_f32_16x16x32_bf16 v[124:127], v[76:79], a[76:79], v[124:127]
    ds_read_b128 v[44:47], v10 offset:19456
    v_lshl_add_u32 v8, v4, 4, v8
    s_waitcnt lgkmcnt(6)
    v_mfma_f32_16x16x32_bf16 v[132:135], v[80:83], a[76:79], v[132:135]
    ds_read_b128 v[48:51], v10 offset:20480
    v_mfma_f32_16x16x32_bf16 v[140:143], v[84:87], a[76:79], v[140:143]
    ds_read_b128 v[52:55], v10 offset:21504
    buffer_load_dwordx4 a[100:103], v255, s[8:11], s61 offen offset:1024 sc1
    s_waitcnt lgkmcnt(6)
    v_mfma_f32_16x16x32_bf16 v[148:151], v[88:91], a[76:79], v[148:151]
    ds_read_b128 v[56:59], v10 offset:22528
    v_mfma_f32_16x16x32_bf16 v[156:159], v[92:95], a[76:79], v[156:159]
    ds_read_b128 v[60:63], v10 offset:23552
    v_add_u32 v8, s58, v8
    s_waitcnt lgkmcnt(6)
    v_mfma_f32_16x16x32_bf16 v[96:99], v[32:35], a[16:19], v[96:99]
    ds_read_b128 v[64:67], v10 offset:24576
    v_mfma_f32_16x16x32_bf16 v[104:107], v[36:39], a[16:19], v[104:107]
    ds_read_b128 v[68:71], v10 offset:25600
    s_add_u32 m0, s47, 49152
    s_nop 0
    buffer_load_dwordx4 v2, s[8:11], s54 offen sc1 lds
    s_waitcnt lgkmcnt(6)
    v_mfma_f32_16x16x32_bf16 v[112:115], v[40:43], a[16:19], v[112:115]
    ds_read_b128 v[72:75], v10 offset:26624
    v_mfma_f32_16x16x32_bf16 v[120:123], v[44:47], a[16:19], v[120:123]
    ds_read_b128 v[76:79], v10 offset:27648
    v_lshlrev_b32 v6, 19, v3
    s_waitcnt lgkmcnt(6)
    v_mfma_f32_16x16x32_bf16 v[128:131], v[48:51], a[16:19], v[128:131]
    ds_read_b128 v[80:83], v10 offset:28672
    v_mfma_f32_16x16x32_bf16 v[136:139], v[52:55], a[16:19], v[136:139]
    ds_read_b128 v[84:87], v10 offset:29696
    buffer_load_dwordx4 v2, s[8:11], s54 offen offset:1024 sc1 lds
    s_add_u32 s54, s54, 8192
    s_waitcnt lgkmcnt(6)
    v_mfma_f32_16x16x32_bf16 v[144:147], v[56:59], a[16:19], v[144:147]
    ds_read_b128 v[88:91], v10 offset:30720
    v_mfma_f32_16x16x32_bf16 v[152:155], v[60:63], a[16:19], v[152:155]
    ds_read_b128 v[92:95], v10 offset:31744
    v_lshl_add_u32 v6, v4, 4, v6
    s_waitcnt vmcnt(9)
    s_barrier
    s_waitcnt lgkmcnt(6)
    v_mfma_f32_16x16x32_bf16 v[96:99], v[64:67], a[24:27], v[96:99]
    ds_read_b128 v[32:35], v2 offset:0
    v_mfma_f32_16x16x32_bf16 v[104:107], v[68:71], a[24:27], v[104:107]
    ds_read_b128 v[36:39], v2 offset:1024
    buffer_load_dwordx4 a[104:107], v255, s[8:11], s61 offen offset:2048 sc1
    s_waitcnt lgkmcnt(6)
    v_mfma_f32_16x16x32_bf16 v[112:115], v[72:75], a[24:27], v[112:115]
    ds_read_b128 v[40:43], v2 offset:2048
    v_mfma_f32_16x16x32_bf16 v[120:123], v[76:79], a[24:27], v[120:123]
    ds_read_b128 v[44:47], v2 offset:3072
    s_add_u32 s32, s4, s20
    s_addc_u32 s33, s5, 0
    s_waitcnt lgkmcnt(6)
    v_mfma_f32_16x16x32_bf16 v[128:131], v[80:83], a[24:27], v[128:131]
    ds_read_b128 v[48:51], v2 offset:4096
    v_mfma_f32_16x16x32_bf16 v[136:139], v[84:87], a[24:27], v[136:139]
    ds_read_b128 v[52:55], v2 offset:5120
    s_add_u32 m0, s47, 57344
    s_nop 0
    buffer_load_dwordx4 v2, s[8:11], s54 offen sc1 lds
    s_waitcnt lgkmcnt(6)
    v_mfma_f32_16x16x32_bf16 v[144:147], v[88:91], a[24:27], v[144:147]
    ds_read_b128 v[56:59], v2 offset:6144
    v_mfma_f32_16x16x32_bf16 v[152:155], v[92:95], a[24:27], v[152:155]
    ds_read_b128 v[60:63], v2 offset:7168
    s_mov_b32 s34, 4194304
    s_waitcnt lgkmcnt(6)
    v_mfma_f32_16x16x32_bf16 v[100:103], v[32:35], a[80:83], v[100:103]
    ds_read_b128 v[64:67], v2 offset:8192
    v_mfma_f32_16x16x32_bf16 v[108:111], v[36:39], a[80:83], v[108:111]
    ds_read_b128 v[68:71], v2 offset:9216
    buffer_load_dwordx4 v2, s[8:11], s54 offen offset:1024 sc1 lds
    s_add_u32 s54, s54, 8192
    s_waitcnt lgkmcnt(6)
    v_mfma_f32_16x16x32_bf16 v[116:119], v[40:43], a[80:83], v[116:119]
    ds_read_b128 v[72:75], v2 offset:10240
    v_mfma_f32_16x16x32_bf16 v[124:127], v[44:47], a[80:83], v[124:127]
    ds_read_b128 v[76:79], v2 offset:11264
    s_mov_b32 s35, 0x20000
    s_waitcnt lgkmcnt(6)
    v_mfma_f32_16x16x32_bf16 v[132:135], v[48:51], a[80:83], v[132:135]
    ds_read_b128 v[80:83], v2 offset:12288
    v_mfma_f32_16x16x32_bf16 v[140:143], v[52:55], a[80:83], v[140:143]
    ds_read_b128 v[84:87], v2 offset:13312
    buffer_load_dwordx4 a[108:111], v255, s[8:11], s61 offen offset:3072 sc1
    s_waitcnt lgkmcnt(6)
    v_mfma_f32_16x16x32_bf16 v[148:151], v[56:59], a[80:83], v[148:151]
    ds_read_b128 v[88:91], v2 offset:14336
    v_mfma_f32_16x16x32_bf16 v[156:159], v[60:63], a[80:83], v[156:159]
    ds_read_b128 v[92:95], v2 offset:15360
    s_lshl_b32 s50, s50, 12
    s_waitcnt lgkmcnt(6)
    v_mfma_f32_16x16x32_bf16 v[100:103], v[64:67], a[84:87], v[100:103]
    ds_read_b128 v[32:35], v2 offset:16384
    v_mfma_f32_16x16x32_bf16 v[108:111], v[68:71], a[84:87], v[108:111]
    ds_read_b128 v[36:39], v2 offset:17408
    buffer_load_dwordx4 a[32:35], v254, s[8:11], s55 offen offset:0 sc1
    s_waitcnt lgkmcnt(6)
    v_mfma_f32_16x16x32_bf16 v[116:119], v[72:75], a[84:87], v[116:119]
    ds_read_b128 v[40:43], v2 offset:18432
    v_mfma_f32_16x16x32_bf16 v[124:127], v[76:79], a[84:87], v[124:127]
    ds_read_b128 v[44:47], v2 offset:19456
    s_add_u32 s50, s50, s63
    s_waitcnt lgkmcnt(6)
    v_mfma_f32_16x16x32_bf16 v[132:135], v[80:83], a[84:87], v[132:135]
    ds_read_b128 v[48:51], v2 offset:20480
    v_mfma_f32_16x16x32_bf16 v[140:143], v[84:87], a[84:87], v[140:143]
    ds_read_b128 v[52:55], v2 offset:21504
    buffer_load_dwordx4 a[36:39], v254, s[8:11], s55 offen offset:1024 sc1
    s_waitcnt lgkmcnt(6)
    v_mfma_f32_16x16x32_bf16 v[148:151], v[88:91], a[84:87], v[148:151]
    ds_read_b128 v[56:59], v2 offset:22528
    v_mfma_f32_16x16x32_bf16 v[156:159], v[92:95], a[84:87], v[156:159]
    ds_read_b128 v[60:63], v2 offset:23552
    s_mov_b32 s48, 0x00003f80
    s_waitcnt lgkmcnt(6)
    v_mfma_f32_16x16x32_bf16 v[100:103], v[32:35], a[88:91], v[100:103]
    ds_read_b128 v[64:67], v2 offset:24576
    v_mfma_f32_16x16x32_bf16 v[108:111], v[36:39], a[88:91], v[108:111]
    ds_read_b128 v[68:71], v2 offset:25600
    buffer_load_dwordx4 a[40:43], v254, s[8:11], s55 offen offset:2048 sc1
    s_waitcnt lgkmcnt(6)
    v_mfma_f32_16x16x32_bf16 v[116:119], v[40:43], a[88:91], v[116:119]
    ds_read_b128 v[72:75], v2 offset:26624
    v_mfma_f32_16x16x32_bf16 v[124:127], v[44:47], a[88:91], v[124:127]
    ds_read_b128 v[76:79], v2 offset:27648
    s_mov_b32 s49, 0x3f800000
    s_waitcnt lgkmcnt(6)
    v_mfma_f32_16x16x32_bf16 v[132:135], v[48:51], a[88:91], v[132:135]
    ds_read_b128 v[80:83], v2 offset:28672
    v_mfma_f32_16x16x32_bf16 v[140:143], v[52:55], a[88:91], v[140:143]
    ds_read_b128 v[84:87], v2 offset:29696
    buffer_load_dwordx4 a[44:47], v254, s[8:11], s55 offen offset:3072 sc1
    s_waitcnt lgkmcnt(6)
    v_mfma_f32_16x16x32_bf16 v[148:151], v[56:59], a[88:91], v[148:151]
    ds_read_b128 v[88:91], v2 offset:30720
    v_mfma_f32_16x16x32_bf16 v[156:159], v[60:63], a[88:91], v[156:159]
    ds_read_b128 v[92:95], v2 offset:31744
    s_waitcnt vmcnt(16)
    s_waitcnt vmcnt(5)
    s_barrier
    s_waitcnt lgkmcnt(6)
    v_mfma_f32_16x16x32_bf16 v[100:103], v[64:67], a[92:95], v[100:103]
    ds_read_b128 v[32:35], v2 offset:32768
    v_mfma_f32_16x16x32_bf16 v[108:111], v[68:71], a[92:95], v[108:111]
    ds_read_b128 v[36:39], v2 offset:33792
    buffer_load_dwordx4 a[48:51], v254, s[8:11], s60 offen offset:0 sc1
    s_waitcnt lgkmcnt(6)
    v_mfma_f32_16x16x32_bf16 v[116:119], v[72:75], a[92:95], v[116:119]
    ds_read_b128 v[40:43], v2 offset:34816
    v_mfma_f32_16x16x32_bf16 v[124:127], v[76:79], a[92:95], v[124:127]
    ds_read_b128 v[44:47], v2 offset:35840
    s_waitcnt lgkmcnt(6)
    v_mfma_f32_16x16x32_bf16 v[132:135], v[80:83], a[92:95], v[132:135]
    ds_read_b128 v[48:51], v2 offset:36864
    v_mfma_f32_16x16x32_bf16 v[140:143], v[84:87], a[92:95], v[140:143]
    ds_read_b128 v[52:55], v2 offset:37888
    buffer_load_dwordx4 a[52:55], v254, s[8:11], s60 offen offset:1024 sc1
    s_waitcnt lgkmcnt(6)
    v_mfma_f32_16x16x32_bf16 v[148:151], v[88:91], a[92:95], v[148:151]
    ds_read_b128 v[56:59], v2 offset:38912
    v_mfma_f32_16x16x32_bf16 v[156:159], v[92:95], a[92:95], v[156:159]
    ds_read_b128 v[60:63], v2 offset:39936
    s_waitcnt lgkmcnt(6)
    v_mfma_f32_16x16x32_bf16 v[100:103], v[32:35], a[96:99], v[100:103]
    ds_read_b128 v[64:67], v2 offset:40960
    v_mfma_f32_16x16x32_bf16 v[108:111], v[36:39], a[96:99], v[108:111]
    ds_read_b128 v[68:71], v2 offset:41984
    buffer_load_dwordx4 a[56:59], v254, s[8:11], s60 offen offset:2048 sc1
    s_waitcnt lgkmcnt(6)
    v_mfma_f32_16x16x32_bf16 v[116:119], v[40:43], a[96:99], v[116:119]
    ds_read_b128 v[72:75], v2 offset:43008
    v_mfma_f32_16x16x32_bf16 v[124:127], v[44:47], a[96:99], v[124:127]
    ds_read_b128 v[76:79], v2 offset:44032
    s_waitcnt lgkmcnt(6)
    v_mfma_f32_16x16x32_bf16 v[132:135], v[48:51], a[96:99], v[132:135]
    ds_read_b128 v[80:83], v2 offset:45056
    v_mfma_f32_16x16x32_bf16 v[140:143], v[52:55], a[96:99], v[140:143]
    ds_read_b128 v[84:87], v2 offset:46080
    buffer_load_dwordx4 a[60:63], v254, s[8:11], s60 offen offset:3072 sc1
    s_waitcnt lgkmcnt(6)
    v_mfma_f32_16x16x32_bf16 v[148:151], v[56:59], a[96:99], v[148:151]
    ds_read_b128 v[88:91], v2 offset:47104
    v_mfma_f32_16x16x32_bf16 v[156:159], v[60:63], a[96:99], v[156:159]
    ds_read_b128 v[92:95], v2 offset:48128
    s_waitcnt lgkmcnt(6)
    v_mfma_f32_16x16x32_bf16 v[100:103], v[64:67], a[100:103], v[100:103]
    ds_read_b128 v[32:35], v2 offset:49152
    v_mfma_f32_16x16x32_bf16 v[108:111], v[68:71], a[100:103], v[108:111]
    ds_read_b128 v[36:39], v2 offset:50176
    buffer_load_dwordx4 a[112:115], v254, s[8:11], s61 offen offset:0 sc1
    s_waitcnt lgkmcnt(6)
    v_mfma_f32_16x16x32_bf16 v[116:119], v[72:75], a[100:103], v[116:119]
    ds_read_b128 v[40:43], v2 offset:51200
    v_mfma_f32_16x16x32_bf16 v[124:127], v[76:79], a[100:103], v[124:127]
    ds_read_b128 v[44:47], v2 offset:52224
    s_waitcnt lgkmcnt(6)
    v_mfma_f32_16x16x32_bf16 v[132:135], v[80:83], a[100:103], v[132:135]
    ds_read_b128 v[48:51], v2 offset:53248
    v_mfma_f32_16x16x32_bf16 v[140:143], v[84:87], a[100:103], v[140:143]
    ds_read_b128 v[52:55], v2 offset:54272
    buffer_load_dwordx4 a[116:119], v254, s[8:11], s61 offen offset:1024 sc1
    s_waitcnt lgkmcnt(6)
    v_mfma_f32_16x16x32_bf16 v[148:151], v[88:91], a[100:103], v[148:151]
    ds_read_b128 v[56:59], v2 offset:55296
    v_mfma_f32_16x16x32_bf16 v[156:159], v[92:95], a[100:103], v[156:159]
    ds_read_b128 v[60:63], v2 offset:56320
    s_waitcnt lgkmcnt(6)
    v_mfma_f32_16x16x32_bf16 v[100:103], v[32:35], a[104:107], v[100:103]
    ds_read_b128 v[64:67], v2 offset:57344
    v_mfma_f32_16x16x32_bf16 v[108:111], v[36:39], a[104:107], v[108:111]
    ds_read_b128 v[68:71], v2 offset:58368
    buffer_load_dwordx4 a[120:123], v254, s[8:11], s61 offen offset:2048 sc1
    s_waitcnt lgkmcnt(6)
    v_mfma_f32_16x16x32_bf16 v[116:119], v[40:43], a[104:107], v[116:119]
    ds_read_b128 v[72:75], v2 offset:59392
    v_mfma_f32_16x16x32_bf16 v[124:127], v[44:47], a[104:107], v[124:127]
    ds_read_b128 v[76:79], v2 offset:60416
    s_waitcnt lgkmcnt(6)
    v_mfma_f32_16x16x32_bf16 v[132:135], v[48:51], a[104:107], v[132:135]
    ds_read_b128 v[80:83], v2 offset:61440
    v_mfma_f32_16x16x32_bf16 v[140:143], v[52:55], a[104:107], v[140:143]
    ds_read_b128 v[84:87], v2 offset:62464
    buffer_load_dwordx4 a[124:127], v254, s[8:11], s61 offen offset:3072 sc1
    s_waitcnt lgkmcnt(6)
    v_mfma_f32_16x16x32_bf16 v[148:151], v[56:59], a[104:107], v[148:151]
    ds_read_b128 v[88:91], v2 offset:63488
    v_mfma_f32_16x16x32_bf16 v[156:159], v[60:63], a[104:107], v[156:159]
    ds_read_b128 v[92:95], v2 offset:64512
    s_waitcnt vmcnt(12) lgkmcnt(6)
    v_mfma_f32_16x16x32_bf16 v[100:103], v[64:67], a[108:111], v[100:103]
    ds_read_b128 v[32:35], v10 offset:32768
    v_mfma_f32_16x16x32_bf16 v[108:111], v[68:71], a[108:111], v[108:111]
    ds_read_b128 v[36:39], v10 offset:33792
    buffer_load_dword v13, v253, s[96:99], 0 offen
    s_waitcnt lgkmcnt(6)
    v_mfma_f32_16x16x32_bf16 v[116:119], v[72:75], a[108:111], v[116:119]
    ds_read_b128 v[40:43], v10 offset:34816
    v_mfma_f32_16x16x32_bf16 v[124:127], v[76:79], a[108:111], v[124:127]
    ds_read_b128 v[44:47], v10 offset:35840
    s_waitcnt lgkmcnt(6)
    v_mfma_f32_16x16x32_bf16 v[132:135], v[80:83], a[108:111], v[132:135]
    ds_read_b128 v[48:51], v10 offset:36864
    v_mfma_f32_16x16x32_bf16 v[140:143], v[84:87], a[108:111], v[140:143]
    ds_read_b128 v[52:55], v10 offset:37888
    s_waitcnt lgkmcnt(6)
    v_mfma_f32_16x16x32_bf16 v[148:151], v[88:91], a[108:111], v[148:151]
    ds_read_b128 v[56:59], v10 offset:38912
    v_mfma_f32_16x16x32_bf16 v[156:159], v[92:95], a[108:111], v[156:159]
    ds_read_b128 v[60:63], v10 offset:39936
    s_waitcnt vmcnt(12) lgkmcnt(6)
    v_mfma_f32_16x16x32_bf16 v[96:99], v[32:35], a[32:35], v[96:99]
    ds_read_b128 v[64:67], v10 offset:40960
    v_mfma_f32_16x16x32_bf16 v[104:107], v[36:39], a[32:35], v[104:107]
    ds_read_b128 v[68:71], v10 offset:41984
    v_cvt_pk_bf16_f32 v160, v100, v101
    s_waitcnt lgkmcnt(6)
    v_mfma_f32_16x16x32_bf16 v[112:115], v[40:43], a[32:35], v[112:115]
    ds_read_b128 v[72:75], v10 offset:43008
    v_cvt_pk_bf16_f32 v161, v102, v103
    v_mfma_f32_16x16x32_bf16 v[120:123], v[44:47], a[32:35], v[120:123]
    ds_read_b128 v[76:79], v10 offset:44032
    v_cvt_pk_bf16_f32 v162, v108, v109
    s_waitcnt lgkmcnt(6)
    v_mfma_f32_16x16x32_bf16 v[128:131], v[48:51], a[32:35], v[128:131]
    ds_read_b128 v[80:83], v10 offset:45056
    v_cvt_pk_bf16_f32 v163, v110, v111
    v_mfma_f32_16x16x32_bf16 v[136:139], v[52:55], a[32:35], v[136:139]
    ds_read_b128 v[84:87], v10 offset:46080
    buffer_store_dwordx4 v[160:163], v2, s[8:11], s59 offen offset:0 sc1
    s_waitcnt lgkmcnt(6)
    v_mfma_f32_16x16x32_bf16 v[144:147], v[56:59], a[32:35], v[144:147]
    ds_read_b128 v[88:91], v10 offset:47104
    v_cvt_pk_bf16_f32 v164, v116, v117
    v_mfma_f32_16x16x32_bf16 v[152:155], v[60:63], a[32:35], v[152:155]
    ds_read_b128 v[92:95], v10 offset:48128
    v_cvt_pk_bf16_f32 v165, v118, v119
    s_waitcnt vmcnt(12) lgkmcnt(6)
    v_mfma_f32_16x16x32_bf16 v[96:99], v[64:67], a[36:39], v[96:99]
    ds_read_b128 v[32:35], v10 offset:49152
    v_cvt_pk_bf16_f32 v166, v124, v125
    v_mfma_f32_16x16x32_bf16 v[104:107], v[68:71], a[36:39], v[104:107]
    ds_read_b128 v[36:39], v10 offset:50176
    v_cvt_pk_bf16_f32 v167, v126, v127
    s_waitcnt lgkmcnt(6)
    v_mfma_f32_16x16x32_bf16 v[112:115], v[72:75], a[36:39], v[112:115]
    ds_read_b128 v[40:43], v10 offset:51200
    buffer_store_dwordx4 v[164:167], v2, s[8:11], s59 offen offset:1024 sc1
    v_mfma_f32_16x16x32_bf16 v[120:123], v[76:79], a[36:39], v[120:123]
    ds_read_b128 v[44:47], v10 offset:52224
    v_cvt_pk_bf16_f32 v168, v132, v133
    s_waitcnt lgkmcnt(6)
    v_mfma_f32_16x16x32_bf16 v[128:131], v[80:83], a[36:39], v[128:131]
    ds_read_b128 v[48:51], v10 offset:53248
    v_cvt_pk_bf16_f32 v169, v134, v135
    v_mfma_f32_16x16x32_bf16 v[136:139], v[84:87], a[36:39], v[136:139]
    ds_read_b128 v[52:55], v10 offset:54272
    v_cvt_pk_bf16_f32 v170, v140, v141
    s_waitcnt lgkmcnt(6)
    v_mfma_f32_16x16x32_bf16 v[144:147], v[88:91], a[36:39], v[144:147]
    ds_read_b128 v[56:59], v10 offset:55296
    v_cvt_pk_bf16_f32 v171, v142, v143
    v_mfma_f32_16x16x32_bf16 v[152:155], v[92:95], a[36:39], v[152:155]
    ds_read_b128 v[60:63], v10 offset:56320
    buffer_store_dwordx4 v[168:171], v2, s[8:11], s59 offen offset:2048 sc1
    s_waitcnt vmcnt(13) lgkmcnt(6)
    v_mfma_f32_16x16x32_bf16 v[96:99], v[32:35], a[40:43], v[96:99]
    ds_read_b128 v[64:67], v10 offset:57344
    v_cvt_pk_bf16_f32 v172, v148, v149
    v_mfma_f32_16x16x32_bf16 v[104:107], v[36:39], a[40:43], v[104:107]
    ds_read_b128 v[68:71], v10 offset:58368
    v_cvt_pk_bf16_f32 v173, v150, v151
    s_waitcnt lgkmcnt(6)
    v_mfma_f32_16x16x32_bf16 v[112:115], v[40:43], a[40:43], v[112:115]
    ds_read_b128 v[72:75], v10 offset:59392
    v_cvt_pk_bf16_f32 v174, v156, v157
    v_mfma_f32_16x16x32_bf16 v[120:123], v[44:47], a[40:43], v[120:123]
    ds_read_b128 v[76:79], v10 offset:60416
    v_cvt_pk_bf16_f32 v175, v158, v159
    s_waitcnt lgkmcnt(6)
    v_mfma_f32_16x16x32_bf16 v[128:131], v[48:51], a[40:43], v[128:131]
    ds_read_b128 v[80:83], v10 offset:61440
    buffer_store_dwordx4 v[172:175], v2, s[8:11], s59 offen offset:3072 sc1
    v_mfma_f32_16x16x32_bf16 v[136:139], v[52:55], a[40:43], v[136:139]
    ds_read_b128 v[84:87], v10 offset:62464
    s_waitcnt lgkmcnt(6)
    v_mfma_f32_16x16x32_bf16 v[144:147], v[56:59], a[40:43], v[144:147]
    ds_read_b128 v[88:91], v10 offset:63488
    v_mfma_f32_16x16x32_bf16 v[152:155], v[60:63], a[40:43], v[152:155]
    ds_read_b128 v[92:95], v10 offset:64512
    s_waitcnt vmcnt(13) lgkmcnt(6)
    v_mfma_f32_16x16x32_bf16 v[96:99], v[64:67], a[44:47], v[96:99]
    ds_read_b128 v[32:35], v2 offset:0
    v_mfma_f32_16x16x32_bf16 v[104:107], v[68:71], a[44:47], v[104:107]
    ds_read_b128 v[36:39], v2 offset:1024
    s_waitcnt lgkmcnt(6)
    v_mfma_f32_16x16x32_bf16 v[112:115], v[72:75], a[44:47], v[112:115]
    ds_read_b128 v[40:43], v2 offset:2048
    v_mfma_f32_16x16x32_bf16 v[120:123], v[76:79], a[44:47], v[120:123]
    ds_read_b128 v[44:47], v2 offset:3072
    s_waitcnt lgkmcnt(6)
    v_mfma_f32_16x16x32_bf16 v[128:131], v[80:83], a[44:47], v[128:131]
    ds_read_b128 v[48:51], v2 offset:4096
    v_mfma_f32_16x16x32_bf16 v[136:139], v[84:87], a[44:47], v[136:139]
    ds_read_b128 v[52:55], v2 offset:5120
    s_waitcnt lgkmcnt(6)
    v_mfma_f32_16x16x32_bf16 v[144:147], v[88:91], a[44:47], v[144:147]
    ds_read_b128 v[56:59], v2 offset:6144
    v_mfma_f32_16x16x32_bf16 v[152:155], v[92:95], a[44:47], v[152:155]
    ds_read_b128 v[60:63], v2 offset:7168
    s_waitcnt vmcnt(12) lgkmcnt(6)
    v_mfma_f32_16x16x32_bf16 v[96:99], v[32:35], a[48:51], v[96:99]
    ds_read_b128 v[64:67], v2 offset:8192
    v_mfma_f32_16x16x32_bf16 v[104:107], v[36:39], a[48:51], v[104:107]
    ds_read_b128 v[68:71], v2 offset:9216
    s_waitcnt lgkmcnt(6)
    v_mfma_f32_16x16x32_bf16 v[112:115], v[40:43], a[48:51], v[112:115]
    ds_read_b128 v[72:75], v2 offset:10240
    v_mfma_f32_16x16x32_bf16 v[120:123], v[44:47], a[48:51], v[120:123]
    ds_read_b128 v[76:79], v2 offset:11264
    s_waitcnt lgkmcnt(6)
    v_mfma_f32_16x16x32_bf16 v[128:131], v[48:51], a[48:51], v[128:131]
    ds_read_b128 v[80:83], v2 offset:12288
    v_mfma_f32_16x16x32_bf16 v[136:139], v[52:55], a[48:51], v[136:139]
    ds_read_b128 v[84:87], v2 offset:13312
    s_waitcnt lgkmcnt(6)
    v_mfma_f32_16x16x32_bf16 v[144:147], v[56:59], a[48:51], v[144:147]
    ds_read_b128 v[88:91], v2 offset:14336
    v_mfma_f32_16x16x32_bf16 v[152:155], v[60:63], a[48:51], v[152:155]
    ds_read_b128 v[92:95], v2 offset:15360
    s_waitcnt vmcnt(11) lgkmcnt(6)
    v_mfma_f32_16x16x32_bf16 v[96:99], v[64:67], a[52:55], v[96:99]
    ds_read_b128 v[32:35], v2 offset:16384
    v_mfma_f32_16x16x32_bf16 v[104:107], v[68:71], a[52:55], v[104:107]
    ds_read_b128 v[36:39], v2 offset:17408
    s_waitcnt lgkmcnt(6)
    v_mfma_f32_16x16x32_bf16 v[112:115], v[72:75], a[52:55], v[112:115]
    ds_read_b128 v[40:43], v2 offset:18432
    v_mfma_f32_16x16x32_bf16 v[120:123], v[76:79], a[52:55], v[120:123]
    ds_read_b128 v[44:47], v2 offset:19456
    s_waitcnt lgkmcnt(6)
    v_mfma_f32_16x16x32_bf16 v[128:131], v[80:83], a[52:55], v[128:131]
    ds_read_b128 v[48:51], v2 offset:20480
    v_mfma_f32_16x16x32_bf16 v[136:139], v[84:87], a[52:55], v[136:139]
    ds_read_b128 v[52:55], v2 offset:21504
    s_waitcnt lgkmcnt(6)
    v_mfma_f32_16x16x32_bf16 v[144:147], v[88:91], a[52:55], v[144:147]
    ds_read_b128 v[56:59], v2 offset:22528
    v_mfma_f32_16x16x32_bf16 v[152:155], v[92:95], a[52:55], v[152:155]
    ds_read_b128 v[60:63], v2 offset:23552
    s_waitcnt vmcnt(10) lgkmcnt(6)
    v_mfma_f32_16x16x32_bf16 v[96:99], v[32:35], a[56:59], v[96:99]
    ds_read_b128 v[64:67], v2 offset:24576
    v_mfma_f32_16x16x32_bf16 v[104:107], v[36:39], a[56:59], v[104:107]
    ds_read_b128 v[68:71], v2 offset:25600
    s_waitcnt lgkmcnt(6)
    v_mfma_f32_16x16x32_bf16 v[112:115], v[40:43], a[56:59], v[112:115]
    ds_read_b128 v[72:75], v2 offset:26624
    v_mfma_f32_16x16x32_bf16 v[120:123], v[44:47], a[56:59], v[120:123]
    ds_read_b128 v[76:79], v2 offset:27648
    s_waitcnt lgkmcnt(6)
    v_mfma_f32_16x16x32_bf16 v[128:131], v[48:51], a[56:59], v[128:131]
    ds_read_b128 v[80:83], v2 offset:28672
    v_mfma_f32_16x16x32_bf16 v[136:139], v[52:55], a[56:59], v[136:139]
    ds_read_b128 v[84:87], v2 offset:29696
    s_waitcnt lgkmcnt(6)
    v_mfma_f32_16x16x32_bf16 v[144:147], v[56:59], a[56:59], v[144:147]
    ds_read_b128 v[88:91], v2 offset:30720
    v_mfma_f32_16x16x32_bf16 v[152:155], v[60:63], a[56:59], v[152:155]
    ds_read_b128 v[92:95], v2 offset:31744
    s_waitcnt vmcnt(9) lgkmcnt(6)
    v_mfma_f32_16x16x32_bf16 v[96:99], v[64:67], a[60:63], v[96:99]
    ds_read_b128 v[32:35], v2 offset:32768
    v_mfma_f32_16x16x32_bf16 v[104:107], v[68:71], a[60:63], v[104:107]
    ds_read_b128 v[36:39], v2 offset:33792
    s_waitcnt lgkmcnt(6)
    v_mfma_f32_16x16x32_bf16 v[112:115], v[72:75], a[60:63], v[112:115]
    ds_read_b128 v[40:43], v2 offset:34816
    v_mfma_f32_16x16x32_bf16 v[120:123], v[76:79], a[60:63], v[120:123]
    ds_read_b128 v[44:47], v2 offset:35840
    s_waitcnt lgkmcnt(6)
    v_mfma_f32_16x16x32_bf16 v[128:131], v[80:83], a[60:63], v[128:131]
    ds_read_b128 v[48:51], v2 offset:36864
    v_mfma_f32_16x16x32_bf16 v[136:139], v[84:87], a[60:63], v[136:139]
    ds_read_b128 v[52:55], v2 offset:37888
    s_waitcnt lgkmcnt(6)
    v_mfma_f32_16x16x32_bf16 v[144:147], v[88:91], a[60:63], v[144:147]
    ds_read_b128 v[56:59], v2 offset:38912
    v_mfma_f32_16x16x32_bf16 v[152:155], v[92:95], a[60:63], v[152:155]
    ds_read_b128 v[60:63], v2 offset:39936
    s_waitcnt vmcnt(8)
    s_waitcnt vmcnt(0)
    s_mov_b64 exec, 1
    buffer_store_dword v251, v250, s[8:11], s56 offen sc1
    s_mov_b64 exec, -1
    s_waitcnt lgkmcnt(6)
    v_mfma_f32_16x16x32_bf16 v[96:99], v[32:35], a[112:115], v[96:99]
    ds_read_b128 v[64:67], v2 offset:40960
    v_mfma_f32_16x16x32_bf16 v[104:107], v[36:39], a[112:115], v[104:107]
    ds_read_b128 v[68:71], v2 offset:41984
    s_waitcnt lgkmcnt(6)
    v_mfma_f32_16x16x32_bf16 v[112:115], v[40:43], a[112:115], v[112:115]
    ds_read_b128 v[72:75], v2 offset:43008
    v_mfma_f32_16x16x32_bf16 v[120:123], v[44:47], a[112:115], v[120:123]
    ds_read_b128 v[76:79], v2 offset:44032
    s_waitcnt lgkmcnt(6)
    v_mfma_f32_16x16x32_bf16 v[128:131], v[48:51], a[112:115], v[128:131]
    ds_read_b128 v[80:83], v2 offset:45056
    v_mfma_f32_16x16x32_bf16 v[136:139], v[52:55], a[112:115], v[136:139]
    ds_read_b128 v[84:87], v2 offset:46080
    s_waitcnt lgkmcnt(6)
    v_mfma_f32_16x16x32_bf16 v[144:147], v[56:59], a[112:115], v[144:147]
    ds_read_b128 v[88:91], v2 offset:47104
    v_mfma_f32_16x16x32_bf16 v[152:155], v[60:63], a[112:115], v[152:155]
    ds_read_b128 v[92:95], v2 offset:48128
    s_waitcnt lgkmcnt(6)
    v_mfma_f32_16x16x32_bf16 v[96:99], v[64:67], a[116:119], v[96:99]
    ds_read_b128 v[32:35], v2 offset:49152
    v_mfma_f32_16x16x32_bf16 v[104:107], v[68:71], a[116:119], v[104:107]
    ds_read_b128 v[36:39], v2 offset:50176
    s_waitcnt lgkmcnt(6)
    v_mfma_f32_16x16x32_bf16 v[112:115], v[72:75], a[116:119], v[112:115]
    ds_read_b128 v[40:43], v2 offset:51200
    v_mfma_f32_16x16x32_bf16 v[120:123], v[76:79], a[116:119], v[120:123]
    ds_read_b128 v[44:47], v2 offset:52224
    s_waitcnt lgkmcnt(6)
    v_mfma_f32_16x16x32_bf16 v[128:131], v[80:83], a[116:119], v[128:131]
    ds_read_b128 v[48:51], v2 offset:53248
    v_mfma_f32_16x16x32_bf16 v[136:139], v[84:87], a[116:119], v[136:139]
    ds_read_b128 v[52:55], v2 offset:54272
    s_waitcnt lgkmcnt(6)
    v_mfma_f32_16x16x32_bf16 v[144:147], v[88:91], a[116:119], v[144:147]
    ds_read_b128 v[56:59], v2 offset:55296
    v_mfma_f32_16x16x32_bf16 v[152:155], v[92:95], a[116:119], v[152:155]
    ds_read_b128 v[60:63], v2 offset:56320
    s_waitcnt lgkmcnt(6)
    v_mfma_f32_16x16x32_bf16 v[96:99], v[32:35], a[120:123], v[96:99]
    ds_read_b128 v[64:67], v2 offset:57344
    v_mfma_f32_16x16x32_bf16 v[104:107], v[36:39], a[120:123], v[104:107]
    ds_read_b128 v[68:71], v2 offset:58368
    s_waitcnt lgkmcnt(6)
    v_mfma_f32_16x16x32_bf16 v[112:115], v[40:43], a[120:123], v[112:115]
    ds_read_b128 v[72:75], v2 offset:59392
    v_mfma_f32_16x16x32_bf16 v[120:123], v[44:47], a[120:123], v[120:123]
    ds_read_b128 v[76:79], v2 offset:60416
    s_waitcnt lgkmcnt(6)
    v_mfma_f32_16x16x32_bf16 v[128:131], v[48:51], a[120:123], v[128:131]
    ds_read_b128 v[80:83], v2 offset:61440
    v_mfma_f32_16x16x32_bf16 v[136:139], v[52:55], a[120:123], v[136:139]
    ds_read_b128 v[84:87], v2 offset:62464
    s_waitcnt lgkmcnt(6)
    v_mfma_f32_16x16x32_bf16 v[144:147], v[56:59], a[120:123], v[144:147]
    ds_read_b128 v[88:91], v2 offset:63488
    v_mfma_f32_16x16x32_bf16 v[152:155], v[60:63], a[120:123], v[152:155]
    ds_read_b128 v[92:95], v2 offset:64512
    buffer_load_dword v249, v250, s[8:11], s51 offen sc1
    s_waitcnt lgkmcnt(6)
    v_mfma_f32_16x16x32_bf16 v[96:99], v[64:67], a[124:127], v[96:99]
    v_mfma_f32_16x16x32_bf16 v[104:107], v[68:71], a[124:127], v[104:107]
    s_waitcnt lgkmcnt(4)
    v_mfma_f32_16x16x32_bf16 v[112:115], v[72:75], a[124:127], v[112:115]
    v_mfma_f32_16x16x32_bf16 v[120:123], v[76:79], a[124:127], v[120:123]
    s_waitcnt lgkmcnt(2)
    v_mfma_f32_16x16x32_bf16 v[128:131], v[80:83], a[124:127], v[128:131]
    v_mfma_f32_16x16x32_bf16 v[136:139], v[84:87], a[124:127], v[136:139]
    s_waitcnt lgkmcnt(0)
    v_mfma_f32_16x16x32_bf16 v[144:147], v[88:91], a[124:127], v[144:147]
    v_mfma_f32_16x16x32_bf16 v[152:155], v[92:95], a[124:127], v[152:155]
    s_waitcnt vmcnt(0)
    s_mov_b32 s3, 0x40000
L_gg_poll2:
    v_readfirstlane_b32 s95, v249
    s_nop 0
    s_cmp_ge_u32 s95, 1
    s_cbranch_scc1 L_gg_poll2_x
    buffer_load_dword v249, v250, s[8:11], s51 offen offset:0 sc1
    s_sub_u32 s3, s3, 1
    s_waitcnt vmcnt(0)
    s_cmp_lg_u32 s3, 0
    s_cbranch_scc1 L_gg_poll2
L_gg_poll2_x:
    buffer_load_dwordx4 v[160:163], v2, s[8:11], s53 offen offset:0 sc1
    buffer_load_dwordx4 v[164:167], v2, s[8:11], s53 offen offset:1024 sc1
    buffer_load_dwordx4 v[168:171], v2, s[8:11], s53 offen offset:2048 sc1
    buffer_load_dwordx4 v[172:175], v2, s[8:11], s53 offen offset:3072 sc1
    s_waitcnt vmcnt(3)
    v_dot2_f32_bf16 v96, v160, s48, v96
    v_dot2_f32_bf16 v97, v160, s49, v97
    v_dot2_f32_bf16 v98, v161, s48, v98
    v_dot2_f32_bf16 v99, v161, s49, v99
    v_dot2_f32_bf16 v104, v162, s48, v104
    v_dot2_f32_bf16 v105, v162, s49, v105
    v_dot2_f32_bf16 v106, v163, s48, v106
    v_dot2_f32_bf16 v107, v163, s49, v107
    v_cvt_pk_bf16_f32 v32, v96, v97
    v_cvt_pk_bf16_f32 v33, v98, v99
    v_cvt_pk_bf16_f32 v34, v104, v105
    v_cvt_pk_bf16_f32 v35, v106, v107
    s_nop 0
    v_permlane32_swap_b32 v32, v34
    v_permlane32_swap_b32 v33, v35
    ds_write_b128 v9, v[32:35] offset:0
    s_waitcnt vmcnt(2)
    v_dot2_f32_bf16 v112, v164, s48, v112
    v_dot2_f32_bf16 v113, v164, s49, v113
    v_dot2_f32_bf16 v114, v165, s48, v114
    v_dot2_f32_bf16 v115, v165, s49, v115
    v_dot2_f32_bf16 v120, v166, s48, v120
    v_dot2_f32_bf16 v121, v166, s49, v121
    v_dot2_f32_bf16 v122, v167, s48, v122
    v_dot2_f32_bf16 v123, v167, s49, v123
    v_cvt_pk_bf16_f32 v36, v112, v113
    v_cvt_pk_bf16_f32 v37, v114, v115
    v_cvt_pk_bf16_f32 v38, v120, v121
    v_cvt_pk_bf16_f32 v39, v122, v123
    s_nop 0
    v_permlane32_swap_b32 v36, v38
    v_permlane32_swap_b32 v37, v39
    ds_write_b128 v9, v[36:39] offset:64
    s_waitcnt vmcnt(1)
    v_dot2_f32_bf16 v128, v168, s48, v128
    v_dot2_f32_bf16 v129, v168, s49, v129
    v_dot2_f32_bf16 v130, v169, s48, v130
    v_dot2_f32_bf16 v131, v169, s49, v131
    v_dot2_f32_bf16 v136, v170, s48, v136
    v_dot2_f32_bf16 v137, v170, s49, v137
    v_dot2_f32_bf16 v138, v171, s48, v138
    v_dot2_f32_bf16 v139, v171, s49, v139
    v_cvt_pk_bf16_f32 v40, v128, v129
    v_cvt_pk_bf16_f32 v41, v130, v131
    v_cvt_pk_bf16_f32 v42, v136, v137
    v_cvt_pk_bf16_f32 v43, v138, v139
    s_nop 0
    v_permlane32_swap_b32 v40, v42
    v_permlane32_swap_b32 v41, v43
    ds_write_b128 v9, v[40:43] offset:128
    s_waitcnt vmcnt(0)
    v_dot2_f32_bf16 v144, v172, s48, v144
    v_dot2_f32_bf16 v145, v172, s49, v145
    v_dot2_f32_bf16 v146, v173, s48, v146
    v_dot2_f32_bf16 v147, v173, s49, v147
    v_dot2_f32_bf16 v152, v174, s48, v152
    v_dot2_f32_bf16 v153, v174, s49, v153
    v_dot2_f32_bf16 v154, v175, s48, v154
    v_dot2_f32_bf16 v155, v175, s49, v155
    v_cvt_pk_bf16_f32 v44, v144, v145
    v_cvt_pk_bf16_f32 v45, v146, v147
    v_cvt_pk_bf16_f32 v46, v152, v153
    v_cvt_pk_bf16_f32 v47, v154, v155
    s_nop 0
    v_permlane32_swap_b32 v44, v46
    v_permlane32_swap_b32 v45, v47
    ds_write_b128 v9, v[44:47] offset:192
    s_waitcnt lgkmcnt(0)
    ds_read_b128 v[64:67], v8 offset:0
    ds_read_b128 v[68:71], v8 offset:1088
    ds_read_b128 v[72:75], v8 offset:2176
    ds_read_b128 v[76:79], v8 offset:3264
    s_add_u32 s59, s50, 0
    s_waitcnt lgkmcnt(3)
    buffer_store_dwordx4 v[64:67], v6, s[32:35], s59 offen sc1
    s_add_u32 s59, s50, 2097152
    s_waitcnt lgkmcnt(2)
    buffer_store_dwordx4 v[68:71], v6, s[32:35], s59 offen sc1
    s_add_u32 s59, s50, 2048
    s_waitcnt lgkmcnt(1)
    buffer_store_dwordx4 v[72:75], v6, s[32:35], s59 offen sc1
    s_add_u32 s59, s50, 2099200
    s_waitcnt lgkmcnt(0)
    buffer_store_dwordx4 v[76:79], v6, s[32:35], s59 offen sc1
    s_cmp_eq_u32 s23, 0
    s_cbranch_scc1 L_gg_nok1
    s_and_b32 s3, s2, 3
    s_lshl_b32 s76, s3, 6
    s_lshr_b32 s3, s2, 4
    s_lshl_b32 s3, s3, 2
    s_or_b32 s76, s76, s3
    s_bfe_u32 s3, s2, 0x10002
    s_lshl_b32 s3, s3, 1
    s_or_b32 s76, s76, s3
    s_bfe_u32 s3, s2, 0x10003
    s_or_b32 s76, s76, s3
    s_getpc_b64 s[28:29]
Lpc_k1p:
    s_add_u32 s28, s28, tbl_k1-Lpc_k1p
    s_addc_u32 s29, s29, 0
    global_load_dwordx4 v[176:179], v2, s[28:29]
    global_load_dwordx4 v[180:183], v2, s[28:29] offset:1024
    s_and_b32 s77, s2, 7
    s_bfe_u32 s3, s76, 0x20004
    s_lshl_b32 s3, s3, 3
    s_or_b32 s77, s77, s3
    s_lshl_b32 s77, s77, 2
    s_bfe_u32 s3, s76, 0x20002
    s_add_u32 s77, s77, s3
    s_lshl_b32 s77, s77, 6
    s_add_u32 s77, s77, s21
    s_add_u32 s77, s77, 13697056
    v_and_b32 v227, 7, v1
    v_lshlrev_b32 v227, 13, v227
    s_lshl_b32 s78, s22, 8
    s_add_u32 s78, s78, s76
    s_lshl_b32 s78, s78, 11
    s_add_u32 s79, s78, 2097152
    s_lshl_b32 s80, s22, 11
    s_mov_b32 s72, 0x00010001
    s_mov_b32 s73, 0x00010001
    s_mov_b32 s74, 1
    s_mov_b32 s75, 0
    v_cndmask_b32 v12, v4, 16, s[72:73]
    v_cvt_f32_u32 v12, v12
    v_cvt_f32_u32 v13, v3
    v_mul_f32 v12, 0x3a800000, v12
    v_mul_f32 v13, v13, v12
    v_mul_f32 v13, 4.0, v13
    v_cos_f32 v208, v13
    v_sin_f32 v216, v13
    v_add_f32 v13, v13, v12
    v_cos_f32 v209, v13
    v_sin_f32 v217, v13
    v_add_f32 v13, v13, v12
    v_cos_f32 v210, v13
    v_sin_f32 v218, v13
    v_add_f32 v13, v13, v12
    v_cos_f32 v211, v13
    v_sin_f32 v219, v13
    v_fmac_f32 v13, 0x41500000, v12
    v_cos_f32 v212, v13
    v_sin_f32 v220, v13
    v_add_f32 v13, v13, v12
    v_cos_f32 v213, v13
    v_sin_f32 v221, v13
    v_add_f32 v13, v13, v12
    v_cos_f32 v214, v13
    v_sin_f32 v222, v13
    v_add_f32 v13, v13, v12
    v_cos_f32 v215, v13
    v_sin_f32 v223, v13
    s_waitcnt vmcnt(0)
    s_mov_b64 exec, 1
    buffer_store_dword v251, v250, s[8:11], s56 offen offset:32 sc1
    s_mov_b64 exec, -1
    s_barrier
    v_mov_b32 v204, 0x3f803f80
    v_mov_b32 v205, 0x3f803f80
    v_mov_b32 v206, 0x3f803f80
    v_mov_b32 v207, 0x3f803f80
    v_mov_b32 v12, 0xbf803f80
    v_xor_b32 v184, 0x80008000, v180
    v_xor_b32 v188, 0x80000000, v176
    v_xor_b32 v192, 0x80000000, v180
    v_xor_b32 v196, 0x00008000, v180
    v_cndmask_b32 v200, v176, v12, s[72:73]
    v_xor_b32 v185, 0x80008000, v181
    v_xor_b32 v189, 0x80000000, v177
    v_xor_b32 v193, 0x80000000, v181
    v_xor_b32 v197, 0x00008000, v181
    v_cndmask_b32 v201, v177, v12, s[72:73]
    v_xor_b32 v186, 0x80008000, v182
    v_xor_b32 v190, 0x80000000, v178
    v_xor_b32 v194, 0x80000000, v182
    v_xor_b32 v198, 0x00008000, v182
    v_cndmask_b32 v202, v178, v12, s[72:73]
    v_xor_b32 v187, 0x80008000, v183
    v_xor_b32 v191, 0x80000000, v179
    v_xor_b32 v195, 0x80000000, v183
    v_xor_b32 v199, 0x00008000, v183
    v_cndmask_b32 v203, v179, v12, s[72:73]
    buffer_load_dword v249, v227, s[8:11], s77 offen sc1
    v_lshrrev_b32 v12, 1, v4
    v_and_b32 v13, 1, v4
    v_lshlrev_b32 v13, 9, v13
    v_lshlrev_b32 v14, 9, v3
    v_add_u32 v14, s76, v14
    v_mad_u32_u24 v14, v12, v14, v13
    v_lshl_add_u32 v15, v12, 8, v14
    v_and_b32 v14, 2047, v14
    v_and_b32 v15, 2047, v15
    v_cvt_f32_u32 v14, v14
    v_cvt_f32_u32 v15, v15
    v_mul_f32 v14, 0x3a000000, v14
    v_mul_f32 v15, 0x3a000000, v15
    v_cos_f32 v240, v14
    v_sin_f32 v241, v14
    v_cos_f32 v242, v15
    v_sin_f32 v243, v15
    v_lshrrev_b32 v228, 2, v1
    v_lshlrev_b32 v228, 6, v228
    v_and_b32 v12, 3, v1
    v_lshl_add_u32 v228, v12, 3, v228
    v_add_u32 v228, s80, v228
    v_add_u32 v229, s80, v2
    v_lshlrev_b32 v230, 12, v3
    v_lshl_add_u32 v230, v4, 4, v230
    s_lshl_b32 s3, s22, 8
    v_add_u32 v230, s3, v230
    v_lshlrev_b32 v231, 20, v3
    v_lshl_add_u32 v231, v4, 4, v231
    s_lshl_b32 s81, s76, 12
    s_lshl_b32 s3, s22, 9
    s_add_u32 s81, s81, s3
    s_add_u32 s81, s81, 58720256
    s_lshl_b32 s3, s22, 2
    v_mov_b32 v232, s3
    v_lshlrev_b32 v233, 3, v3
    s_waitcnt vmcnt(0)
    s_mov_b32 s3, 0x40000
L_gg_pollx:
    v_cmp_eq_u32 vcc, 0, v249
    s_nop 4
    s_cbranch_vccz L_gg_pollx_x
    buffer_load_dword v249, v227, s[8:11], s77 offen sc1
    s_sub_u32 s3, s3, 1
    s_waitcnt vmcnt(0)
    s_cmp_lg_u32 s3, 0
    s_cbranch_scc1 L_gg_pollx
L_gg_pollx_x:
    s_add_u32 m0, s80, 0
    s_nop 0
    buffer_load_dwordx4 v2, s[32:35], s78 offen sc1 lds
    buffer_load_dwordx4 v2, s[32:35], s78 offen offset:1024 sc1 lds
    s_add_u32 m0, s80, 8192
    s_nop 0
    buffer_load_dwordx4 v2, s[32:35], s79 offen sc1 lds
    buffer_load_dwordx4 v2, s[32:35], s79 offen offset:1024 sc1 lds
    s_and_b32 s82, s2, 7
    s_lshl_b32 s82, s82, 5
    s_lshr_b32 s3, s2, 3
    s_add_u32 s82, s82, s3
    s_lshl_b32 s82, s82, 2
    s_add_u32 s82, s82, s22
    s_lshl_b32 s82, s82, 12
    v_lshlrev_b32 v12, 6, v1
    buffer_load_dword v0, v12, s[8:11], s82 offen
    s_waitcnt vmcnt(3)
    ds_read_b64_tr_b16 v[32:33], v228 offset:0
    ds_read_b64_tr_b16 v[34:35], v228 offset:1024
    ds_read_b64_tr_b16 v[36:37], v228 offset:32
    ds_read_b64_tr_b16 v[38:39], v228 offset:1056
    s_waitcnt vmcnt(1)
    ds_read_b64_tr_b16 v[96:97], v228 offset:8192
    ds_read_b64_tr_b16 v[98:99], v228 offset:9216
    ds_read_b64_tr_b16 v[100:101], v228 offset:8224
    ds_read_b64_tr_b16 v[102:103], v228 offset:9248
    s_waitcnt lgkmcnt(4)
    v_mfma_f32_16x16x32_bf16 v[40:43], v[32:35], v[200:203], 0
    v_mfma_f32_16x16x32_bf16 v[48:51], v[32:35], v[180:183], 0
    v_mfma_f32_16x16x32_bf16 v[44:47], v[36:39], v[200:203], 0
    v_mfma_f32_16x16x32_bf16 v[52:55], v[36:39], v[180:183], 0
    s_waitcnt lgkmcnt(0)
    v_mfma_f32_16x16x32_bf16 v[104:107], v[96:99], v[200:203], 0
    v_mfma_f32_16x16x32_bf16 v[112:115], v[96:99], v[180:183], 0
    v_mfma_f32_16x16x32_bf16 v[108:111], v[100:103], v[200:203], 0
    v_mfma_f32_16x16x32_bf16 v[116:119], v[100:103], v[180:183], 0
    v_dot2_f32_bf16 v84, v32, v204, 0
    v_dot2_f32_bf16 v148, v96, v204, 0
    v_dot2_f32_bf16 v85, v32, v32, 0
    v_dot2_f32_bf16 v149, v96, v96, 0
    v_dot2_f32_bf16 v84, v33, v204, v84
    v_dot2_f32_bf16 v148, v97, v204, v148
    v_dot2_f32_bf16 v85, v33, v33, v85
    v_dot2_f32_bf16 v149, v97, v97, v149
    v_dot2_f32_bf16 v84, v34, v204, v84
    v_dot2_f32_bf16 v148, v98, v204, v148
    v_dot2_f32_bf16 v85, v34, v34, v85
    v_dot2_f32_bf16 v149, v98, v98, v149
    v_dot2_f32_bf16 v84, v35, v204, v84
    v_dot2_f32_bf16 v148, v99, v204, v148
    v_dot2_f32_bf16 v85, v35, v35, v85
    v_dot2_f32_bf16 v149, v99, v99, v149
    v_dot2_f32_bf16 v84, v36, v204, v84
    v_dot2_f32_bf16 v148, v100, v204, v148
    v_dot2_f32_bf16 v85, v36, v36, v85
    v_dot2_f32_bf16 v149, v100, v100, v149
    v_dot2_f32_bf16 v84, v37, v204, v84
    v_dot2_f32_bf16 v148, v101, v204, v148
    v_dot2_f32_bf16 v85, v37, v37, v85
    v_dot2_f32_bf16 v149, v101, v101, v149
    v_dot2_f32_bf16 v84, v38, v204, v84
    v_dot2_f32_bf16 v148, v102, v204, v148
    v_dot2_f32_bf16 v85, v38, v38, v85
    v_dot2_f32_bf16 v149, v102, v102, v149
    v_dot2_f32_bf16 v84, v39, v204, v84
    v_dot2_f32_bf16 v148, v103, v204, v148
    v_dot2_f32_bf16 v85, v39, v39, v85
    v_dot2_f32_bf16 v149, v103, v103, v149
    v_mov_b32 v86, 0xbd000000
    v_mov_b32 v150, 0xbd000000
    v_mov_b32 v87, 0x3a800000
    v_mov_b32 v151, 0x3a800000
    v_add_f32_dpp v84, v84, v84 quad_perm:[1,0,3,2] row_mask:0xf bank_mask:0xf
    v_add_f32_dpp v148, v148, v148 quad_perm:[1,0,3,2] row_mask:0xf bank_mask:0xf
    v_add_f32_dpp v85, v85, v85 quad_perm:[1,0,3,2] row_mask:0xf bank_mask:0xf
    v_add_f32_dpp v149, v149, v149 quad_perm:[1,0,3,2] row_mask:0xf bank_mask:0xf
    v_add_f32_dpp v84, v84, v84 quad_perm:[2,3,0,1] row_mask:0xf bank_mask:0xf
    v_add_f32_dpp v148, v148, v148 quad_perm:[2,3,0,1] row_mask:0xf bank_mask:0xf
    v_add_f32_dpp v85, v85, v85 quad_perm:[2,3,0,1] row_mask:0xf bank_mask:0xf
    v_add_f32_dpp v149, v149, v149 quad_perm:[2,3,0,1] row_mask:0xf bank_mask:0xf
    v_add_f32_dpp v84, v84, v84 row_half_mirror row_mask:0xf bank_mask:0xf
    v_add_f32_dpp v148, v148, v148 row_half_mirror row_mask:0xf bank_mask:0xf
    v_add_f32_dpp v85, v85, v85 row_half_mirror row_mask:0xf bank_mask:0xf
    v_add_f32_dpp v149, v149, v149 row_half_mirror row_mask:0xf bank_mask:0xf
    v_add_f32_dpp v84, v84, v84 row_mirror row_mask:0xf bank_mask:0xf
    v_add_f32_dpp v148, v148, v148 row_mirror row_mask:0xf bank_mask:0xf
    v_add_f32_dpp v85, v85, v85 row_mirror row_mask:0xf bank_mask:0xf
    v_add_f32_dpp v149, v149, v149 row_mirror row_mask:0xf bank_mask:0xf
    v_add_f32_dpp v84, v84, v84 row_bcast:15 row_mask:0xa bank_mask:0xf
    v_add_f32_dpp v148, v148, v148 row_bcast:15 row_mask:0xa bank_mask:0xf
    v_add_f32_dpp v85, v85, v85 row_bcast:15 row_mask:0xa bank_mask:0xf
    v_add_f32_dpp v149, v149, v149 row_bcast:15 row_mask:0xa bank_mask:0xf
    v_add_f32_dpp v84, v84, v84 row_bcast:31 row_mask:0xc bank_mask:0xf
    v_add_f32_dpp v148, v148, v148 row_bcast:31 row_mask:0xc bank_mask:0xf
    v_add_f32_dpp v85, v85, v85 row_bcast:31 row_mask:0xc bank_mask:0xf
    v_add_f32_dpp v149, v149, v149 row_bcast:31 row_mask:0xc bank_mask:0xf
    v_readlane_b32 s84, v84, 63
    v_readlane_b32 s86, v148, 63
    v_readlane_b32 s85, v85, 63
    v_readlane_b32 s87, v149, 63
    s_nop 0
    s_nop 0
    v_mul_f32 v64, s84, v86
    v_mul_f32 v128, s86, v150
    v_mul_f32 v65, s84, v86
    v_mul_f32 v129, s86, v150
    v_mul_f32 v66, s84, v86
    v_mul_f32 v130, s86, v150
    v_mul_f32 v67, s84, v86
    v_mul_f32 v131, s86, v150
    s_nop 0
    v_mfma_f32_16x16x32_bf16 v[56:59], v[32:35], v[204:207], v[64:67]
    v_mfma_f32_16x16x32_bf16 v[60:63], v[36:39], v[204:207], v[64:67]
    v_mfma_f32_16x16x32_bf16 v[120:123], v[96:99], v[204:207], v[128:131]
    v_mfma_f32_16x16x32_bf16 v[124:127], v[100:103], v[204:207], v[128:131]
    v_pk_mul_f32 v[68:69], v[40:41], v[208:209]
    v_pk_mul_f32 v[76:77], v[48:49], v[208:209]
    v_pk_mul_f32 v[70:71], v[42:43], v[210:211]
    v_pk_mul_f32 v[78:79], v[50:51], v[210:211]
    v_pk_fma_f32 v[68:69], v[48:49], v[216:217], v[68:69]
    v_pk_fma_f32 v[76:77], v[40:41], v[216:217], v[76:77] neg_lo:[0,1,0] neg_hi:[0,1,0]
    v_pk_fma_f32 v[70:71], v[50:51], v[218:219], v[70:71]
    v_pk_fma_f32 v[78:79], v[42:43], v[218:219], v[78:79] neg_lo:[0,1,0] neg_hi:[0,1,0]
    v_pk_mul_f32 v[72:73], v[44:45], v[212:213]
    v_pk_mul_f32 v[80:81], v[52:53], v[212:213]
    v_pk_mul_f32 v[74:75], v[46:47], v[214:215]
    v_pk_mul_f32 v[82:83], v[54:55], v[214:215]
    v_pk_fma_f32 v[72:73], v[52:53], v[220:221], v[72:73]
    v_pk_fma_f32 v[80:81], v[44:45], v[220:221], v[80:81] neg_lo:[0,1,0] neg_hi:[0,1,0]
    v_pk_fma_f32 v[74:75], v[54:55], v[222:223], v[74:75]
    v_pk_fma_f32 v[82:83], v[46:47], v[222:223], v[82:83] neg_lo:[0,1,0] neg_hi:[0,1,0]
    v_cvt_pk_bf16_f32 v40, v68, v69
    v_cvt_pk_bf16_f32 v44, v76, v77
    v_cvt_pk_bf16_f32 v41, v70, v71
    v_cvt_pk_bf16_f32 v45, v78, v79
    v_cvt_pk_bf16_f32 v42, v72, v73
    v_cvt_pk_bf16_f32 v46, v80, v81
    v_cvt_pk_bf16_f32 v43, v74, v75
    v_cvt_pk_bf16_f32 v47, v82, v83
    v_pk_mul_f32 v[132:133], v[104:105], v[208:209]
    v_pk_mul_f32 v[140:141], v[112:113], v[208:209]
    v_pk_mul_f32 v[134:135], v[106:107], v[210:211]
    v_pk_mul_f32 v[142:143], v[114:115], v[210:211]
    v_pk_fma_f32 v[132:133], v[112:113], v[216:217], v[132:133]
    v_pk_fma_f32 v[140:141], v[104:105], v[216:217], v[140:141] neg_lo:[0,1,0] neg_hi:[0,1,0]
    v_pk_fma_f32 v[134:135], v[114:115], v[218:219], v[134:135]
    v_pk_fma_f32 v[142:143], v[106:107], v[218:219], v[142:143] neg_lo:[0,1,0] neg_hi:[0,1,0]
    v_pk_mul_f32 v[136:137], v[108:109], v[212:213]
    v_pk_mul_f32 v[144:145], v[116:117], v[212:213]
    v_pk_mul_f32 v[138:139], v[110:111], v[214:215]
    v_pk_mul_f32 v[146:147], v[118:119], v[214:215]
    v_pk_fma_f32 v[136:137], v[116:117], v[220:221], v[136:137]
    v_pk_fma_f32 v[144:145], v[108:109], v[220:221], v[144:145] neg_lo:[0,1,0] neg_hi:[0,1,0]
    v_pk_fma_f32 v[138:139], v[118:119], v[222:223], v[138:139]
    v_pk_fma_f32 v[146:147], v[110:111], v[222:223], v[146:147] neg_lo:[0,1,0] neg_hi:[0,1,0]
    v_cvt_pk_bf16_f32 v104, v132, v133
    v_cvt_pk_bf16_f32 v108, v140, v141
    v_cvt_pk_bf16_f32 v105, v134, v135
    v_cvt_pk_bf16_f32 v109, v142, v143
    v_cvt_pk_bf16_f32 v106, v136, v137
    v_cvt_pk_bf16_f32 v110, v144, v145
    v_cvt_pk_bf16_f32 v107, v138, v139
    v_cvt_pk_bf16_f32 v111, v146, v147
    v_mfma_f32_16x16x32_bf16 v[68:71], v[188:191], v[40:43], 0
    v_cvt_pk_bf16_f32 v48, v56, v57
    v_cndmask_b32 v48, v40, v48, s[72:73]
    v_cndmask_b32 v52, v44, 0, s[72:73]
    v_mfma_f32_16x16x32_bf16 v[72:75], v[188:191], v[44:47], 0
    v_cvt_pk_bf16_f32 v49, v58, v59
    v_cndmask_b32 v49, v41, v49, s[72:73]
    v_cndmask_b32 v53, v45, 0, s[72:73]
    v_mfma_f32_16x16x32_bf16 v[68:71], v[196:199], v[44:47], v[68:71]
    v_cvt_pk_bf16_f32 v50, v60, v61
    v_cndmask_b32 v50, v42, v50, s[72:73]
    v_cndmask_b32 v54, v46, 0, s[72:73]
    v_mfma_f32_16x16x32_bf16 v[72:75], v[192:195], v[40:43], v[72:75]
    v_cvt_pk_bf16_f32 v51, v62, v63
    v_cndmask_b32 v51, v43, v51, s[72:73]
    v_cndmask_b32 v55, v47, 0, s[72:73]
    v_mfma_f32_16x16x32_bf16 v[132:135], v[188:191], v[104:107], 0
    v_cvt_pk_bf16_f32 v112, v120, v121
    v_cndmask_b32 v112, v104, v112, s[72:73]
    v_cndmask_b32 v116, v108, 0, s[72:73]
    v_mfma_f32_16x16x32_bf16 v[136:139], v[188:191], v[108:111], 0
    v_cvt_pk_bf16_f32 v113, v122, v123
    v_cndmask_b32 v113, v105, v113, s[72:73]
    v_cndmask_b32 v117, v109, 0, s[72:73]
    v_mfma_f32_16x16x32_bf16 v[132:135], v[196:199], v[108:111], v[132:135]
    v_cvt_pk_bf16_f32 v114, v124, v125
    v_cndmask_b32 v114, v106, v114, s[72:73]
    v_cndmask_b32 v118, v110, 0, s[72:73]
    v_mfma_f32_16x16x32_bf16 v[136:139], v[192:195], v[104:107], v[136:139]
    v_cvt_pk_bf16_f32 v115, v126, v127
    v_cndmask_b32 v115, v107, v115, s[72:73]
    v_cndmask_b32 v119, v111, 0, s[72:73]
    v_mfma_f32_16x16x32_bf16 v[64:67], v[188:191], v[48:51], 0
    v_mul_f32 v86, s84, v87
    v_mul_f32 v87, s85, v87
    v_mfma_f32_16x16x32_bf16 v[76:79], v[176:179], v[48:51], 0
    v_fma_f32 v87, -v86, v86, v87
    v_max_f32 v87, 0, v87
    v_mfma_f32_16x16x32_bf16 v[80:83], v[176:179], v[52:55], 0
    v_add_f32 v87, 0x3727c5ac, v87
    v_rsq_f32 v87, v87
    v_mfma_f32_16x16x32_bf16 v[76:79], v[184:187], v[52:55], v[76:79]
    v_cvt_pk_bf16_f32 v60, v68, v72
    v_cvt_pk_bf16_f32 v61, v69, v73
    v_mfma_f32_16x16x32_bf16 v[80:83], v[180:183], v[48:51], v[80:83]
    v_cvt_pk_bf16_f32 v62, v70, v74
    v_cvt_pk_bf16_f32 v63, v71, v75
    v_mfma_f32_16x16x32_bf16 v[128:131], v[188:191], v[112:115], 0
    ds_write_b128 v229, v[60:63] offset:1024
    ds_write_b32 v232, v87 offset:16384
    v_mfma_f32_16x16x32_bf16 v[140:143], v[176:179], v[112:115], 0
    v_mul_f32 v150, s86, v151
    v_mul_f32 v151, s87, v151
    v_mfma_f32_16x16x32_bf16 v[144:147], v[176:179], v[116:119], 0
    v_fma_f32 v151, -v150, v150, v151
    v_max_f32 v151, 0, v151
    v_mfma_f32_16x16x32_bf16 v[140:143], v[184:187], v[116:119], v[140:143]
    v_add_f32 v151, 0x3727c5ac, v151
    v_rsq_f32 v151, v151
    v_mfma_f32_16x16x32_bf16 v[144:147], v[180:183], v[112:115], v[144:147]
    v_cvt_pk_bf16_f32 v124, v132, v136
    v_cvt_pk_bf16_f32 v125, v133, v137
    v_cvt_pk_bf16_f32 v126, v134, v138
    v_cvt_pk_bf16_f32 v127, v135, v139
    ds_write_b128 v229, v[124:127] offset:9216
    ds_write_b32 v232, v151 offset:16400
    v_mul_f32 v64, 0.5, v64
    v_cndmask_b32 v76, v76, v64, s[74:75]
    v_cvt_pk_bf16_f32 v56, v76, v80
    v_cvt_pk_bf16_f32 v57, v77, v81
    v_cvt_pk_bf16_f32 v58, v78, v82
    v_cvt_pk_bf16_f32 v59, v79, v83
    ds_write_b128 v229, v[56:59] offset:0
    v_mul_f32 v128, 0.5, v128
    v_cndmask_b32 v140, v140, v128, s[74:75]
    v_cvt_pk_bf16_f32 v120, v140, v144
    v_cvt_pk_bf16_f32 v121, v141, v145
    v_cvt_pk_bf16_f32 v122, v142, v146
    v_cvt_pk_bf16_f32 v123, v143, v147
    ds_write_b128 v229, v[120:123] offset:8192
    s_waitcnt lgkmcnt(0)
    s_barrier
    ds_read_b64 v[236:237], v233 offset:16384
    ds_read_b128 v[32:35], v230 offset:0
    ds_read_b128 v[36:39], v230 offset:2048
    ds_read_b128 v[96:99], v230 offset:1024
    ds_read_b128 v[100:103], v230 offset:3072
    s_waitcnt lgkmcnt(4)
    v_mul_f32 v240, v240, v236
    v_mul_f32 v241, v241, v236
    v_mul_f32 v242, v242, v237
    v_mul_f32 v243, v243, v237
    v_cvt_pk_bf16_f32 v234, v240, v241
    v_cvt_pk_bf16_f32 v235, v242, v243
    s_waitcnt lgkmcnt(2)
    v_swap_b32 v33, v36
    v_swap_b32 v35, v38
    s_waitcnt lgkmcnt(0)
    v_swap_b32 v97, v100
    v_swap_b32 v99, v102
    v_mfma_f32_16x16x16_bf16 v[40:43], v[234:235], v[32:33], 0
    v_mfma_f32_16x16x16_bf16 v[44:47], v[234:235], v[36:37], 0
    v_mfma_f32_16x16x16_bf16 v[48:51], v[234:235], v[34:35], 0
    v_mfma_f32_16x16x16_bf16 v[52:55], v[234:235], v[38:39], 0
    v_mfma_f32_16x16x16_bf16 v[104:107], v[234:235], v[96:97], 0
    v_mfma_f32_16x16x16_bf16 v[108:111], v[234:235], v[100:101], 0
    v_mfma_f32_16x16x16_bf16 v[112:115], v[234:235], v[98:99], 0
    v_mfma_f32_16x16x16_bf16 v[116:119], v[234:235], v[102:103], 0
    s_nop 0
    v_cvt_pk_bf16_f32 v68, v40, v41
    v_cvt_pk_bf16_f32 v69, v42, v43
    v_cvt_pk_bf16_f32 v70, v44, v45
    v_cvt_pk_bf16_f32 v71, v46, v47
    buffer_store_dwordx4 v[68:71], v231, s[8:11], s81 offen offset:0 sc1
    v_cvt_pk_bf16_f32 v72, v48, v49
    v_cvt_pk_bf16_f32 v73, v50, v51
    v_cvt_pk_bf16_f32 v74, v52, v53
    v_cvt_pk_bf16_f32 v75, v54, v55
    buffer_store_dwordx4 v[72:75], v231, s[8:11], s81 offen offset:256 sc1
    v_cvt_pk_bf16_f32 v132, v104, v105
    v_cvt_pk_bf16_f32 v133, v106, v107
    v_cvt_pk_bf16_f32 v134, v108, v109
    v_cvt_pk_bf16_f32 v135, v110, v111
    buffer_store_dwordx4 v[132:135], v231, s[8:11], s81 offen offset:2048 sc1
    v_cvt_pk_bf16_f32 v136, v112, v113
    v_cvt_pk_bf16_f32 v137, v114, v115
    v_cvt_pk_bf16_f32 v138, v116, v117
    v_cvt_pk_bf16_f32 v139, v118, v119
    buffer_store_dwordx4 v[136:139], v231, s[8:11], s81 offen offset:2304 sc1
L_gg_nok1:
L_gg_exit:
    s_endpgm
.p2align 6
L_gg_warm0:
    s_branch L_gg_warm1
L_g2_hook4_0:
    buffer_load_dword v252, v9, s[8:11], 0 offen offset:128 sc1
    buffer_load_dword v249, v250, s[8:11], s62 offen offset:256 sc1
    s_nop 1
    s_branch L_g2_back4_0
.p2align 6
L_gg_warm1:
    s_branch L_gg_warm2
L_g2_hook0_0:
    s_mov_b32 s3, 0x40000
L_gg_pk3:
    v_cmp_gt_u32 vcc, s23, v252
    s_nop 4
    s_cbranch_vccz L_gg_pk3_x
    buffer_load_dword v252, v9, s[8:11], 0 offen offset:128 sc1
    s_sub_u32 s3, s3, 1
    s_waitcnt vmcnt(0)
    s_cmp_lg_u32 s3, 0
    s_cbranch_scc1 L_gg_pk3
L_gg_pk3_x:
    s_mov_b32 s3, 0x40000
L_gg_poll3:
    v_readfirstlane_b32 s95, v249
    s_nop 0
    s_cmp_ge_u32 s95, 14
    s_cbranch_scc1 L_gg_poll3_x
    buffer_load_dword v249, v250, s[8:11], s62 offen offset:256 sc1
    s_sub_u32 s3, s3, 1
    s_waitcnt vmcnt(0)
    s_cmp_lg_u32 s3, 0
    s_cbranch_scc1 L_gg_poll3
L_gg_poll3_x:
    s_nop 1
    s_branch L_g2_back0_0
L_gg_warm2:
    s_branch L_gg_warmed
L_gg_hot_end:
L_gg_skip1:
    v_mov_b32 v249, 0
    s_mov_b32 s3, 0x40000
L_gg_pollrb:
    v_cmp_eq_u32 vcc, 0, v249
    s_nop 4
    s_cbranch_vccz L_gg_pollrb_x
    buffer_load_dword v249, v227, s[8:11], s88 offen sc1
    s_sub_u32 s3, s3, 1
    s_waitcnt vmcnt(0)
    s_cmp_lg_u32 s3, 0
    s_cbranch_scc1 L_gg_pollrb
L_gg_pollrb_x:
    v_lshlrev_b32 v230, 2, v1
    buffer_load_dword a128, v230, s[24:27], s63 offen
    v_lshlrev_b32 v231, 3, v4
    buffer_load_dword a144, v231, s[8:11], s43 offen offset:4 sc1
    buffer_load_dwordx4 a[148:151], v2, s[8:11], s42 offen offset:0 sc1
    buffer_load_dwordx4 a[152:155], v2, s[8:11], s42 offen offset:1024 sc1
    buffer_load_dwordx4 a[156:159], v2, s[8:11], s42 offen offset:2048 sc1
    buffer_load_dwordx4 a[160:163], v2, s[8:11], s42 offen offset:3072 sc1
    s_mov_b32 s44, 0x40000000
    s_mov_b32 s54, s40
    s_cmp_eq_u32 s23, 0
    s_cbranch_scc1 L_gg_nopack
    s_add_u32 s28, s68, 0
    s_addc_u32 s29, s69, 0
    s_mov_b32 s30, 7340032
    s_mov_b32 s31, 0x20000
    v_lshlrev_b32 v12, 1, v3
    v_xor_b32 v12, v12, v4
    v_lshlrev_b32 v13, 11, v3
    v_lshl_add_u32 v7, v12, 4, v13
    v_xor_b32 v8, 128, v7
    s_sub_u32 s72, s2, 224
    s_lshl_b32 s72, s72, 2
    s_add_u32 s72, s72, s22
    s_lshl_b32 s73, s22, 15
    v_add_u32 v224, s73, v16
    v_add_u32 v225, s73, v17
    v_add_u32 v226, s73, v18
    v_add_u32 v227, s73, v19
    v_add_u32 v228, s73, v20
    v_add_u32 v229, s73, v21
    v_add_u32 v230, s73, v22
    v_add_u32 v231, s73, v23
    s_and_b32 s75, s2, 7
    s_lshl_b32 s75, s75, 8
    s_add_u32 s75, s75, 32768
    s_add_u32 s75, s75, s56
    s_cmp_eq_u32 s22, 0
    s_cselect_b32 s75, s75, 0x40000000
    s_add_u32 s76, s72, 0
    s_lshr_b32 s77, s76, 4
    s_and_b32 s76, s76, 15
    s_cmp_ge_u32 s77, 28
    s_cselect_b32 s78, 28, 0
    s_cselect_b32 s79, 2, 0
    s_sub_u32 s77, s77, s78
    s_lshr_b32 s78, s77, 1
    s_lshl_b32 s78, s78, 2
    s_add_u32 s78, s78, s79
    s_and_b32 s77, s77, 1
    s_add_u32 s78, s78, s77
    s_lshr_b32 s77, s76, 3
    s_mul_i32 s77, s77, 56
    s_add_u32 s78, s78, s77
    s_lshl_b32 s78, s78, 16
    s_and_b32 s74, s76, 7
    s_lshl_b32 s74, s74, 8
    s_add_u32 s74, s74, s78
    s_add_u32 m0, s73, 0
    s_nop 0
    buffer_load_dwordx4 v7, s[28:31], s74 offen lds
    s_add_u32 s74, s74, 8192
    s_add_u32 m0, s73, 1024
    s_nop 0
    buffer_load_dwordx4 v7, s[28:31], s74 offen lds
    s_add_u32 s74, s74, 8192
    s_add_u32 m0, s73, 2048
    s_nop 0
    buffer_load_dwordx4 v8, s[28:31], s74 offen lds
    s_add_u32 s74, s74, 8192
    s_add_u32 m0, s73, 3072
    s_nop 0
    buffer_load_dwordx4 v8, s[28:31], s74 offen lds
    s_add_u32 s74, s74, 8192
    s_add_u32 m0, s73, 4096
    s_nop 0
    buffer_load_dwordx4 v7, s[28:31], s74 offen lds
    s_add_u32 s74, s74, 8192
    s_add_u32 m0, s73, 5120
    s_nop 0
    buffer_load_dwordx4 v7, s[28:31], s74 offen lds
    s_add_u32 s74, s74, 8192
    s_add_u32 m0, s73, 6144
    s_nop 0
    buffer_load_dwordx4 v8, s[28:31], s74 offen lds
    s_add_u32 s74, s74, 8192
    s_add_u32 m0, s73, 7168
    s_nop 0
    buffer_load_dwordx4 v8, s[28:31], s74 offen lds
    s_add_u32 s76, s72, 128
    s_lshr_b32 s77, s76, 4
    s_and_b32 s76, s76, 15
    s_cmp_ge_u32 s77, 28
    s_cselect_b32 s78, 28, 0
    s_cselect_b32 s79, 2, 0
    s_sub_u32 s77, s77, s78
    s_lshr_b32 s78, s77, 1
    s_lshl_b32 s78, s78, 2
    s_add_u32 s78, s78, s79
    s_and_b32 s77, s77, 1
    s_add_u32 s78, s78, s77
    s_lshr_b32 s77, s76, 3
    s_mul_i32 s77, s77, 56
    s_add_u32 s78, s78, s77
    s_lshl_b32 s78, s78, 16
    s_and_b32 s74, s76, 7
    s_lshl_b32 s74, s74, 8
    s_add_u32 s74, s74, s78
    s_add_u32 m0, s73, 8192
    s_nop 0
    buffer_load_dwordx4 v7, s[28:31], s74 offen lds
    s_add_u32 s74, s74, 8192
    s_add_u32 m0, s73, 9216
    s_nop 0
    buffer_load_dwordx4 v7, s[28:31], s74 offen lds
    s_add_u32 s74, s74, 8192
    s_add_u32 m0, s73, 10240
    s_nop 0
    buffer_load_dwordx4 v8, s[28:31], s74 offen lds
    s_add_u32 s74, s74, 8192
    s_add_u32 m0, s73, 11264
    s_nop 0
    buffer_load_dwordx4 v8, s[28:31], s74 offen lds
    s_add_u32 s74, s74, 8192
    s_add_u32 m0, s73, 12288
    s_nop 0
    buffer_load_dwordx4 v7, s[28:31], s74 offen lds
    s_add_u32 s74, s74, 8192
    s_add_u32 m0, s73, 13312
    s_nop 0
    buffer_load_dwordx4 v7, s[28:31], s74 offen lds
    s_add_u32 s74, s74, 8192
    s_add_u32 m0, s73, 14336
    s_nop 0
    buffer_load_dwordx4 v8, s[28:31], s74 offen lds
    s_add_u32 s74, s74, 8192
    s_add_u32 m0, s73, 15360
    s_nop 0
    buffer_load_dwordx4 v8, s[28:31], s74 offen lds
    s_waitcnt vmcnt(8)
    ds_read_b64_tr_b16 v[32:33], v224 offset:0
    ds_read_b64_tr_b16 v[34:35], v224 offset:1024
    ds_read_b64_tr_b16 v[36:37], v225 offset:0
    ds_read_b64_tr_b16 v[38:39], v225 offset:1024
    ds_read_b64_tr_b16 v[40:41], v226 offset:0
    ds_read_b64_tr_b16 v[42:43], v226 offset:1024
    ds_read_b64_tr_b16 v[44:45], v227 offset:0
    ds_read_b64_tr_b16 v[46:47], v227 offset:1024
    ds_read_b64_tr_b16 v[48:49], v228 offset:0
    ds_read_b64_tr_b16 v[50:51], v228 offset:1024
    ds_read_b64_tr_b16 v[52:53], v229 offset:0
    ds_read_b64_tr_b16 v[54:55], v229 offset:1024
    ds_read_b64_tr_b16 v[56:57], v230 offset:0
    ds_read_b64_tr_b16 v[58:59], v230 offset:1024
    ds_read_b64_tr_b16 v[60:61], v231 offset:0
    ds_read_b64_tr_b16 v[62:63], v231 offset:1024
    s_waitcnt lgkmcnt(0)
    s_add_u32 s76, s72, 0
    s_lshr_b32 s77, s76, 4
    s_and_b32 s76, s76, 15
    s_mul_i32 s76, s76, 56
    s_add_u32 s76, s76, s77
    s_lshl_b32 s76, s76, 13
    s_add_u32 s76, s76, 117440512
    s_add_u32 s77, s76, 4096
    buffer_store_dwordx4 v[32:35], v2, s[8:11], s76 offen offset:0 sc1
    buffer_store_dwordx4 v[36:39], v2, s[8:11], s76 offen offset:1024 sc1
    buffer_store_dwordx4 v[40:43], v2, s[8:11], s76 offen offset:2048 sc1
    buffer_store_dwordx4 v[44:47], v2, s[8:11], s76 offen offset:3072 sc1
    buffer_store_dwordx4 v[48:51], v2, s[8:11], s77 offen offset:0 sc1
    buffer_store_dwordx4 v[52:55], v2, s[8:11], s77 offen offset:1024 sc1
    buffer_store_dwordx4 v[56:59], v2, s[8:11], s77 offen offset:2048 sc1
    buffer_store_dwordx4 v[60:63], v2, s[8:11], s77 offen offset:3072 sc1
    s_add_u32 s76, s72, 256
    s_lshr_b32 s77, s76, 4
    s_and_b32 s76, s76, 15
    s_cmp_ge_u32 s77, 28
    s_cselect_b32 s78, 28, 0
    s_cselect_b32 s79, 2, 0
    s_sub_u32 s77, s77, s78
    s_lshr_b32 s78, s77, 1
    s_lshl_b32 s78, s78, 2
    s_add_u32 s78, s78, s79
    s_and_b32 s77, s77, 1
    s_add_u32 s78, s78, s77
    s_lshr_b32 s77, s76, 3
    s_mul_i32 s77, s77, 56
    s_add_u32 s78, s78, s77
    s_lshl_b32 s78, s78, 16
    s_and_b32 s74, s76, 7
    s_lshl_b32 s74, s74, 8
    s_add_u32 s74, s74, s78
    s_add_u32 m0, s73, 16384
    s_nop 0
    buffer_load_dwordx4 v7, s[28:31], s74 offen lds
    s_add_u32 s74, s74, 8192
    s_add_u32 m0, s73, 17408
    s_nop 0
    buffer_load_dwordx4 v7, s[28:31], s74 offen lds
    s_add_u32 s74, s74, 8192
    s_add_u32 m0, s73, 18432
    s_nop 0
    buffer_load_dwordx4 v8, s[28:31], s74 offen lds
    s_add_u32 s74, s74, 8192
    s_add_u32 m0, s73, 19456
    s_nop 0
    buffer_load_dwordx4 v8, s[28:31], s74 offen lds
    s_add_u32 s74, s74, 8192
    s_add_u32 m0, s73, 20480
    s_nop 0
    buffer_load_dwordx4 v7, s[28:31], s74 offen lds
    s_add_u32 s74, s74, 8192
    s_add_u32 m0, s73, 21504
    s_nop 0
    buffer_load_dwordx4 v7, s[28:31], s74 offen lds
    s_add_u32 s74, s74, 8192
    s_add_u32 m0, s73, 22528
    s_nop 0
    buffer_load_dwordx4 v8, s[28:31], s74 offen lds
    s_add_u32 s74, s74, 8192
    s_add_u32 m0, s73, 23552
    s_nop 0
    buffer_load_dwordx4 v8, s[28:31], s74 offen lds
    s_add_u32 s76, s72, 384
    s_lshr_b32 s77, s76, 4
    s_and_b32 s76, s76, 15
    s_cmp_ge_u32 s77, 28
    s_cselect_b32 s78, 28, 0
    s_cselect_b32 s79, 2, 0
    s_sub_u32 s77, s77, s78
    s_lshr_b32 s78, s77, 1
    s_lshl_b32 s78, s78, 2
    s_add_u32 s78, s78, s79
    s_and_b32 s77, s77, 1
    s_add_u32 s78, s78, s77
    s_lshr_b32 s77, s76, 3
    s_mul_i32 s77, s77, 56
    s_add_u32 s78, s78, s77
    s_lshl_b32 s78, s78, 16
    s_and_b32 s74, s76, 7
    s_lshl_b32 s74, s74, 8
    s_add_u32 s74, s74, s78
    s_add_u32 m0, s73, 24576
    s_nop 0
    buffer_load_dwordx4 v7, s[28:31], s74 offen lds
    s_add_u32 s74, s74, 8192
    s_add_u32 m0, s73, 25600
    s_nop 0
    buffer_load_dwordx4 v7, s[28:31], s74 offen lds
    s_add_u32 s74, s74, 8192
    s_add_u32 m0, s73, 26624
    s_nop 0
    buffer_load_dwordx4 v8, s[28:31], s74 offen lds
    s_add_u32 s74, s74, 8192
    s_add_u32 m0, s73, 27648
    s_nop 0
    buffer_load_dwordx4 v8, s[28:31], s74 offen lds
    s_add_u32 s74, s74, 8192
    s_add_u32 m0, s73, 28672
    s_nop 0
    buffer_load_dwordx4 v7, s[28:31], s74 offen lds
    s_add_u32 s74, s74, 8192
    s_add_u32 m0, s73, 29696
    s_nop 0
    buffer_load_dwordx4 v7, s[28:31], s74 offen lds
    s_add_u32 s74, s74, 8192
    s_add_u32 m0, s73, 30720
    s_nop 0
    buffer_load_dwordx4 v8, s[28:31], s74 offen lds
    s_add_u32 s74, s74, 8192
    s_add_u32 m0, s73, 31744
    s_nop 0
    buffer_load_dwordx4 v8, s[28:31], s74 offen lds
    s_add_u32 s76, s72, 512
    s_lshr_b32 s77, s76, 4
    s_and_b32 s76, s76, 15
    s_cmp_ge_u32 s77, 28
    s_cselect_b32 s78, 28, 0
    s_cselect_b32 s79, 2, 0
    s_sub_u32 s77, s77, s78
    s_lshr_b32 s78, s77, 1
    s_lshl_b32 s78, s78, 2
    s_add_u32 s78, s78, s79
    s_and_b32 s77, s77, 1
    s_add_u32 s78, s78, s77
    s_lshr_b32 s77, s76, 3
    s_mul_i32 s77, s77, 56
    s_add_u32 s78, s78, s77
    s_lshl_b32 s78, s78, 16
    s_and_b32 s74, s76, 7
    s_lshl_b32 s74, s74, 8
    s_add_u32 s74, s74, s78
    s_add_u32 m0, s73, 0
    s_nop 0
    buffer_load_dwordx4 v7, s[28:31], s74 offen lds
    s_add_u32 s74, s74, 8192
    s_add_u32 m0, s73, 1024
    s_nop 0
    buffer_load_dwordx4 v7, s[28:31], s74 offen lds
    s_add_u32 s74, s74, 8192
    s_add_u32 m0, s73, 2048
    s_nop 0
    buffer_load_dwordx4 v8, s[28:31], s74 offen lds
    s_add_u32 s74, s74, 8192
    s_add_u32 m0, s73, 3072
    s_nop 0
    buffer_load_dwordx4 v8, s[28:31], s74 offen lds
    s_add_u32 s74, s74, 8192
    s_add_u32 m0, s73, 4096
    s_nop 0
    buffer_load_dwordx4 v7, s[28:31], s74 offen lds
    s_add_u32 s74, s74, 8192
    s_add_u32 m0, s73, 5120
    s_nop 0
    buffer_load_dwordx4 v7, s[28:31], s74 offen lds
    s_add_u32 s74, s74, 8192
    s_add_u32 m0, s73, 6144
    s_nop 0
    buffer_load_dwordx4 v8, s[28:31], s74 offen lds
    s_add_u32 s74, s74, 8192
    s_add_u32 m0, s73, 7168
    s_nop 0
    buffer_load_dwordx4 v8, s[28:31], s74 offen lds
    s_waitcnt vmcnt(32)
    ds_read_b64_tr_b16 v[64:65], v224 offset:8192
    ds_read_b64_tr_b16 v[66:67], v224 offset:9216
    ds_read_b64_tr_b16 v[68:69], v225 offset:8192
    ds_read_b64_tr_b16 v[70:71], v225 offset:9216
    ds_read_b64_tr_b16 v[72:73], v226 offset:8192
    ds_read_b64_tr_b16 v[74:75], v226 offset:9216
    ds_read_b64_tr_b16 v[76:77], v227 offset:8192
    ds_read_b64_tr_b16 v[78:79], v227 offset:9216
    ds_read_b64_tr_b16 v[80:81], v228 offset:8192
    ds_read_b64_tr_b16 v[82:83], v228 offset:9216
    ds_read_b64_tr_b16 v[84:85], v229 offset:8192
    ds_read_b64_tr_b16 v[86:87], v229 offset:9216
    ds_read_b64_tr_b16 v[88:89], v230 offset:8192
    ds_read_b64_tr_b16 v[90:91], v230 offset:9216
    ds_read_b64_tr_b16 v[92:93], v231 offset:8192
    ds_read_b64_tr_b16 v[94:95], v231 offset:9216
    s_waitcnt lgkmcnt(0)
    s_add_u32 s76, s72, 128
    s_lshr_b32 s77, s76, 4
    s_and_b32 s76, s76, 15
    s_mul_i32 s76, s76, 56
    s_add_u32 s76, s76, s77
    s_lshl_b32 s76, s76, 13
    s_add_u32 s76, s76, 117440512
    s_add_u32 s77, s76, 4096
    buffer_store_dwordx4 v[64:67], v2, s[8:11], s76 offen offset:0 sc1
    buffer_store_dwordx4 v[68:71], v2, s[8:11], s76 offen offset:1024 sc1
    buffer_store_dwordx4 v[72:75], v2, s[8:11], s76 offen offset:2048 sc1
    buffer_store_dwordx4 v[76:79], v2, s[8:11], s76 offen offset:3072 sc1
    buffer_store_dwordx4 v[80:83], v2, s[8:11], s77 offen offset:0 sc1
    buffer_store_dwordx4 v[84:87], v2, s[8:11], s77 offen offset:1024 sc1
    buffer_store_dwordx4 v[88:91], v2, s[8:11], s77 offen offset:2048 sc1
    buffer_store_dwordx4 v[92:95], v2, s[8:11], s77 offen offset:3072 sc1
    s_waitcnt vmcnt(32)
    s_barrier
    s_mov_b64 exec, 1
    buffer_atomic_add v251, v250, s[8:11], s75 offen offset:0 sc1
    s_mov_b64 exec, -1
    s_add_u32 s76, s72, 640
    s_lshr_b32 s77, s76, 4
    s_and_b32 s76, s76, 15
    s_cmp_ge_u32 s77, 28
    s_cselect_b32 s78, 28, 0
    s_cselect_b32 s79, 2, 0
    s_sub_u32 s77, s77, s78
    s_lshr_b32 s78, s77, 1
    s_lshl_b32 s78, s78, 2
    s_add_u32 s78, s78, s79
    s_and_b32 s77, s77, 1
    s_add_u32 s78, s78, s77
    s_lshr_b32 s77, s76, 3
    s_mul_i32 s77, s77, 56
    s_add_u32 s78, s78, s77
    s_lshl_b32 s78, s78, 16
    s_and_b32 s74, s76, 7
    s_lshl_b32 s74, s74, 8
    s_add_u32 s74, s74, s78
    s_add_u32 m0, s73, 8192
    s_nop 0
    buffer_load_dwordx4 v7, s[28:31], s74 offen lds
    s_add_u32 s74, s74, 8192
    s_add_u32 m0, s73, 9216
    s_nop 0
    buffer_load_dwordx4 v7, s[28:31], s74 offen lds
    s_add_u32 s74, s74, 8192
    s_add_u32 m0, s73, 10240
    s_nop 0
    buffer_load_dwordx4 v8, s[28:31], s74 offen lds
    s_add_u32 s74, s74, 8192
    s_add_u32 m0, s73, 11264
    s_nop 0
    buffer_load_dwordx4 v8, s[28:31], s74 offen lds
    s_add_u32 s74, s74, 8192
    s_add_u32 m0, s73, 12288
    s_nop 0
    buffer_load_dwordx4 v7, s[28:31], s74 offen lds
    s_add_u32 s74, s74, 8192
    s_add_u32 m0, s73, 13312
    s_nop 0
    buffer_load_dwordx4 v7, s[28:31], s74 offen lds
    s_add_u32 s74, s74, 8192
    s_add_u32 m0, s73, 14336
    s_nop 0
    buffer_load_dwordx4 v8, s[28:31], s74 offen lds
    s_add_u32 s74, s74, 8192
    s_add_u32 m0, s73, 15360
    s_nop 0
    buffer_load_dwordx4 v8, s[28:31], s74 offen lds
    s_waitcnt vmcnt(33)
    ds_read_b64_tr_b16 v[32:33], v224 offset:16384
    ds_read_b64_tr_b16 v[34:35], v224 offset:17408
    ds_read_b64_tr_b16 v[36:37], v225 offset:16384
    ds_read_b64_tr_b16 v[38:39], v225 offset:17408
    ds_read_b64_tr_b16 v[40:41], v226 offset:16384
    ds_read_b64_tr_b16 v[42:43], v226 offset:17408
    ds_read_b64_tr_b16 v[44:45], v227 offset:16384
    ds_read_b64_tr_b16 v[46:47], v227 offset:17408
    ds_read_b64_tr_b16 v[48:49], v228 offset:16384
    ds_read_b64_tr_b16 v[50:51], v228 offset:17408
    ds_read_b64_tr_b16 v[52:53], v229 offset:16384
    ds_read_b64_tr_b16 v[54:55], v229 offset:17408
    ds_read_b64_tr_b16 v[56:57], v230 offset:16384
    ds_read_b64_tr_b16 v[58:59], v230 offset:17408
    ds_read_b64_tr_b16 v[60:61], v231 offset:16384
    ds_read_b64_tr_b16 v[62:63], v231 offset:17408
    s_waitcnt lgkmcnt(0)
    s_add_u32 s76, s72, 256
    s_lshr_b32 s77, s76, 4
    s_and_b32 s76, s76, 15
    s_mul_i32 s76, s76, 56
    s_add_u32 s76, s76, s77
    s_lshl_b32 s76, s76, 13
    s_add_u32 s76, s76, 117440512
    s_add_u32 s77, s76, 4096
    buffer_store_dwordx4 v[32:35], v2, s[8:11], s76 offen offset:0 sc1
    buffer_store_dwordx4 v[36:39], v2, s[8:11], s76 offen offset:1024 sc1
    buffer_store_dwordx4 v[40:43], v2, s[8:11], s76 offen offset:2048 sc1
    buffer_store_dwordx4 v[44:47], v2, s[8:11], s76 offen offset:3072 sc1
    buffer_store_dwordx4 v[48:51], v2, s[8:11], s77 offen offset:0 sc1
    buffer_store_dwordx4 v[52:55], v2, s[8:11], s77 offen offset:1024 sc1
    buffer_store_dwordx4 v[56:59], v2, s[8:11], s77 offen offset:2048 sc1
    buffer_store_dwordx4 v[60:63], v2, s[8:11], s77 offen offset:3072 sc1
    s_add_u32 s76, s72, 768
    s_lshr_b32 s77, s76, 4
    s_and_b32 s76, s76, 15
    s_cmp_ge_u32 s77, 28
    s_cselect_b32 s78, 28, 0
    s_cselect_b32 s79, 2, 0
    s_sub_u32 s77, s77, s78
    s_lshr_b32 s78, s77, 1
    s_lshl_b32 s78, s78, 2
    s_add_u32 s78, s78, s79
    s_and_b32 s77, s77, 1
    s_add_u32 s78, s78, s77
    s_lshr_b32 s77, s76, 3
    s_mul_i32 s77, s77, 56
    s_add_u32 s78, s78, s77
    s_lshl_b32 s78, s78, 16
    s_and_b32 s74, s76, 7
    s_lshl_b32 s74, s74, 8
    s_add_u32 s74, s74, s78
    s_add_u32 m0, s73, 16384
    s_nop 0
    buffer_load_dwordx4 v7, s[28:31], s74 offen lds
    s_add_u32 s74, s74, 8192
    s_add_u32 m0, s73, 17408
    s_nop 0
    buffer_load_dwordx4 v7, s[28:31], s74 offen lds
    s_add_u32 s74, s74, 8192
    s_add_u32 m0, s73, 18432
    s_nop 0
    buffer_load_dwordx4 v8, s[28:31], s74 offen lds
    s_add_u32 s74, s74, 8192
    s_add_u32 m0, s73, 19456
    s_nop 0
    buffer_load_dwordx4 v8, s[28:31], s74 offen lds
    s_add_u32 s74, s74, 8192
    s_add_u32 m0, s73, 20480
    s_nop 0
    buffer_load_dwordx4 v7, s[28:31], s74 offen lds
    s_add_u32 s74, s74, 8192
    s_add_u32 m0, s73, 21504
    s_nop 0
    buffer_load_dwordx4 v7, s[28:31], s74 offen lds
    s_add_u32 s74, s74, 8192
    s_add_u32 m0, s73, 22528
    s_nop 0
    buffer_load_dwordx4 v8, s[28:31], s74 offen lds
    s_add_u32 s74, s74, 8192
    s_add_u32 m0, s73, 23552
    s_nop 0
    buffer_load_dwordx4 v8, s[28:31], s74 offen lds
    s_waitcnt vmcnt(41)
    ds_read_b64_tr_b16 v[64:65], v224 offset:24576
    ds_read_b64_tr_b16 v[66:67], v224 offset:25600
    ds_read_b64_tr_b16 v[68:69], v225 offset:24576
    ds_read_b64_tr_b16 v[70:71], v225 offset:25600
    ds_read_b64_tr_b16 v[72:73], v226 offset:24576
    ds_read_b64_tr_b16 v[74:75], v226 offset:25600
    ds_read_b64_tr_b16 v[76:77], v227 offset:24576
    ds_read_b64_tr_b16 v[78:79], v227 offset:25600
    ds_read_b64_tr_b16 v[80:81], v228 offset:24576
    ds_read_b64_tr_b16 v[82:83], v228 offset:25600
    ds_read_b64_tr_b16 v[84:85], v229 offset:24576
    ds_read_b64_tr_b16 v[86:87], v229 offset:25600
    ds_read_b64_tr_b16 v[88:89], v230 offset:24576
    ds_read_b64_tr_b16 v[90:91], v230 offset:25600
    ds_read_b64_tr_b16 v[92:93], v231 offset:24576
    ds_read_b64_tr_b16 v[94:95], v231 offset:25600
    s_waitcnt lgkmcnt(0)
    s_add_u32 s76, s72, 384
    s_lshr_b32 s77, s76, 4
    s_and_b32 s76, s76, 15
    s_mul_i32 s76, s76, 56
    s_add_u32 s76, s76, s77
    s_lshl_b32 s76, s76, 13
    s_add_u32 s76, s76, 117440512
    s_add_u32 s77, s76, 4096
    buffer_store_dwordx4 v[64:67], v2, s[8:11], s76 offen offset:0 sc1
    buffer_store_dwordx4 v[68:71], v2, s[8:11], s76 offen offset:1024 sc1
    buffer_store_dwordx4 v[72:75], v2, s[8:11], s76 offen offset:2048 sc1
    buffer_store_dwordx4 v[76:79], v2, s[8:11], s76 offen offset:3072 sc1
    buffer_store_dwordx4 v[80:83], v2, s[8:11], s77 offen offset:0 sc1
    buffer_store_dwordx4 v[84:87], v2, s[8:11], s77 offen offset:1024 sc1
    buffer_store_dwordx4 v[88:91], v2, s[8:11], s77 offen offset:2048 sc1
    buffer_store_dwordx4 v[92:95], v2, s[8:11], s77 offen offset:3072 sc1
    s_waitcnt vmcnt(41)
    ds_read_b64_tr_b16 v[32:33], v224 offset:0
    ds_read_b64_tr_b16 v[34:35], v224 offset:1024
    ds_read_b64_tr_b16 v[36:37], v225 offset:0
    ds_read_b64_tr_b16 v[38:39], v225 offset:1024
    ds_read_b64_tr_b16 v[40:41], v226 offset:0
    ds_read_b64_tr_b16 v[42:43], v226 offset:1024
    ds_read_b64_tr_b16 v[44:45], v227 offset:0
    ds_read_b64_tr_b16 v[46:47], v227 offset:1024
    ds_read_b64_tr_b16 v[48:49], v228 offset:0
    ds_read_b64_tr_b16 v[50:51], v228 offset:1024
    ds_read_b64_tr_b16 v[52:53], v229 offset:0
    ds_read_b64_tr_b16 v[54:55], v229 offset:1024
    ds_read_b64_tr_b16 v[56:57], v230 offset:0
    ds_read_b64_tr_b16 v[58:59], v230 offset:1024
    ds_read_b64_tr_b16 v[60:61], v231 offset:0
    ds_read_b64_tr_b16 v[62:63], v231 offset:1024
    s_waitcnt lgkmcnt(0)
    s_add_u32 s76, s72, 512
    s_lshr_b32 s77, s76, 4
    s_and_b32 s76, s76, 15
    s_mul_i32 s76, s76, 56
    s_add_u32 s76, s76, s77
    s_lshl_b32 s76, s76, 13
    s_add_u32 s76, s76, 117440512
    s_add_u32 s77, s76, 4096
    buffer_store_dwordx4 v[32:35], v2, s[8:11], s76 offen offset:0 sc1
    buffer_store_dwordx4 v[36:39], v2, s[8:11], s76 offen offset:1024 sc1
    buffer_store_dwordx4 v[40:43], v2, s[8:11], s76 offen offset:2048 sc1
    buffer_store_dwordx4 v[44:47], v2, s[8:11], s76 offen offset:3072 sc1
    buffer_store_dwordx4 v[48:51], v2, s[8:11], s77 offen offset:0 sc1
    buffer_store_dwordx4 v[52:55], v2, s[8:11], s77 offen offset:1024 sc1
    buffer_store_dwordx4 v[56:59], v2, s[8:11], s77 offen offset:2048 sc1
    buffer_store_dwordx4 v[60:63], v2, s[8:11], s77 offen offset:3072 sc1
    s_waitcnt vmcnt(8)
    s_barrier
    s_mov_b64 exec, 1
    buffer_atomic_add v251, v250, s[8:11], s75 offen offset:64 sc1
    s_mov_b64 exec, -1
    ds_read_b64_tr_b16 v[64:65], v224 offset:8192
    ds_read_b64_tr_b16 v[66:67], v224 offset:9216
    ds_read_b64_tr_b16 v[68:69], v225 offset:8192
    ds_read_b64_tr_b16 v[70:71], v225 offset:9216
    ds_read_b64_tr_b16 v[72:73], v226 offset:8192
    ds_read_b64_tr_b16 v[74:75], v226 offset:9216
    ds_read_b64_tr_b16 v[76:77], v227 offset:8192
    ds_read_b64_tr_b16 v[78:79], v227 offset:9216
    ds_read_b64_tr_b16 v[80:81], v228 offset:8192
    ds_read_b64_tr_b16 v[82:83], v228 offset:9216
    ds_read_b64_tr_b16 v[84:85], v229 offset:8192
    ds_read_b64_tr_b16 v[86:87], v229 offset:9216
    ds_read_b64_tr_b16 v[88:89], v230 offset:8192
    ds_read_b64_tr_b16 v[90:91], v230 offset:9216
    ds_read_b64_tr_b16 v[92:93], v231 offset:8192
    ds_read_b64_tr_b16 v[94:95], v231 offset:9216
    s_waitcnt lgkmcnt(0)
    s_add_u32 s76, s72, 640
    s_lshr_b32 s77, s76, 4
    s_and_b32 s76, s76, 15
    s_mul_i32 s76, s76, 56
    s_add_u32 s76, s76, s77
    s_lshl_b32 s76, s76, 13
    s_add_u32 s76, s76, 117440512
    s_add_u32 s77, s76, 4096
    buffer_store_dwordx4 v[64:67], v2, s[8:11], s76 offen offset:0 sc1
    buffer_store_dwordx4 v[68:71], v2, s[8:11], s76 offen offset:1024 sc1
    buffer_store_dwordx4 v[72:75], v2, s[8:11], s76 offen offset:2048 sc1
    buffer_store_dwordx4 v[76:79], v2, s[8:11], s76 offen offset:3072 sc1
    buffer_store_dwordx4 v[80:83], v2, s[8:11], s77 offen offset:0 sc1
    buffer_store_dwordx4 v[84:87], v2, s[8:11], s77 offen offset:1024 sc1
    buffer_store_dwordx4 v[88:91], v2, s[8:11], s77 offen offset:2048 sc1
    buffer_store_dwordx4 v[92:95], v2, s[8:11], s77 offen offset:3072 sc1
    ds_read_b64_tr_b16 v[32:33], v224 offset:16384
    ds_read_b64_tr_b16 v[34:35], v224 offset:17408
    ds_read_b64_tr_b16 v[36:37], v225 offset:16384
    ds_read_b64_tr_b16 v[38:39], v225 offset:17408
    ds_read_b64_tr_b16 v[40:41], v226 offset:16384
    ds_read_b64_tr_b16 v[42:43], v226 offset:17408
    ds_read_b64_tr_b16 v[44:45], v227 offset:16384
    ds_read_b64_tr_b16 v[46:47], v227 offset:17408
    ds_read_b64_tr_b16 v[48:49], v228 offset:16384
    ds_read_b64_tr_b16 v[50:51], v228 offset:17408
    ds_read_b64_tr_b16 v[52:53], v229 offset:16384
    ds_read_b64_tr_b16 v[54:55], v229 offset:17408
    ds_read_b64_tr_b16 v[56:57], v230 offset:16384
    ds_read_b64_tr_b16 v[58:59], v230 offset:17408
    ds_read_b64_tr_b16 v[60:61], v231 offset:16384
    ds_read_b64_tr_b16 v[62:63], v231 offset:17408
    s_waitcnt lgkmcnt(0)
    s_add_u32 s76, s72, 768
    s_lshr_b32 s77, s76, 4
    s_and_b32 s76, s76, 15
    s_mul_i32 s76, s76, 56
    s_add_u32 s76, s76, s77
    s_lshl_b32 s76, s76, 13
    s_add_u32 s76, s76, 117440512
    s_add_u32 s77, s76, 4096
    buffer_store_dwordx4 v[32:35], v2, s[8:11], s76 offen offset:0 sc1
    buffer_store_dwordx4 v[36:39], v2, s[8:11], s76 offen offset:1024 sc1
    buffer_store_dwordx4 v[40:43], v2, s[8:11], s76 offen offset:2048 sc1
    buffer_store_dwordx4 v[44:47], v2, s[8:11], s76 offen offset:3072 sc1
    buffer_store_dwordx4 v[48:51], v2, s[8:11], s77 offen offset:0 sc1
    buffer_store_dwordx4 v[52:55], v2, s[8:11], s77 offen offset:1024 sc1
    buffer_store_dwordx4 v[56:59], v2, s[8:11], s77 offen offset:2048 sc1
    buffer_store_dwordx4 v[60:63], v2, s[8:11], s77 offen offset:3072 sc1
    s_waitcnt vmcnt(0)
    s_barrier
    s_mov_b64 exec, 1
    buffer_atomic_add v251, v250, s[8:11], s75 offen offset:128 sc1
    s_mov_b64 exec, -1
L_gg_nopack:
    buffer_load_dword v252, v9, s[8:11], 0 offen offset:0 sc1
    s_waitcnt vmcnt(0)
    s_mov_b32 s3, 0x40000
L_gg_pk2:
    v_cmp_gt_u32 vcc, s23, v252
    s_nop 4
    s_cbranch_vccz L_gg_pk2_x
    buffer_load_dword v252, v9, s[8:11], 0 offen offset:0 sc1
    s_sub_u32 s3, s3, 1
    s_waitcnt vmcnt(0)
    s_cmp_lg_u32 s3, 0
    s_cbranch_scc1 L_gg_pk2
L_gg_pk2_x:
    s_add_u32 m0, s46, 0
    s_nop 0
    buffer_load_dwordx4 v2, s[8:11], s54 offen sc1 lds
    buffer_load_dwordx4 v2, s[8:11], s54 offen offset:1024 sc1 lds
    s_add_u32 s54, s54, 8192
    s_add_u32 m0, s46, 8192
    s_nop 0
    buffer_load_dwordx4 v2, s[8:11], s54 offen sc1 lds
    buffer_load_dwordx4 v2, s[8:11], s54 offen offset:1024 sc1 lds
    s_add_u32 s54, s54, 8192
    s_add_u32 m0, s46, 16384
    s_nop 0
    buffer_load_dwordx4 v2, s[8:11], s54 offen sc1 lds
    buffer_load_dwordx4 v2, s[8:11], s54 offen offset:1024 sc1 lds
    s_add_u32 s54, s54, 8192
    s_add_u32 m0, s46, 24576
    s_nop 0
    buffer_load_dwordx4 v2, s[8:11], s54 offen sc1 lds
    buffer_load_dwordx4 v2, s[8:11], s54 offen offset:1024 sc1 lds
    s_add_u32 s54, s54, 8192
    s_add_u32 m0, s46, 32768
    s_nop 0
    buffer_load_dwordx4 v2, s[8:11], s54 offen sc1 lds
    buffer_load_dwordx4 v2, s[8:11], s54 offen offset:1024 sc1 lds
    s_add_u32 s54, s54, 8192
    s_add_u32 m0, s46, 40960
    s_nop 0
    buffer_load_dwordx4 v2, s[8:11], s54 offen sc1 lds
    buffer_load_dwordx4 v2, s[8:11], s54 offen offset:1024 sc1 lds
    s_add_u32 s54, s54, 8192
    s_add_u32 m0, s46, 49152
    s_nop 0
    buffer_load_dwordx4 v2, s[8:11], s54 offen sc1 lds
    buffer_load_dwordx4 v2, s[8:11], s54 offen offset:1024 sc1 lds
    s_add_u32 s54, s54, 8192
    s_add_u32 m0, s46, 57344
    s_nop 0
    buffer_load_dwordx4 v2, s[8:11], s54 offen sc1 lds
    buffer_load_dwordx4 v2, s[8:11], s54 offen offset:1024 sc1 lds
    s_add_u32 s54, s54, 8192
    buffer_load_dword v252, v9, s[8:11], 0 offen offset:64 sc1
    buffer_load_dword v249, v250, s[8:11], s62 offen offset:0 sc1
    s_waitcnt vmcnt(0)
    s_branch L_gg_g2
.p2align 8
.type tbl_k1,@object
tbl_k1:
.long 0x3f803f80,0x3f803f80,0x3f803f80,0x3f803f80,0x3f7b3f80,0x3f553f6d,0xbf7bbf80,0xbf55bf6d
.long 0x3f6d3f80,0x3ec43f35,0x3f6d3f80,0x3ec43f35,0x3f553f80,0xbe483ec4,0xbf55bf80,0x3e48bec4
.long 0x3f353f80,0xbf350000,0x3f353f80,0xbf350000,0x3f0e3f80,0xbf7bbec4,0xbf0ebf80,0x3f7b3ec4
.long 0x3ec43f80,0xbf6dbf35,0x3ec43f80,0xbf6dbf35,0x3e483f80,0xbf0ebf6d,0xbe48bf80,0x3f0e3f6d
.long 0x3f80,0xbf80,0x3f80,0xbf80,0xbe483f80,0x3f0ebf6d,0x3e48bf80,0xbf0e3f6d
.long 0xbec43f80,0x3f6dbf35,0xbec43f80,0x3f6dbf35,0xbf0e3f80,0x3f7bbec4,0x3f0ebf80,0xbf7b3ec4
.long 0xbf353f80,0x3f350000,0xbf353f80,0x3f350000,0xbf553f80,0x3e483ec4,0x3f55bf80,0xbe48bec4
.long 0xbf6d3f80,0xbec43f35,0xbf6d3f80,0xbec43f35,0xbf7b3f80,0xbf553f6d,0x3f7bbf80,0x3f55bf6d
.long 0x3f803f80,0x3f803f80,0x3f803f80,0x3f803f80,0x3f0e3f35,0x3e483ec4,0xbf0ebf35,0xbe48bec4
.long 0xbec40000,0xbf6dbf35,0xbec40000,0xbf6dbf35,0xbf7bbf35,0xbf0ebf6d,0x3f7b3f35,0x3f0e3f6d
.long 0xbf35bf80,0x3f350000,0xbf35bf80,0x3f350000,0x3e48bf35,0x3f553f6d,0xbe483f35,0xbf55bf6d
.long 0x3f6d0000,0xbec43f35,0x3f6d0000,0xbec43f35,0x3f553f35,0xbf7bbec4,0xbf55bf35,0x3f7b3ec4
.long 0x3f80,0xbf80,0x3f80,0xbf80,0xbf553f35,0x3f7bbec4,0x3f55bf35,0xbf7b3ec4
.long 0xbf6d0000,0x3ec43f35,0xbf6d0000,0x3ec43f35,0xbe48bf35,0xbf553f6d,0x3e483f35,0x3f55bf6d
.long 0x3f35bf80,0xbf350000,0x3f35bf80,0xbf350000,0x3f7bbf35,0x3f0ebf6d,0xbf7b3f35,0xbf0e3f6d
.long 0x3ec40000,0x3f6dbf35,0x3ec40000,0x3f6dbf35,0xbf0e3f35,0xbe483ec4,0x3f0ebf35,0x3e48bec4
.long 0x3f803f80,0x3f803f80,0x3f803f80,0x3f803f80,0xbe480000,0xbf0ebec4,0x3e480000,0x3f0e3ec4
.long 0xbf6dbf80,0xbec4bf35,0xbf6dbf80,0xbec4bf35,0x3f0e0000,0x3f7b3f6d,0xbf0e0000,0xbf7bbf6d
.long 0x3f353f80,0xbf350000,0x3f353f80,0xbf350000,0xbf550000,0xbe48bf6d,0x3f550000,0x3e483f6d
.long 0xbec4bf80,0x3f6d3f35,0xbec4bf80,0x3f6d3f35,0x3f7b0000,0xbf553ec4,0xbf7b0000,0x3f55bec4
.long 0x3f80,0xbf80,0x3f80,0xbf80,0xbf7b0000,0x3f553ec4,0x3f7b0000,0xbf55bec4
.long 0x3ec4bf80,0xbf6d3f35,0x3ec4bf80,0xbf6d3f35,0x3f550000,0x3e48bf6d,0xbf550000,0xbe483f6d
.long 0xbf353f80,0x3f350000,0xbf353f80,0x3f350000,0xbf0e0000,0xbf7b3f6d,0x3f0e0000,0x3f7bbf6d
.long 0x3f6dbf80,0x3ec4bf35,0x3f6dbf80,0x3ec4bf35,0x3e480000,0x3f0ebec4,0xbe480000,0xbf0e3ec4
.long 0x3f803f80,0x3f803f80,0x3f803f80,0x3f803f80,0xbf55bf35,0xbf7bbf6d,0x3f553f35,0x3f7b3f6d
.long 0x3ec40000,0x3f6d3f35,0x3ec40000,0x3f6d3f35,0x3e483f35,0xbf55bec4,0xbe48bf35,0x3f553ec4
.long 0xbf35bf80,0x3f350000,0xbf35bf80,0x3f350000,0x3f7b3f35,0xbf0e3ec4,0xbf7bbf35,0x3f0ebec4
.long 0xbf6d0000,0x3ec4bf35,0xbf6d0000,0x3ec4bf35,0x3f0ebf35,0xbe483f6d,0xbf0e3f35,0x3e48bf6d
.long 0x3f80,0xbf80,0x3f80,0xbf80,0xbf0ebf35,0x3e483f6d,0x3f0e3f35,0xbe48bf6d
.long 0x3f6d0000,0xbec4bf35,0x3f6d0000,0xbec4bf35,0xbf7b3f35,0x3f0e3ec4,0x3f7bbf35,0xbf0ebec4
.long 0x3f35bf80,0xbf350000,0x3f35bf80,0xbf350000,0xbe483f35,0x3f55bec4,0x3e48bf35,0xbf553ec4
.long 0xbec40000,0xbf6d3f35,0xbec40000,0xbf6d3f35,0x3f55bf35,0x3f7bbf6d,0xbf553f35,0xbf7b3f6d
.long 0x80008000,0x80008000,0x80008000,0x80008000,0xbe488000,0xbf0ebec4,0x3e488000,0x3f0e3ec4
.long 0xbec48000,0xbf6dbf35,0xbec48000,0xbf6dbf35,0xbf0e8000,0xbf7bbf6d,0x3f0e8000,0x3f7b3f6d
.long 0xbf358000,0xbf35bf80,0xbf358000,0xbf35bf80,0xbf558000,0xbe48bf6d,0x3f558000,0x3e483f6d
.long 0xbf6d8000,0x3ec4bf35,0xbf6d8000,0x3ec4bf35,0xbf7b8000,0x3f55bec4,0x3f7b8000,0xbf553ec4
.long 0xbf808000,0x3f808000,0xbf808000,0x3f808000,0xbf7b8000,0x3f553ec4,0x3f7b8000,0xbf55bec4
.long 0xbf6d8000,0x3ec43f35,0xbf6d8000,0x3ec43f35,0xbf558000,0xbe483f6d,0x3f558000,0x3e48bf6d
.long 0xbf358000,0xbf353f80,0xbf358000,0xbf353f80,0xbf0e8000,0xbf7b3f6d,0x3f0e8000,0x3f7bbf6d
.long 0xbec48000,0xbf6d3f35,0xbec48000,0xbf6d3f35,0xbe488000,0xbf0e3ec4,0x3e488000,0x3f0ebec4
.long 0x80008000,0x80008000,0x80008000,0x80008000,0xbf55bf35,0xbf7bbf6d,0x3f553f35,0x3f7b3f6d
.long 0xbf6dbf80,0xbec4bf35,0xbf6dbf80,0xbec4bf35,0xbe48bf35,0x3f553ec4,0x3e483f35,0xbf55bec4
.long 0x3f358000,0x3f353f80,0x3f358000,0x3f353f80,0x3f7b3f35,0xbf0e3ec4,0xbf7bbf35,0x3f0ebec4
.long 0x3ec43f80,0xbf6dbf35,0x3ec43f80,0xbf6dbf35,0xbf0e3f35,0x3e48bf6d,0x3f0ebf35,0xbe483f6d
.long 0xbf808000,0x3f808000,0xbf808000,0x3f808000,0xbf0ebf35,0x3e483f6d,0x3f0e3f35,0xbe48bf6d
.long 0x3ec4bf80,0xbf6d3f35,0x3ec4bf80,0xbf6d3f35,0x3f7bbf35,0xbf0ebec4,0xbf7b3f35,0x3f0e3ec4
.long 0x3f358000,0x3f35bf80,0x3f358000,0x3f35bf80,0xbe483f35,0x3f55bec4,0x3e48bf35,0xbf553ec4
.long 0xbf6d3f80,0xbec43f35,0xbf6d3f80,0xbec43f35,0xbf553f35,0xbf7b3f6d,0x3f55bf35,0x3f7bbf6d
.long 0x80008000,0x80008000,0x80008000,0x80008000,0xbf7bbf80,0xbf55bf6d,0x3f7b3f80,0x3f553f6d
.long 0x3ec48000,0x3f6d3f35,0x3ec48000,0x3f6d3f35,0x3f553f80,0xbe483ec4,0xbf55bf80,0x3e48bec4
.long 0xbf358000,0xbf35bf80,0xbf358000,0xbf35bf80,0xbf0ebf80,0x3f7b3ec4,0x3f0e3f80,0xbf7bbec4
.long 0x3f6d8000,0xbec43f35,0x3f6d8000,0xbec43f35,0x3e483f80,0xbf0ebf6d,0xbe48bf80,0x3f0e3f6d
.long 0xbf808000,0x3f808000,0xbf808000,0x3f808000,0x3e48bf80,0xbf0e3f6d,0xbe483f80,0x3f0ebf6d
.long 0x3f6d8000,0xbec4bf35,0x3f6d8000,0xbec4bf35,0xbf0e3f80,0x3f7bbec4,0x3f0ebf80,0xbf7b3ec4
.long 0xbf358000,0xbf353f80,0xbf358000,0xbf353f80,0x3f55bf80,0xbe48bec4,0xbf553f80,0x3e483ec4
.long 0x3ec48000,0x3f6dbf35,0x3ec48000,0x3f6dbf35,0xbf7b3f80,0xbf553f6d,0x3f7bbf80,0x3f55bf6d
.long 0x80008000,0x80008000,0x80008000,0x80008000,0xbf0ebf35,0xbe48bec4,0x3f0e3f35,0x3e483ec4
.long 0x3f6d3f80,0x3ec43f35,0x3f6d3f80,0x3ec43f35,0xbf7bbf35,0xbf0ebf6d,0x3f7b3f35,0x3f0e3f6d
.long 0x3f358000,0x3f353f80,0x3f358000,0x3f353f80,0xbe483f35,0xbf55bf6d,0x3e48bf35,0x3f553f6d
.long 0xbec4bf80,0x3f6d3f35,0xbec4bf80,0x3f6d3f35,0x3f553f35,0xbf7bbec4,0xbf55bf35,0x3f7b3ec4
.long 0xbf808000,0x3f808000,0xbf808000,0x3f808000,0x3f55bf35,0xbf7b3ec4,0xbf553f35,0x3f7bbec4
.long 0xbec43f80,0x3f6dbf35,0xbec43f80,0x3f6dbf35,0xbe48bf35,0xbf553f6d,0x3e483f35,0x3f55bf6d
.long 0x3f358000,0x3f35bf80,0x3f358000,0x3f35bf80,0xbf7b3f35,0xbf0e3f6d,0x3f7bbf35,0x3f0ebf6d
.long 0x3f6dbf80,0x3ec4bf35,0x3f6dbf80,0x3ec4bf35,0xbf0e3f35,0xbe483ec4,0x3f0ebf35,0x3e48bec4
.size tbl_k1, 2048
.p2align 8
.type tbl_k3,@object
tbl_k3:
.long 0x80003f80,0x80003f80,0x80003f80,0x80003f80,0x80003f80,0xbec43f6d,0xbf353f35,0xbf6d3ec4
.long 0x80003f80,0xbf353f35,0xbf800000,0xbf35bf35,0x80003f80,0xbf6d3ec4,0xbf35bf35,0x3ec4bf6d
.long 0x80003f80,0xbf800000,0x8000bf80,0x3f800000,0x80003f80,0xbf6dbec4,0x3f35bf35,0x3ec43f6d
.long 0x80003f80,0xbf35bf35,0x3f800000,0xbf353f35,0x80003f80,0xbec4bf6d,0x3f353f35,0xbf6dbec4
.long 0x80003f80,0x8000bf80,0x80003f80,0x8000bf80,0x80003f80,0x3ec4bf6d,0xbf353f35,0x3f6dbec4
.long 0x80003f80,0x3f35bf35,0xbf800000,0x3f353f35,0x80003f80,0x3f6dbec4,0xbf35bf35,0xbec43f6d
.long 0x80003f80,0x3f800000,0x8000bf80,0xbf800000,0x80003f80,0x3f6d3ec4,0x3f35bf35,0xbec4bf6d
.long 0x80003f80,0x3f353f35,0x3f800000,0x3f35bf35,0x80003f80,0x3ec43f6d,0x3f353f35,0x3f6d3ec4
.long 0x80003f80,0x80003f80,0x80003f80,0x80003f80,0xbf800000,0xbf6dbec4,0xbf35bf35,0xbec4bf6d
.long 0x8000bf80,0x3f35bf35,0x3f800000,0x3f353f35,0x3f800000,0x3ec43f6d,0xbf353f35,0xbf6dbec4
.long 0x80003f80,0xbf800000,0x8000bf80,0x3f800000,0xbf800000,0x3ec4bf6d,0x3f353f35,0xbf6d3ec4
.long 0x8000bf80,0x3f353f35,0xbf800000,0x3f35bf35,0x3f800000,0xbf6d3ec4,0x3f35bf35,0xbec43f6d
.long 0x80003f80,0x8000bf80,0x80003f80,0x8000bf80,0xbf800000,0x3f6d3ec4,0xbf35bf35,0x3ec43f6d
.long 0x8000bf80,0xbf353f35,0x3f800000,0xbf35bf35,0x3f800000,0xbec4bf6d,0xbf353f35,0x3f6d3ec4
.long 0x80003f80,0x3f800000,0x8000bf80,0xbf800000,0xbf800000,0xbec43f6d,0x3f353f35,0x3f6dbec4
.long 0x8000bf80,0xbf35bf35,0xbf800000,0xbf353f35,0x3f800000,0x3f6dbec4,0x3f35bf35,0x3ec4bf6d
.long 0x80003f80,0x80003f80,0x80003f80,0x80003f80,0x8000bf80,0x3ec4bf6d,0x3f35bf35,0x3f6dbec4
.long 0x80003f80,0xbf353f35,0xbf800000,0xbf35bf35,0x8000bf80,0x3f6dbec4,0x3f353f35,0xbec43f6d
.long 0x80003f80,0xbf800000,0x8000bf80,0x3f800000,0x8000bf80,0x3f6d3ec4,0xbf353f35,0xbec4bf6d
.long 0x80003f80,0xbf35bf35,0x3f800000,0xbf353f35,0x8000bf80,0x3ec43f6d,0xbf35bf35,0x3f6d3ec4
.long 0x80003f80,0x8000bf80,0x80003f80,0x8000bf80,0x8000bf80,0xbec43f6d,0x3f35bf35,0xbf6d3ec4
.long 0x80003f80,0x3f35bf35,0xbf800000,0x3f353f35,0x8000bf80,0xbf6d3ec4,0x3f353f35,0x3ec4bf6d
.long 0x80003f80,0x3f800000,0x8000bf80,0xbf800000,0x8000bf80,0xbf6dbec4,0xbf353f35,0x3ec43f6d
.long 0x80003f80,0x3f353f35,0x3f800000,0x3f35bf35,0x8000bf80,0xbec4bf6d,0xbf35bf35,0xbf6dbec4
.long 0x80003f80,0x80003f80,0x80003f80,0x80003f80,0x3f800000,0x3f6d3ec4,0x3f353f35,0x3ec43f6d
.long 0x8000bf80,0x3f35bf35,0x3f800000,0x3f353f35,0xbf800000,0xbec4bf6d,0x3f35bf35,0x3f6d3ec4
.long 0x80003f80,0xbf800000,0x8000bf80,0x3f800000,0x3f800000,0xbec43f6d,0xbf35bf35,0x3f6dbec4
.long 0x8000bf80,0x3f353f35,0xbf800000,0x3f35bf35,0xbf800000,0x3f6dbec4,0xbf353f35,0x3ec4bf6d
.long 0x80003f80,0x8000bf80,0x80003f80,0x8000bf80,0x3f800000,0xbf6dbec4,0x3f353f35,0xbec4bf6d
.long 0x8000bf80,0xbf353f35,0x3f800000,0xbf35bf35,0xbf800000,0x3ec43f6d,0x3f35bf35,0xbf6dbec4
.long 0x80003f80,0x3f800000,0x8000bf80,0xbf800000,0x3f800000,0x3ec4bf6d,0xbf35bf35,0xbf6d3ec4
.long 0x8000bf80,0xbf35bf35,0xbf800000,0xbf353f35,0xbf800000,0xbf6d3ec4,0xbf353f35,0xbec43f6d
.long 0x80003f80,0xbe483f7b,0xbec43f6d,0xbf0e3f55,0x80003f80,0xbf0e3f55,0xbf6d3ec4,0xbf7bbe48
.long 0x80003f80,0xbf553f0e,0xbf6dbec4,0xbe48bf7b,0x80003f80,0xbf7b3e48,0xbec4bf6d,0x3f55bf0e
.long 0x80003f80,0xbf7bbe48,0x3ec4bf6d,0x3f553f0e,0x80003f80,0xbf55bf0e,0x3f6dbec4,0xbe483f7b
.long 0x80003f80,0xbf0ebf55,0x3f6d3ec4,0xbf7b3e48,0x80003f80,0xbe48bf7b,0x3ec43f6d,0xbf0ebf55
.long 0x80003f80,0x3e48bf7b,0xbec43f6d,0x3f0ebf55,0x80003f80,0x3f0ebf55,0xbf6d3ec4,0x3f7b3e48
.long 0x80003f80,0x3f55bf0e,0xbf6dbec4,0x3e483f7b,0x80003f80,0x3f7bbe48,0xbec4bf6d,0xbf553f0e
.long 0x80003f80,0x3f7b3e48,0x3ec4bf6d,0xbf55bf0e,0x80003f80,0x3f553f0e,0x3f6dbec4,0x3e48bf7b
.long 0x80003f80,0x3f0e3f55,0x3f6d3ec4,0x3f7bbe48,0x80003f80,0x3e483f7b,0x3ec43f6d,0x3f0e3f55
.long 0xbf353f35,0xbf553f0e,0xbf6d3ec4,0xbf7b3e48,0xbf35bf35,0xbe48bf7b,0x3ec4bf6d,0x3f55bf0e
.long 0x3f35bf35,0x3f7b3e48,0x3ec43f6d,0xbf0e3f55,0x3f353f35,0xbf0e3f55,0xbf6dbec4,0x3e48bf7b
.long 0xbf353f35,0xbf0ebf55,0x3f6dbec4,0x3e483f7b,0xbf35bf35,0x3f7bbe48,0xbec43f6d,0xbf0ebf55
.long 0x3f35bf35,0xbe483f7b,0xbec4bf6d,0x3f553f0e,0x3f353f35,0xbf55bf0e,0x3f6d3ec4,0xbf7bbe48
.long 0xbf353f35,0x3f55bf0e,0xbf6d3ec4,0x3f7bbe48,0xbf35bf35,0x3e483f7b,0x3ec4bf6d,0xbf553f0e
.long 0x3f35bf35,0xbf7bbe48,0x3ec43f6d,0x3f0ebf55,0x3f353f35,0x3f0ebf55,0xbf6dbec4,0xbe483f7b
.long 0xbf353f35,0x3f0e3f55,0x3f6dbec4,0xbe48bf7b,0xbf35bf35,0xbf7b3e48,0xbec43f6d,0x3f0e3f55
.long 0x3f35bf35,0x3e48bf7b,0xbec4bf6d,0xbf55bf0e,0x3f353f35,0x3f553f0e,0x3f6d3ec4,0x3f7b3e48
.long 0xbf800000,0xbf7bbe48,0xbf6dbec4,0xbf55bf0e,0x3f800000,0x3f553f0e,0x3ec43f6d,0xbe483f7b
.long 0xbf800000,0xbf0ebf55,0x3ec4bf6d,0x3f7bbe48,0x3f800000,0x3e483f7b,0xbf6d3ec4,0xbf0ebf55
.long 0xbf800000,0x3e48bf7b,0x3f6d3ec4,0xbf0e3f55,0x3f800000,0xbf0e3f55,0xbec4bf6d,0x3f7b3e48
.long 0xbf800000,0x3f55bf0e,0xbec43f6d,0xbe48bf7b,0x3f800000,0xbf7b3e48,0x3f6dbec4,0xbf553f0e
.long 0xbf800000,0x3f7b3e48,0xbf6dbec4,0x3f553f0e,0x3f800000,0xbf55bf0e,0x3ec43f6d,0x3e48bf7b
.long 0xbf800000,0x3f0e3f55,0x3ec4bf6d,0xbf7b3e48,0x3f800000,0xbe48bf7b,0xbf6d3ec4,0x3f0e3f55
.long 0xbf800000,0xbe483f7b,0x3f6d3ec4,0x3f0ebf55,0x3f800000,0x3f0ebf55,0xbec4bf6d,0xbf7bbe48
.long 0xbf800000,0xbf553f0e,0xbec43f6d,0x3e483f7b,0x3f800000,0x3f7bbe48,0x3f6dbec4,0x3f55bf0e
.long 0xbf35bf35,0xbf0ebf55,0xbec4bf6d,0xbe48bf7b,0xbf353f35,0xbf7b3e48,0xbf6dbec4,0xbf0ebf55
.long 0x3f353f35,0xbe483f7b,0xbf6d3ec4,0xbf55bf0e,0x3f35bf35,0x3f553f0e,0xbec43f6d,0xbf7bbe48
.long 0xbf35bf35,0x3f55bf0e,0x3ec43f6d,0xbf7b3e48,0xbf353f35,0xbe48bf7b,0x3f6d3ec4,0xbf553f0e
.long 0x3f353f35,0xbf7bbe48,0x3f6dbec4,0xbf0e3f55,0x3f35bf35,0xbf0e3f55,0x3ec4bf6d,0xbe483f7b
.long 0xbf35bf35,0x3f0e3f55,0xbec4bf6d,0x3e483f7b,0xbf353f35,0x3f7bbe48,0xbf6dbec4,0x3f0e3f55
.long 0x3f353f35,0x3e48bf7b,0xbf6d3ec4,0x3f553f0e,0x3f35bf35,0xbf55bf0e,0xbec43f6d,0x3f7b3e48
.long 0xbf35bf35,0xbf553f0e,0x3ec43f6d,0x3f7bbe48,0xbf353f35,0x3e483f7b,0x3f6d3ec4,0x3f55bf0e
.long 0x3f353f35,0x3f7b3e48,0x3f6dbec4,0x3f0ebf55,0x3f35bf35,0x3f0ebf55,0x3ec4bf6d,0x3e48bf7b
.long 0x3f803f80,0x80003f80,0x80003f80,0x80003f80,0x3f80bf80,0xbe483f7b,0xbec43f6d,0xbf0e3f55
.long 0x3f803f80,0xbec43f6d,0xbf353f35,0xbf6d3ec4,0x3f80bf80,0xbf0e3f55,0xbf6d3ec4,0xbf7bbe48
.long 0x3f803f80,0xbf353f35,0xbf800000,0xbf35bf35,0x3f80bf80,0xbf553f0e,0xbf6dbec4,0xbe48bf7b
.long 0x3f803f80,0xbf6d3ec4,0xbf35bf35,0x3ec4bf6d,0x3f80bf80,0xbf7b3e48,0xbec4bf6d,0x3f55bf0e
.long 0x3f803f80,0xbf800000,0x8000bf80,0x3f800000,0x3f80bf80,0xbf7bbe48,0x3ec4bf6d,0x3f553f0e
.long 0x3f803f80,0xbf6dbec4,0x3f35bf35,0x3ec43f6d,0x3f80bf80,0xbf55bf0e,0x3f6dbec4,0xbe483f7b
.long 0x3f803f80,0xbf35bf35,0x3f800000,0xbf353f35,0x3f80bf80,0xbf0ebf55,0x3f6d3ec4,0xbf7b3e48
.long 0x3f803f80,0xbec4bf6d,0x3f353f35,0xbf6dbec4,0x3f80bf80,0xbe48bf7b,0x3ec43f6d,0xbf0ebf55
.long 0x80003f80,0x80003f80,0x80003f80,0x80003f80,0xbf353f35,0xbf553f0e,0xbf6d3ec4,0xbf7b3e48
.long 0xbf800000,0xbf6dbec4,0xbf35bf35,0xbec4bf6d,0xbf35bf35,0xbe48bf7b,0x3ec4bf6d,0x3f55bf0e
.long 0x8000bf80,0x3f35bf35,0x3f800000,0x3f353f35,0x3f35bf35,0x3f7b3e48,0x3ec43f6d,0xbf0e3f55
.long 0x3f800000,0x3ec43f6d,0xbf353f35,0xbf6dbec4,0x3f353f35,0xbf0e3f55,0xbf6dbec4,0x3e48bf7b
.long 0x80003f80,0xbf800000,0x8000bf80,0x3f800000,0xbf353f35,0xbf0ebf55,0x3f6dbec4,0x3e483f7b
.long 0xbf800000,0x3ec4bf6d,0x3f353f35,0xbf6d3ec4,0xbf35bf35,0x3f7bbe48,0xbec43f6d,0xbf0ebf55
.long 0x8000bf80,0x3f353f35,0xbf800000,0x3f35bf35,0x3f35bf35,0xbe483f7b,0xbec4bf6d,0x3f553f0e
.long 0x3f800000,0xbf6d3ec4,0x3f35bf35,0xbec43f6d,0x3f353f35,0xbf55bf0e,0x3f6d3ec4,0xbf7bbe48
.long 0x80003f80,0x80003f80,0x80003f80,0x80003f80,0xbf800000,0xbf7bbe48,0xbf6dbec4,0xbf55bf0e
.long 0x8000bf80,0x3ec4bf6d,0x3f35bf35,0x3f6dbec4,0x3f800000,0x3f553f0e,0x3ec43f6d,0xbe483f7b
.long 0x80003f80,0xbf353f35,0xbf800000,0xbf35bf35,0xbf800000,0xbf0ebf55,0x3ec4bf6d,0x3f7bbe48
.long 0x8000bf80,0x3f6dbec4,0x3f353f35,0xbec43f6d,0x3f800000,0x3e483f7b,0xbf6d3ec4,0xbf0ebf55
.long 0x80003f80,0xbf800000,0x8000bf80,0x3f800000,0xbf800000,0x3e48bf7b,0x3f6d3ec4,0xbf0e3f55
.long 0x8000bf80,0x3f6d3ec4,0xbf353f35,0xbec4bf6d,0x3f800000,0xbf0e3f55,0xbec4bf6d,0x3f7b3e48
.long 0x80003f80,0xbf35bf35,0x3f800000,0xbf353f35,0xbf800000,0x3f55bf0e,0xbec43f6d,0xbe48bf7b
.long 0x8000bf80,0x3ec43f6d,0xbf35bf35,0x3f6d3ec4,0x3f800000,0xbf7b3e48,0x3f6dbec4,0xbf553f0e
.long 0x80003f80,0x80003f80,0x80003f80,0x80003f80,0xbf35bf35,0xbf0ebf55,0xbec4bf6d,0xbe48bf7b
.long 0x3f800000,0x3f6d3ec4,0x3f353f35,0x3ec43f6d,0xbf353f35,0xbf7b3e48,0xbf6dbec4,0xbf0ebf55
.long 0x8000bf80,0x3f35bf35,0x3f800000,0x3f353f35,0x3f353f35,0xbe483f7b,0xbf6d3ec4,0xbf55bf0e
.long 0xbf800000,0xbec4bf6d,0x3f35bf35,0x3f6d3ec4,0x3f35bf35,0x3f553f0e,0xbec43f6d,0xbf7bbe48
.long 0x80003f80,0xbf800000,0x8000bf80,0x3f800000,0xbf35bf35,0x3f55bf0e,0x3ec43f6d,0xbf7b3e48
.long 0x3f800000,0xbec43f6d,0xbf35bf35,0x3f6dbec4,0xbf353f35,0xbe48bf7b,0x3f6d3ec4,0xbf553f0e
.long 0x8000bf80,0x3f353f35,0xbf800000,0x3f35bf35,0x3f353f35,0xbf7bbe48,0x3f6dbec4,0xbf0e3f55
.long 0xbf800000,0x3f6dbec4,0xbf353f35,0x3ec4bf6d,0x3f35bf35,0xbf0e3f55,0x3ec4bf6d,0xbe483f7b
.long 0x3f803f80,0x8000bf80,0x80003f80,0x8000bf80,0x3f80bf80,0x3e48bf7b,0xbec43f6d,0x3f0ebf55
.long 0x3f803f80,0x3ec4bf6d,0xbf353f35,0x3f6dbec4,0x3f80bf80,0x3f0ebf55,0xbf6d3ec4,0x3f7b3e48
.long 0x3f803f80,0x3f35bf35,0xbf800000,0x3f353f35,0x3f80bf80,0x3f55bf0e,0xbf6dbec4,0x3e483f7b
.long 0x3f803f80,0x3f6dbec4,0xbf35bf35,0xbec43f6d,0x3f80bf80,0x3f7bbe48,0xbec4bf6d,0xbf553f0e
.long 0x3f803f80,0x3f800000,0x8000bf80,0xbf800000,0x3f80bf80,0x3f7b3e48,0x3ec4bf6d,0xbf55bf0e
.long 0x3f803f80,0x3f6d3ec4,0x3f35bf35,0xbec4bf6d,0x3f80bf80,0x3f553f0e,0x3f6dbec4,0x3e48bf7b
.long 0x3f803f80,0x3f353f35,0x3f800000,0x3f35bf35,0x3f80bf80,0x3f0e3f55,0x3f6d3ec4,0x3f7bbe48
.long 0x3f803f80,0x3ec43f6d,0x3f353f35,0x3f6d3ec4,0x3f80bf80,0x3e483f7b,0x3ec43f6d,0x3f0e3f55
.long 0x80003f80,0x8000bf80,0x80003f80,0x8000bf80,0xbf353f35,0x3f55bf0e,0xbf6d3ec4,0x3f7bbe48
.long 0xbf800000,0x3f6d3ec4,0xbf35bf35,0x3ec43f6d,0xbf35bf35,0x3e483f7b,0x3ec4bf6d,0xbf553f0e
.long 0x8000bf80,0xbf353f35,0x3f800000,0xbf35bf35,0x3f35bf35,0xbf7bbe48,0x3ec43f6d,0x3f0ebf55
.long 0x3f800000,0xbec4bf6d,0xbf353f35,0x3f6d3ec4,0x3f353f35,0x3f0ebf55,0xbf6dbec4,0xbe483f7b
.long 0x80003f80,0x3f800000,0x8000bf80,0xbf800000,0xbf353f35,0x3f0e3f55,0x3f6dbec4,0xbe48bf7b
.long 0xbf800000,0xbec43f6d,0x3f353f35,0x3f6dbec4,0xbf35bf35,0xbf7b3e48,0xbec43f6d,0x3f0e3f55
.long 0x8000bf80,0xbf35bf35,0xbf800000,0xbf353f35,0x3f35bf35,0x3e48bf7b,0xbec4bf6d,0xbf55bf0e
.long 0x3f800000,0x3f6dbec4,0x3f35bf35,0x3ec4bf6d,0x3f353f35,0x3f553f0e,0x3f6d3ec4,0x3f7b3e48
.long 0x80003f80,0x8000bf80,0x80003f80,0x8000bf80,0xbf800000,0x3f7b3e48,0xbf6dbec4,0x3f553f0e
.long 0x8000bf80,0xbec43f6d,0x3f35bf35,0xbf6d3ec4,0x3f800000,0xbf55bf0e,0x3ec43f6d,0x3e48bf7b
.long 0x80003f80,0x3f35bf35,0xbf800000,0x3f353f35,0xbf800000,0x3f0e3f55,0x3ec4bf6d,0xbf7b3e48
.long 0x8000bf80,0xbf6d3ec4,0x3f353f35,0x3ec4bf6d,0x3f800000,0xbe48bf7b,0xbf6d3ec4,0x3f0e3f55
.long 0x80003f80,0x3f800000,0x8000bf80,0xbf800000,0xbf800000,0xbe483f7b,0x3f6d3ec4,0x3f0ebf55
.long 0x8000bf80,0xbf6dbec4,0xbf353f35,0x3ec43f6d,0x3f800000,0x3f0ebf55,0xbec4bf6d,0xbf7bbe48
.long 0x80003f80,0x3f353f35,0x3f800000,0x3f35bf35,0xbf800000,0xbf553f0e,0xbec43f6d,0x3e483f7b
.long 0x8000bf80,0xbec4bf6d,0xbf35bf35,0xbf6dbec4,0x3f800000,0x3f7bbe48,0x3f6dbec4,0x3f55bf0e
.long 0x80003f80,0x8000bf80,0x80003f80,0x8000bf80,0xbf35bf35,0x3f0e3f55,0xbec4bf6d,0x3e483f7b
.long 0x3f800000,0xbf6dbec4,0x3f353f35,0xbec4bf6d,0xbf353f35,0x3f7bbe48,0xbf6dbec4,0x3f0e3f55
.long 0x8000bf80,0xbf353f35,0x3f800000,0xbf35bf35,0x3f353f35,0x3e48bf7b,0xbf6d3ec4,0x3f553f0e
.long 0xbf800000,0x3ec43f6d,0x3f35bf35,0xbf6dbec4,0x3f35bf35,0xbf55bf0e,0xbec43f6d,0x3f7b3e48
.long 0x80003f80,0x3f800000,0x8000bf80,0xbf800000,0xbf35bf35,0xbf553f0e,0x3ec43f6d,0x3f7bbe48
.long 0x3f800000,0x3ec4bf6d,0xbf35bf35,0xbf6d3ec4,0xbf353f35,0x3e483f7b,0x3f6d3ec4,0x3f55bf0e
.long 0x8000bf80,0xbf35bf35,0xbf800000,0xbf353f35,0x3f353f35,0x3f7b3e48,0x3f6dbec4,0x3f0ebf55
.long 0xbf800000,0xbf6d3ec4,0xbf353f35,0xbec43f6d,0x3f35bf35,0x3f0ebf55,0x3ec4bf6d,0x3e48bf7b
.size tbl_k3, 4096
code_end:
.section .rodata,"a"
.p2align 6
.amdhsa_kernel k1a_kernel
  .amdhsa_next_free_vgpr 128
  .amdhsa_next_free_sgpr 100
  .amdhsa_accum_offset 128
  .amdhsa_group_segment_fixed_size 0
  .amdhsa_kernarg_size 88
  .amdhsa_user_sgpr_count 2
  .amdhsa_user_sgpr_kernarg_segment_ptr 1
  .amdhsa_system_sgpr_workgroup_id_x 1
.end_amdhsa_kernel
.p2align 6
.amdhsa_kernel k2a_kernel
  .amdhsa_next_free_vgpr 96
  .amdhsa_next_free_sgpr 100
  .amdhsa_accum_offset 96
  .amdhsa_group_segment_fixed_size 0
  .amdhsa_kernarg_size 88
  .amdhsa_user_sgpr_count 2
  .amdhsa_user_sgpr_kernarg_segment_ptr 1
  .amdhsa_system_sgpr_workgroup_id_x 1
.end_amdhsa_kernel
.p2align 6
.amdhsa_kernel k2b_kernel
  .amdhsa_next_free_vgpr 96
  .amdhsa_next_free_sgpr 100
  .amdhsa_accum_offset 96
  .amdhsa_group_segment_fixed_size 0
  .amdhsa_kernarg_size 88
  .amdhsa_user_sgpr_count 2
  .amdhsa_user_sgpr_kernarg_segment_ptr 1
  .amdhsa_system_sgpr_workgroup_id_x 1
.end_amdhsa_kernel
.p2align 6
.amdhsa_kernel gga_kernel
  .amdhsa_next_free_vgpr 436
  .amdhsa_next_free_sgpr 100
  .amdhsa_accum_offset 256
  .amdhsa_group_segment_fixed_size 0
  .amdhsa_kernarg_size 88
  .amdhsa_user_sgpr_count 2
  .amdhsa_user_sgpr_kernarg_segment_ptr 1
  .amdhsa_system_sgpr_workgroup_id_x 1
.end_amdhsa_kernel
.p2align 6
.amdhsa_kernel ggb_kernel
  .amdhsa_next_free_vgpr 436
  .amdhsa_next_free_sgpr 100
  .amdhsa_accum_offset 256
  .amdhsa_group_segment_fixed_size 0
  .amdhsa_kernarg_size 88
  .amdhsa_user_sgpr_count 2
  .amdhsa_user_sgpr_kernarg_segment_ptr 1
  .amdhsa_system_sgpr_workgroup_id_x 1
.end_amdhsa_kernel
```
